```python
import torch

def _softmax(x, axis=-1):
    return torch.softmax(x, dim=axis)
def _gelu(x):
    return torch.nn.functional.gelu(x, approximate="tanh")
def _silu(x):
    return torch.nn.functional.silu(x)
def _sigmoid(x):
    return torch.sigmoid(x)
def _layernorm(x, axis=-1, eps=1e-5):
    m = x.mean(dim=axis, keepdim=True)
    v = x.var(dim=axis, keepdim=True, unbiased=False)
    return (x - m) / torch.sqrt(v + eps)
def _scatter_add(tgt, idx, src, axis=0):
    return tgt.clone().index_add_(axis, idx, src)
def _segment_sum(src, seg, n):
    out = torch.zeros((n,) + src.shape[1:], dtype=src.dtype)
    return out.index_add_(0, seg, src)
def _pad(x, pw):
    flat = tuple(v for pair in reversed(pw) for v in pair)
    return torch.nn.functional.pad(x, flat)

kernel_name = 'sequential_preLN__mha_block__moe_arch_mod__prompt'

def setup_inputs():

    _w = (lambda a: (lambda t: t.to(torch.bfloat16) if t.is_floating_point() else t)(torch.as_tensor(a)))
    def _A_setup():
        B, S, D, H = 1, 2048, 448, 16
        return {
            "x": _w((lambda *s: torch.randn(*s, dtype=torch.bfloat16) * 0.05)(B, S, D)),
            "wqkv": _w((lambda *s: torch.randn(*s, dtype=torch.bfloat16) * 0.05)(D, 3 * D)),
            "wo": _w((lambda *s: torch.randn(*s, dtype=torch.bfloat16) * 0.05)(D, D)),
        }
    _A_in = _A_setup()

    def _B_setup():
        B, S, D, F, C = 1, 2048, 448, 1792, 2
        return {
            "x": _w((lambda *s: torch.randn(*s, dtype=torch.bfloat16) * 0.05)(B, S, D)),
            "w_r": _w((lambda *s: torch.randn(*s, dtype=torch.bfloat16) * 0.05)(D)),
            "w_gate": _w((lambda *s: torch.randn(*s, dtype=torch.bfloat16) * 0.05)(D, F)),
            "w_up": _w((lambda *s: torch.randn(*s, dtype=torch.bfloat16) * 0.05)(D, F)),
            "w_down": _w((lambda *s: torch.randn(*s, dtype=torch.bfloat16) * 0.05)(F, D)),
        }
    _B_in = _B_setup()

    return {
        "A_x": _A_in["x"],
        "A_wqkv": _A_in["wqkv"],
        "A_wo": _A_in["wo"],
        "B_x": _B_in["x"],
        "B_w_r": _B_in["w_r"],
        "B_w_gate": _B_in["w_gate"],
        "B_w_up": _B_in["w_up"],
        "B_w_down": _B_in["w_down"],
    }

def reference(A_x, A_wqkv, A_wo, B_x, B_w_r, B_w_gate, B_w_up, B_w_down):
    def _A_ref(x, wqkv, wo):
        B, S, D = x.shape
        H = 16
        Dh = D // H
        qkv = (lambda x, *d: x.permute(*d))((x @ wqkv).reshape(B, S, 3, H, Dh), 2, 0, 3, 1, 4)
        q, k, v = qkv[0], qkv[1], qkv[2]
        scores = torch.einsum("bhqd,bhkd->bhqk", q, k) * (Dh ** -0.5)
        p = _softmax(scores, axis=-1)
        o = torch.einsum("bhqk,bhkd->bhqd", p, v)
        return (lambda x, *d: x.permute(*d))(o, 0, 2, 1, 3).reshape(B, S, D) @ wo

    def _B_ref(x, w_r, w_gate, w_up, w_down):
        B, S, D = x.shape
        C = 2
        r = x @ w_r
        idx = torch.argsort(-r, axis=-1)[:, :C]
        idx_e = (lambda x, n, axis: torch.repeat_interleave(x, n, dim=axis))(idx.reshape(B, C, 1), D, axis=2)
        x_sel = (lambda x, i, axis: torch.take_along_dim(x, i, dim=axis))(x, idx_e, axis=1)
        g = _silu(x_sel @ w_gate)
        u = x_sel @ w_up
        y = (g * u) @ w_down
        r_sel = _sigmoid((lambda x, i, axis: torch.take_along_dim(x, i, dim=axis))(r, idx, axis=1))
        y = y * r_sel.reshape(B, C, 1)
        b_off = (torch.arange(B) * S).reshape(B, 1)
        flat_idx = (idx + b_off).reshape(B * C)
        zero = (x * 0.0).reshape(B * S, D)
        upd = _scatter_add(zero, flat_idx, y.reshape(B * C, D), axis=0)
        return x + upd.reshape(B, S, D)

    x = A_x
    h = x + _A_ref(_layernorm(x, axis=-1), A_wqkv, A_wo)
    h2 = h + _B_ref(_layernorm(h, axis=-1), B_w_r, B_w_gate, B_w_up, B_w_down)
    return h2
```

```asm
; @launch grid=(256,1,1) block=(512,1,1) lds=163840
.amdgcn_target "amdgcn-amd-amdhsa--gfx950"
.text
.globl sequential_preLN__mha_block__moe_arch_mod__prompt_kernel
.p2align 8
.type sequential_preLN__mha_block__moe_arch_mod__prompt_kernel,@function
sequential_preLN__mha_block__moe_arch_mod__prompt_kernel:
  s_cmp_ge_u32 s2, 256
  s_cbranch_scc1 L_end
  s_load_dwordx2 s[28:29], s[0:1], 0
  s_load_dwordx2 s[32:33], s[0:1], 8
  s_load_dwordx2 s[36:37], s[0:1], 80
  s_load_dwordx8 s[12:19], s[0:1], 32
  s_load_dwordx2 s[24:25], s[0:1], 16
  s_load_dwordx2 s[20:21], s[0:1], 64
  v_lshrrev_b32 v2, 6, v0
  v_and_b32 v1, 63, v0
  s_lshr_b32 s91, s2, 3
  v_readfirstlane_b32 s49, v2
  s_getpc_b64 s[40:41]
L_pc:
  s_mov_b32 s42, L_code_end-L_pc
  s_mov_b32 s43, 0x20000
  v_lshlrev_b32 v4, 15, v1
  s_lshl_b32 s58, s49, 5
  s_add_u32 s58, s58, s91
  s_lshl_b32 s58, s58, 7
  s_mov_b64 exec, 3
  buffer_load_dword v97, v4, s[40:43], s58 offen
  s_mov_b64 exec, -1
  s_and_b32 s52, s2, 7
  s_lshr_b32 s50, s91, 1
  s_and_b32 s53, s91, 1
  s_and_b32 s54, s49, 3
  s_lshr_b32 s55, s49, 2
  v_lshrrev_b32 v2, 3, v1
  v_and_b32 v3, 7, v1
  v_lshrrev_b32 v8, 4, v1
  v_mul_u32_u24 v240, 896, v2
  v_xor_b32 v9, v3, v8
  s_lshl_b32 s58, s50, 2
  s_add_u32 s58, s58, s54
  s_mul_i32 s58, s58, 28672
  v_lshl_add_u32 v240, v9, 4, v240
  v_add_u32 v240, s58, v240
  v_xor_b32 v241, 64, v240
  v_add_u32 v241, 6144, v241
  v_add_u32 v242, 12288, v240
  v_add_u32 v243, 12288, v241
  s_add_u32 s61, s50, s52
  s_mul_i32 s59, s61, 147
  s_lshr_b32 s59, s59, 10
  s_mul_i32 s59, s59, 7
  s_sub_u32 s61, s61, s59
  s_lshl_b32 s84, s61, 7
  s_add_u32 s85, s84, 128
  s_cmp_eq_u32 s85, 896
  s_cselect_b32 s85, 0, s85
  s_lshl_b32 s60, s54, 12
  s_mov_b32 s30, 0x1c0000
  s_mov_b32 s31, 0x20000
  s_mov_b32 s38, 0xc00000
  s_mov_b32 s39, 0x20000
  s_cmp_eq_u32 s55, 1
  s_cbranch_scc1 L_wb
  s_waitcnt lgkmcnt(0)
  s_add_u32 m0, s60, 0
  s_nop 0
  buffer_load_dwordx4 v240, s[28:31], s84 offen offset:0 lds
  buffer_load_dwordx4 v241, s[28:31], s84 offen offset:1024 lds
  buffer_load_dwordx4 v242, s[28:31], s84 offen offset:2048 lds
  buffer_load_dwordx4 v243, s[28:31], s84 offen offset:3072 lds
  s_load_dword s48, s[36:37], 0
  s_branch L_wa
L_wb:
  s_setprio 3
  s_mul_i32 s63, s52, 112
  s_mul_i32 s58, s54, 43008
  s_add_u32 s82, s58, s63
  s_mul_i32 s59, s53, 896
  s_add_u32 s59, s59, s82
  s_add_u32 s59, s59, 896
  v_and_b32 v9, 1, v8
  v_lshlrev_b32 v9, 2, v9
  v_xor_b32 v9, v3, v9
  v_min_u32 v9, 6, v9
  v_mul_u32_u24 v6, 2688, v2
  v_lshl_add_u32 v6, v9, 4, v6
  v_add_u32 v6, s59, v6
  v_add_u32 v5, 20480, v6
  s_lshl_b32 s62, s54, 11
  s_mov_b32 s34, 0x126000
  s_mov_b32 s35, 0x20000
  s_waitcnt lgkmcnt(0)
  s_add_u32 m0, s62, 114688
  s_mul_i32 s59, s84, 1344
  buffer_load_dwordx4 v6, s[32:35], s59 offen offset:0 lds
  buffer_load_dwordx4 v5, s[32:35], s59 offen offset:1024 lds
  s_load_dword s48, s[36:37], 0
  s_lshl_b32 s57, s50, 3
  s_add_u32 s57, s57, s52
  s_cmp_lt_u32 s57, 98
  s_cselect_b32 s80, s53, 0
  s_cmp_eq_u32 s54, 1
  s_cselect_b32 s80, s80, 0
  s_add_u32 s86, s85, 128
  s_cmp_eq_u32 s86, 896
  s_cselect_b32 s86, 0, s86
  s_add_u32 s87, s86, 128
  s_cmp_eq_u32 s87, 896
  s_cselect_b32 s87, 0, s87
  s_add_u32 s88, s87, 128
  s_cmp_eq_u32 s88, 896
  s_cselect_b32 s88, 0, s88
  s_add_u32 s89, s88, 128
  s_cmp_eq_u32 s89, 896
  s_cselect_b32 s89, 0, s89
  s_add_u32 s90, s89, 128
  s_cmp_eq_u32 s90, 896
  s_cselect_b32 s90, 0, s90
  s_add_u32 m0, s60, 16384
  s_nop 0
  buffer_load_dwordx4 v240, s[28:31], s85 offen offset:0 lds
  buffer_load_dwordx4 v241, s[28:31], s85 offen offset:1024 lds
  buffer_load_dwordx4 v242, s[28:31], s85 offen offset:2048 lds
  buffer_load_dwordx4 v243, s[28:31], s85 offen offset:3072 lds
  v_lshlrev_b32 v4, 4, v1
  s_mul_i32 s61, s52, 57344
  s_add_u32 s61, s61, 10485760
  s_lshl_b32 s51, s52, 1
  s_add_u32 s51, s51, s53
  s_lshl_b32 s73, s49, 10
  s_getreg_b32 s56, hwreg(HW_REG_XCC_ID, 0, 4)
  v_and_b32 v27, 31, v1
  v_lshrrev_b32 v28, 5, v1
  v_bfe_u32 v9, v27, 1, 3
  v_xor_b32 v9, v9, v28
  s_lshl_b32 s58, s54, 1
  v_xor_b32 v9, s58, v9
  v_lshlrev_b32 v9, 4, v9
  v_lshl_add_u32 v8, v27, 7, v9
  s_lshl_b32 s58, s54, 12
  v_add_u32 v8, s58, v8
  v_xor_b32 v9, 32, v8
  v_xor_b32 v10, 64, v8
  v_xor_b32 v11, 96, v8
  v_add_u32 v12, 0x10000, v8
  v_add_u32 v13, 0x10000, v9
  v_add_u32 v14, 0x10000, v10
  v_add_u32 v15, 0x10000, v11
  v_bfe_u32 v29, v1, 2, 2
  v_and_b32 v3, 3, v1
  v_bfe_u32 v30, v1, 4, 1
  v_lshlrev_b32 v30, 5, v30
  v_lshl_add_u32 v30, v3, 3, v30
  v_lshl_add_u32 v31, v28, 3, v29
  s_lshl_b32 s58, s52, 8
  s_add_u32 s58, s58, 4096
  v_lshl_add_u32 v84, v27, 3, s58
  s_lshl_b32 s58, s55, 3
  s_add_u32 s81, s58, s50
  v_and_b32 v2, 7, v1
  v_add_u32 v2, s81, v2
  v_and_b32 v2, 15, v2
  v_bfe_u32 v3, v1, 3, 1
  v_lshl_add_u32 v2, v3, 4, v2
  s_lshl_b32 s58, s52, 2
  s_add_u32 s58, s58, s54
  s_lshl_b32 s58, s58, 7
  s_add_u32 s8, s58, 36864
  v_lshl_add_u32 v85, v2, 2, s8
  v_lshrrev_b32 v2, 2, v1
  v_lshrrev_b32 v3, 4, v1
  v_xor_b32 v2, v2, v3
  v_and_b32 v2, 1, v2
  v_add_u32 v2, -1, v2
  v_and_b32 v108, 0x3f803f80, v2
  v_mov_b32 v109, v108
  v_mov_b32 v110, v108
  v_mov_b32 v111, v108
  s_add_u32 s4, s54, 1
  s_and_b32 s4, s4, 3
  s_lshl_b32 s4, s4, 11
  s_add_u32 s5, s54, 2
  s_and_b32 s5, s5, 3
  s_lshl_b32 s5, s5, 11
  s_add_u32 s6, s54, 3
  s_and_b32 s6, s6, 3
  s_lshl_b32 s6, s6, 11
  s_add_u32 s7, s54, 4
  s_and_b32 s7, s7, 3
  s_lshl_b32 s7, s7, 11
  s_lshl_b32 s72, s55, 16
  s_lshl_b32 s83, s49, 2
  s_mul_i32 s58, s55, s54
  s_sub_u32 s3, s83, s58
  s_lshl_b32 s83, s3, 10
  s_add_u32 s83, s83, 1179648
  s_mul_i32 s58, s50, 147
  s_lshr_b32 s58, s58, 10
  s_mul_i32 s58, s58, 7
  s_sub_u32 s58, s50, s58
  s_cmp_eq_u32 s58, s52
  s_cselect_b32 s9, 0, 2
  s_mul_i32 s9, s9, s53
  s_cmp_lt_u32 s91, 28
  s_cselect_b32 s58, 1, 2
  s_cmp_eq_u32 s52, 7
  s_cselect_b32 s9, s58, s9
  s_mul_i32 s58, s53, 7
  s_or_b32 s2, s57, s58
  s_lshl_b32 s58, s51, 6
  s_add_u32 s58, s58, s54
  s_lshl_b32 s58, s58, 12
  s_add_u32 s58, s58, 6291456
  s_add_u32 s59, s81, 0
  s_and_b32 s59, s59, 15
  s_lshl_b32 s59, s59, 14
  s_add_u32 s64, s58, s59
  s_add_u32 s59, s81, 1
  s_and_b32 s59, s59, 15
  s_lshl_b32 s59, s59, 14
  s_add_u32 s65, s58, s59
  s_add_u32 s59, s81, 2
  s_and_b32 s59, s59, 15
  s_lshl_b32 s59, s59, 14
  s_add_u32 s66, s58, s59
  s_add_u32 s59, s81, 3
  s_and_b32 s59, s59, 15
  s_lshl_b32 s59, s59, 14
  s_add_u32 s67, s58, s59
  s_add_u32 s59, s81, 4
  s_and_b32 s59, s59, 15
  s_lshl_b32 s59, s59, 14
  s_add_u32 s68, s58, s59
  s_add_u32 s59, s81, 5
  s_and_b32 s59, s59, 15
  s_lshl_b32 s59, s59, 14
  s_add_u32 s69, s58, s59
  s_add_u32 s59, s81, 6
  s_and_b32 s59, s59, 15
  s_lshl_b32 s59, s59, 14
  s_add_u32 s70, s58, s59
  s_add_u32 s59, s81, 7
  s_and_b32 s59, s59, 15
  s_lshl_b32 s59, s59, 14
  s_add_u32 s71, s58, s59
  v_lshl_add_u32 v80, v31, 6, v30
  v_add_u32 v80, s60, v80
  s_lshl_b32 s59, s53, 3
  v_xor_b32 v81, 4096, v80
  v_xor_b32 v82, 8192, v80
  v_xor_b32 v83, 12288, v80
  v_add_u32 v80, s59, v80
  v_add_u32 v81, s59, v81
  v_add_u32 v82, s59, v82
  v_add_u32 v83, s59, v83
  v_lshlrev_b32 v92, 4, v27
  v_add_u32 v92, 35840, v92
  s_lshl_b32 s58, s54, 2
  v_add_u32 v91, s58, v92
  s_lshl_b32 s58, s54, 7
  s_add_u32 s59, s58, 36352
  v_lshl_add_u32 v94, v28, 4, s59
  v_lshl_add_u32 v90, v27, 2, s59
  s_add_u32 s59, s58, 33792
  v_lshl_add_u32 v86, v27, 2, s59
  s_add_u32 s58, s62, 155648
  v_add_u32 v93, s58, v4
  v_and_b32 v3, 15, v1
  v_lshlrev_b32 v87, 7, v3
  v_lshrrev_b32 v2, 4, v1
  v_lshl_add_u32 v87, v2, 18, v87
  v_and_b32 v2, 1, v2
  v_mul_u32_u24 v89, 20480, v2
  v_lshl_add_u32 v89, v28, 8, v89
  v_lshl_add_u32 v89, v3, 4, v89
  v_mov_b32 v128, 0
  v_mov_b32 v129, 0
  v_mov_b32 v130, 0
  v_mov_b32 v131, 0
  v_mov_b32 v132, 0
  v_mov_b32 v133, 0
  v_mov_b32 v134, 0
  v_mov_b32 v135, 0
  v_mov_b32 v136, 0
  v_mov_b32 v137, 0
  v_mov_b32 v138, 0
  v_mov_b32 v139, 0
  v_mov_b32 v140, 0
  v_mov_b32 v141, 0
  v_mov_b32 v142, 0
  v_mov_b32 v143, 0
  v_mov_b32 v144, 0
  v_mov_b32 v145, 0
  v_mov_b32 v146, 0
  v_mov_b32 v147, 0
  v_mov_b32 v148, 0
  v_mov_b32 v149, 0
  v_mov_b32 v150, 0
  v_mov_b32 v151, 0
  v_mov_b32 v152, 0
  v_mov_b32 v153, 0
  v_mov_b32 v154, 0
  v_mov_b32 v155, 0
  v_mov_b32 v156, 0
  v_mov_b32 v157, 0
  v_mov_b32 v158, 0
  v_mov_b32 v159, 0
  v_mov_b32 v160, 0
  v_mov_b32 v161, 0
  v_mov_b32 v162, 0
  v_mov_b32 v163, 0
  v_mov_b32 v164, 0
  v_mov_b32 v165, 0
  v_mov_b32 v166, 0
  v_mov_b32 v167, 0
  v_mov_b32 v168, 0
  v_mov_b32 v169, 0
  v_mov_b32 v170, 0
  v_mov_b32 v171, 0
  v_mov_b32 v172, 0
  v_mov_b32 v173, 0
  v_mov_b32 v174, 0
  v_mov_b32 v175, 0
  s_cmp_eq_u32 s80, 1
  s_cbranch_scc1 L_b_keep
  v_mov_b32 v112, 0
  v_mov_b32 v113, 0
  v_mov_b32 v114, 0
  v_mov_b32 v115, 0
  v_mov_b32 v116, 0
  v_mov_b32 v117, 0
  v_mov_b32 v118, 0
  v_mov_b32 v119, 0
  v_mov_b32 v120, 0
  v_mov_b32 v121, 0
  v_mov_b32 v122, 0
  v_mov_b32 v123, 0
  v_mov_b32 v124, 0
  v_mov_b32 v125, 0
  v_mov_b32 v126, 0
  v_mov_b32 v127, 0
L_b_keep:
  s_add_u32 m0, s62, 122880
  s_mul_i32 s59, s85, 1344
  buffer_load_dwordx4 v6, s[32:35], s59 offen offset:0 lds
  buffer_load_dwordx4 v5, s[32:35], s59 offen offset:1024 lds
  v_lshrrev_b32 v2, 2, v1
  v_and_b32 v3, 3, v1
  v_mul_u32_u24 v7, 2688, v2
  v_lshl_add_u32 v7, v3, 4, v7
  s_cmp_eq_u32 s80, 1
  s_cbranch_scc1 L_b_task
  s_cmp_eq_u32 s54, 2
  s_cbranch_scc1 L_b_warm
  s_mul_i32 s58, s91, 37632
  s_add_u32 s58, s58, s63
  s_cmp_eq_u32 s54, 0
  s_cselect_b32 exec_lo, -1, 1
  s_cselect_b32 exec_hi, 0x00ffffff, 0
  buffer_load_dwordx4 v[100:103], v7, s[32:35], s58 offen
  buffer_load_dwordx4 v[104:107], v7, s[32:35], s58 offen offset:48
  s_mov_b64 exec, 1
  buffer_load_dword v98, v7, s[32:35], s58 offen
  buffer_load_dword v98, v7, s[32:35], s58 offen
  s_mov_b64 exec, -1
  s_branch L_b_common
L_b_task:
  s_mov_b32 s40, s24
  s_mov_b32 s41, s25
  s_mov_b32 s42, 0x62000
  s_mov_b32 s43, 0x20000
  s_mul_i32 s58, s57, 147
  s_lshr_b32 s58, s58, 10
  s_mul_i32 s59, s58, 7
  s_sub_u32 s59, s57, s59
  s_lshl_b32 s58, s58, 4
  s_lshl_b32 s59, s59, 7
  s_mov_b32 s76, 0x85632410
  s_mov_b32 s77, 0xdcba79
  v_lshrrev_b32 v2, 4, v1
  v_add_u32 v2, s58, v2
  v_bfe_u32 v3, v1, 3, 1
  v_mul_u32_u24 v99, 896, v3
  v_and_b32 v3, 7, v1
  v_lshl_add_u32 v99, v3, 4, v99
  v_lshrrev_b32 v3, 1, v2
  v_mul_u32_u24 v3, 147, v3
  v_lshrrev_b32 v3, 10, v3
  v_mul_u32_u24 v3, 14, v3
  v_sub_u32 v98, v2, v3
  v_lshlrev_b32 v98, 2, v98
  v_lshrrev_b64 v[100:101], v98, s[76:77]
  v_and_b32 v100, 15, v100
  v_add_u32 v3, v3, v100
  v_mul_u32_u24 v3, 1792, v3
  v_add_u32 v3, v3, v99
  buffer_load_dwordx4 v[112:115], v3, s[40:43], s59 offen
  v_add_u32 v2, 4, v2
  v_lshrrev_b32 v3, 1, v2
  v_mul_u32_u24 v3, 147, v3
  v_lshrrev_b32 v3, 10, v3
  v_mul_u32_u24 v3, 14, v3
  v_sub_u32 v98, v2, v3
  v_lshlrev_b32 v98, 2, v98
  v_lshrrev_b64 v[100:101], v98, s[76:77]
  v_and_b32 v100, 15, v100
  v_add_u32 v3, v3, v100
  v_mul_u32_u24 v3, 1792, v3
  v_add_u32 v3, v3, v99
  buffer_load_dwordx4 v[116:119], v3, s[40:43], s59 offen
  v_add_u32 v2, 4, v2
  v_lshrrev_b32 v3, 1, v2
  v_mul_u32_u24 v3, 147, v3
  v_lshrrev_b32 v3, 10, v3
  v_mul_u32_u24 v3, 14, v3
  v_sub_u32 v98, v2, v3
  v_lshlrev_b32 v98, 2, v98
  v_lshrrev_b64 v[100:101], v98, s[76:77]
  v_and_b32 v100, 15, v100
  v_add_u32 v3, v3, v100
  v_mul_u32_u24 v3, 1792, v3
  v_add_u32 v3, v3, v99
  buffer_load_dwordx4 v[120:123], v3, s[40:43], s59 offen
  v_add_u32 v2, 4, v2
  v_lshrrev_b32 v3, 1, v2
  v_mul_u32_u24 v3, 147, v3
  v_lshrrev_b32 v3, 10, v3
  v_mul_u32_u24 v3, 14, v3
  v_sub_u32 v98, v2, v3
  v_lshlrev_b32 v98, 2, v98
  v_lshrrev_b64 v[100:101], v98, s[76:77]
  v_and_b32 v100, 15, v100
  v_add_u32 v3, v3, v100
  v_mul_u32_u24 v3, 1792, v3
  v_add_u32 v3, v3, v99
  buffer_load_dwordx4 v[124:127], v3, s[40:43], s59 offen
  s_branch L_b_common
L_b_warm:
  s_mov_b32 s40, s12
  s_mov_b32 s41, s13
  s_mov_b32 s42, 0x380
  s_mov_b32 s43, 0x20000
  v_and_b32 v2, 15, v1
  v_lshlrev_b32 v2, 7, v2
  v_lshrrev_b32 v3, 4, v1
  v_mul_u32_u24 v3, 28672, v3
  v_add_u32 v3, v2, v3
  s_mul_i32 s58, s91, 896
  s_mul_i32 s59, s52, 57344
  s_add_u32 s59, s59, s58
  s_add_u32 s59, s59, 10485760
  s_mov_b64 exec, 0x007f007f
  buffer_load_dword v98, v3, s[36:39], s59 offen sc1
  s_lshl_b32 s58, s52, 8
  s_add_u32 s58, s58, 4096
  s_mov_b64 exec, 3
  buffer_load_dword v98, v2, s[36:39], s58 offen sc1
  s_lshl_b32 s58, s52, 9
  s_add_u32 s58, s58, 36864
  s_mov_b64 exec, 15
  buffer_load_dword v98, v2, s[36:39], s58 offen sc1
  s_mov_b64 exec, 0x7f
  buffer_load_dword v98, v2, s[40:43], 0 offen
  s_mov_b64 exec, -1
L_b_common:
  s_mul_i32 s59, s53, 48
  s_add_u32 s58, s82, s59
  v_add_u32 v7, s58, v7
  s_lshl_b32 s63, s54, 10
  s_waitcnt vmcnt(10) lgkmcnt(0)
  s_add_u32 s48, s48, 0x9e3779b9
  s_barrier
  s_add_u32 m0, s60, 32768
  s_nop 0
  buffer_load_dwordx4 v240, s[28:31], s86 offen offset:0 lds
  buffer_load_dwordx4 v241, s[28:31], s86 offen offset:1024 lds
  buffer_load_dwordx4 v242, s[28:31], s86 offen offset:2048 lds
  buffer_load_dwordx4 v243, s[28:31], s86 offen offset:3072 lds
  s_add_u32 m0, s62, 131072
  s_mul_i32 s59, s86, 1344
  buffer_load_dwordx4 v6, s[32:35], s59 offen offset:0 lds
  buffer_load_dwordx4 v5, s[32:35], s59 offen offset:1024 lds
  s_waitcnt vmcnt(10) lgkmcnt(0)
  s_barrier
  s_add_u32 m0, s60, 49152
  s_nop 0
  buffer_load_dwordx4 v240, s[28:31], s87 offen offset:0 lds
  buffer_load_dwordx4 v241, s[28:31], s87 offen offset:1024 lds
  buffer_load_dwordx4 v242, s[28:31], s87 offen offset:2048 lds
  buffer_load_dwordx4 v243, s[28:31], s87 offen offset:3072 lds
  s_add_u32 m0, s62, 139264
  s_mul_i32 s59, s87, 1344
  buffer_load_dwordx4 v6, s[32:35], s59 offen offset:0 lds
  buffer_load_dwordx4 v5, s[32:35], s59 offen offset:1024 lds
  s_cmp_lg_u32 s54, 0
  s_cbranch_scc1 L_b_nocomp2
  s_mul_i32 s58, s91, 896
  s_add_u32 s58, s58, s61
  s_add_u32 s59, s58, 28672
  s_mov_b32 exec_hi, 0x00ffffff
  s_waitcnt vmcnt(12)
  buffer_store_dwordx4 v[100:103], v4, s[36:39], s58 offen
  buffer_store_dwordx4 v[104:107], v4, s[36:39], s59 offen
  s_mov_b32 exec_hi, -1
L_b_nocomp2:
  s_cmp_eq_u32 s80, 0
  s_cbranch_scc1 L_notask2
  v_add_u32 v2, 0x20000, v4
  s_waitcnt vmcnt(12)
  ds_write_b128 v2, v[112:115] offset:18432
  ds_write_b128 v2, v[116:119] offset:19456
  ds_write_b128 v2, v[120:123] offset:26624
  ds_write_b128 v2, v[124:127] offset:27648
  v_bfe_u32 v2, v1, 4, 1
  v_lshl_add_u32 v2, v2, 3, v29
  v_and_b32 v3, 3, v1
  v_lshlrev_b32 v3, 4, v3
  v_lshl_add_u32 v2, v2, 7, v3
  v_lshl_add_u32 v2, v28, 13, v2
  v_add_u32 v2, 0x20000, v2
  s_waitcnt lgkmcnt(0)
  ds_read_b64_tr_b16 v[112:113], v2 offset:18432
  ds_read_b64_tr_b16 v[114:115], v2 offset:18944
  ds_read_b64_tr_b16 v[116:117], v2 offset:18440
  ds_read_b64_tr_b16 v[118:119], v2 offset:18952
  ds_read_b64_tr_b16 v[120:121], v2 offset:18496
  ds_read_b64_tr_b16 v[122:123], v2 offset:19008
  ds_read_b64_tr_b16 v[124:125], v2 offset:18504
  ds_read_b64_tr_b16 v[126:127], v2 offset:19016
  s_waitcnt lgkmcnt(0)
L_notask2:
  ds_read_b128 v[16:19], v8 offset:0
  ds_read_b128 v[44:47], v9 offset:0
  ds_read_b128 v[48:51], v10 offset:0
  ds_read_b128 v[52:55], v11 offset:0
  s_waitcnt vmcnt(8) lgkmcnt(0)
  s_cmp_eq_u32 s54, 0
  s_cbranch_scc1 L_w4_1
  s_waitcnt vmcnt(6)
L_w4_1:
  s_barrier
  s_add_u32 m0, s60, 65536
  s_nop 0
  buffer_load_dwordx4 v240, s[28:31], s88 offen offset:0 lds
  buffer_load_dwordx4 v241, s[28:31], s88 offen offset:1024 lds
  buffer_load_dwordx4 v242, s[28:31], s88 offen offset:2048 lds
  buffer_load_dwordx4 v243, s[28:31], s88 offen offset:3072 lds
  s_add_u32 m0, s62, 147456
  s_mul_i32 s59, s88, 1344
  buffer_load_dwordx4 v6, s[32:35], s59 offen offset:0 lds
  buffer_load_dwordx4 v5, s[32:35], s59 offen offset:1024 lds
  ds_read_b128 v[20:23], v8 offset:16384
  ds_read_b128 v[56:59], v9 offset:16384
  ds_read_b128 v[60:63], v10 offset:16384
  ds_read_b128 v[64:67], v11 offset:16384
  s_waitcnt vmcnt(8) lgkmcnt(0)
  s_cmp_eq_u32 s54, 0
  s_cbranch_scc1 L_w4_2
  s_waitcnt vmcnt(6)
L_w4_2:
  s_barrier
  s_cmp_lg_u32 s54, 0
  s_cbranch_scc1 L_b_noflag
  v_mov_b32 v2, s48
  v_mov_b32 v3, s56
  s_lshl_b32 s58, s91, 3
  s_mov_b64 exec, 1
  s_waitcnt vmcnt(6)
  buffer_store_dwordx2 v[2:3], v84, s[36:39], s58 offen
  s_mov_b64 exec, -1
L_b_noflag:
  s_add_u32 m0, s60, 0
  s_mul_i32 s59, s90, 1344
  buffer_load_dwordx4 v6, s[32:35], s59 offen offset:0 lds
  buffer_load_dwordx4 v5, s[32:35], s59 offen offset:1024 lds
  s_add_u32 m0, s60, 81920
  s_nop 0
  buffer_load_dwordx4 v240, s[28:31], s89 offen offset:0 lds
  buffer_load_dwordx4 v241, s[28:31], s89 offen offset:1024 lds
  buffer_load_dwordx4 v242, s[28:31], s89 offen offset:2048 lds
  buffer_load_dwordx4 v243, s[28:31], s89 offen offset:3072 lds
  s_add_u32 m0, s62, 155648
  s_mul_i32 s59, s89, 1344
  buffer_load_dwordx4 v6, s[32:35], s59 offen offset:0 lds
  buffer_load_dwordx4 v5, s[32:35], s59 offen offset:1024 lds
  ds_read_b128 v[24:27], v8 offset:32768
  ds_read_b128 v[68:71], v9 offset:32768
  ds_read_b128 v[72:75], v10 offset:32768
  ds_read_b128 v[76:79], v11 offset:32768
  ds_read_b128 v[28:31], v8 offset:49152
  ds_read_b128 v[176:179], v9 offset:49152
  ds_read_b128 v[180:183], v10 offset:49152
  ds_read_b128 v[184:187], v11 offset:49152
  s_waitcnt vmcnt(9) lgkmcnt(0)
  s_cmp_eq_u32 s54, 0
  s_cbranch_scc1 L_w4_3
  s_waitcnt vmcnt(8)
L_w4_3:
  s_barrier
  buffer_load_dwordx2 v[96:97], v84, s[36:39], 0 offen sc1
  s_add_u32 m0, s60, 98304
  s_nop 0
  buffer_load_dwordx4 v240, s[28:31], s90 offen offset:0 lds
  buffer_load_dwordx4 v241, s[28:31], s90 offen offset:1024 lds
  buffer_load_dwordx4 v242, s[28:31], s90 offen offset:2048 lds
  buffer_load_dwordx4 v243, s[28:31], s90 offen offset:3072 lds
  ds_read_b128 v[32:35], v12 offset:0
  ds_read_b128 v[188:191], v13 offset:0
  ds_read_b128 v[192:195], v14 offset:0
  ds_read_b128 v[196:199], v15 offset:0
  s_waitcnt vmcnt(5) lgkmcnt(0)
  s_barrier
  s_movk_i32 s82, 1344
  v_mov_b32 v95, 0
  s_mov_b32 s74, 0
  s_mov_b32 s75, 0
  s_waitcnt vmcnt(4)
L_cf_poll:
  s_add_u32 s75, s75, 1
  v_cmp_ne_u32 s[76:77], s48, v96
  v_cmp_ne_u32 s[78:79], s56, v97
  s_nop 0
  s_or_b64 s[76:77], s[76:77], s[78:79]
  s_cbranch_scc0 L_cf_ok
  s_cmp_ge_u32 s75, 24
  s_cbranch_scc1 L_cf_done
  buffer_load_dwordx2 v[96:97], v84, s[36:39], 0 offen sc1
  s_waitcnt vmcnt(0)
  s_branch L_cf_poll
L_cf_ok:
  s_mul_i32 s58, s53, 28672
  s_add_u32 s58, s58, s61
  s_add_u32 s58, s58, s63
  v_add_u32 v7, s58, v4
  v_mov_b32 v95, 1
  s_mov_b32 s74, 1
  s_movk_i32 s82, 32
  s_mov_b32 s32, s36
  s_mov_b32 s33, s37
  s_mov_b32 s34, 0xc00000
L_cf_done:
  s_add_u32 m0, s60, 2048
  s_mul_i32 s59, s84, s82
  buffer_load_dwordx4 v7, s[32:35], s59 offen sc1 lds
  s_add_u32 m0, s60, 3072
  s_mul_i32 s59, s85, s82
  buffer_load_dwordx4 v7, s[32:35], s59 offen sc1 lds
  s_add_u32 m0, s60, 16384
  s_mul_i32 s59, s86, s82
  buffer_load_dwordx4 v7, s[32:35], s59 offen sc1 lds
  ds_read_b128 v[36:39], v12 offset:16384
  ds_read_b128 v[200:203], v13 offset:16384
  ds_read_b128 v[204:207], v14 offset:16384
  ds_read_b128 v[208:211], v15 offset:16384
  s_waitcnt vmcnt(3) lgkmcnt(0)
  s_barrier
  s_add_u32 m0, s60, 17408
  s_mul_i32 s59, s87, s82
  buffer_load_dwordx4 v7, s[32:35], s59 offen sc1 lds
  s_add_u32 m0, s60, 18432
  s_mul_i32 s59, s88, s82
  buffer_load_dwordx4 v7, s[32:35], s59 offen sc1 lds
  s_add_u32 m0, s60, 19456
  s_mul_i32 s59, s89, s82
  buffer_load_dwordx4 v7, s[32:35], s59 offen sc1 lds
  s_add_u32 m0, s60, 32768
  s_mul_i32 s59, s90, s82
  buffer_load_dwordx4 v7, s[32:35], s59 offen sc1 lds
  s_lshl_b32 s58, s52, 7
  s_lshl_b32 s59, s50, 2
  s_add_u32 s58, s58, s59
  s_add_u32 s58, s58, s54
  s_lshl_b32 s58, s58, 1
  s_add_u32 s58, s58, s53
  s_lshl_b32 s58, s58, 11
  s_add_u32 s58, s58, 6291456
  s_mov_b32 exec_hi, 0
  buffer_load_dword v97, v87, s[36:39], s58 offen sc1
  s_mov_b32 exec_hi, -1
  s_lshl_b32 s58, s50, 2
  s_add_u32 s58, s58, s54
  s_mul_i32 s58, s58, 40960
  s_mul_i32 s59, s51, 1280
  s_add_u32 s58, s58, s59
  s_add_u32 s82, s58, 1638400
  s_mul_i32 s58, s50, 147
  s_lshr_b32 s58, s58, 10
  s_mul_i32 s58, s58, 7
  s_sub_u32 s58, s50, s58
  s_cmp_eq_u32 s58, s52
  s_cselect_b32 s81, 0xffff0000, 0
  s_cmp_eq_u32 s54, 3
  s_cselect_b32 s81, s81, 0
  s_and_b32 s58, s52, 1
  s_lshl_b32 s58, s58, 4
  s_lshl_b32 s58, 0xffff, s58
  s_lshr_b32 s59, s52, 1
  s_cmp_eq_u32 s59, s54
  s_cselect_b32 s81, s58, s81
  s_cmp_eq_u32 s52, 7
  s_cselect_b32 s81, 0, s81
  s_mul_i32 s81, s81, s74
  s_setprio 1
  s_lshl_b32 s58, s54, 2
  s_add_u32 s58, s58, 37888
  v_mov_b32 v2, s58
  ds_write_b32 v2, v95
  ds_read_b128 v[40:43], v12 offset:32768
  ds_read_b128 v[212:215], v13 offset:32768
  ds_read_b128 v[216:219], v14 offset:32768
  ds_read_b128 v[220:223], v15 offset:32768
  v_mov_b32 v15, v4
  v_add_u32 v12, 155648, v15
  v_add_u32 v13, s72, v15
  v_mov_b32 v14, 0xdddddddd
  v_add_u32 v8, s4, v12
  v_lshl_add_u32 v4, s4, 3, v13
  v_add_u32 v9, s5, v12
  v_lshl_add_u32 v5, s5, 3, v13
  v_add_u32 v10, s6, v12
  v_lshl_add_u32 v6, s6, 3, v13
  v_add_u32 v11, s7, v12
  v_lshl_add_u32 v7, s7, 3, v13
  v_mov_b32 v13, v89
  v_mov_b32 v106, 0
  v_mov_b32 v107, 0
  v_mov_b32 v88, 37952
  v_mov_b32 v89, 1
  ds_write_b32 v88, v106
  s_setprio 0
  s_waitcnt vmcnt(1) lgkmcnt(0)
  s_barrier
  ds_read_b64_tr_b16 v[240:241], v80 offset:2048
  ds_read_b64_tr_b16 v[242:243], v80 offset:2304
  ds_read_b64_tr_b16 v[244:245], v80 offset:3072
  ds_read_b64_tr_b16 v[246:247], v80 offset:3328
  ds_read_b64_tr_b16 v[248:249], v80 offset:16384
  ds_read_b64_tr_b16 v[250:251], v80 offset:16640
  s_cmp_eq_u32 s80, 0
  s_cbranch_scc1 L_notask4
  s_lshl_b32 s58, s57, 12
  s_add_u32 s58, s58, 1179648
  s_setprio 1
  buffer_store_dwordx4 v[112:115], v15, s[36:39], s58 offen offset:0 sc1
  buffer_store_dwordx4 v[116:119], v15, s[36:39], s58 offen offset:1024 sc1
  buffer_store_dwordx4 v[120:123], v15, s[36:39], s58 offen offset:2048 sc1
  buffer_store_dwordx4 v[124:127], v15, s[36:39], s58 offen offset:3072 sc1
  s_nop 1
  v_mov_b32 v112, 0
  v_mov_b32 v113, 0
  v_mov_b32 v114, 0
  v_mov_b32 v115, 0
  v_mov_b32 v116, 0
  v_mov_b32 v117, 0
  v_mov_b32 v118, 0
  v_mov_b32 v119, 0
  v_mov_b32 v120, 0
  v_mov_b32 v121, 0
  v_mov_b32 v122, 0
  v_mov_b32 v123, 0
  v_mov_b32 v124, 0
  v_mov_b32 v125, 0
  v_mov_b32 v126, 0
  v_mov_b32 v127, 0
  s_setprio 0
L_notask4:
  ds_read_b64_tr_b16 v[252:253], v80 offset:17408
  ds_read_b64_tr_b16 v[254:255], v80 offset:17664
  s_waitcnt lgkmcnt(6)
  v_mfma_f32_32x32x16_bf16 v[224:239], v[240:243], v[16:19], 0
  v_mfma_f32_16x16x32_bf16 v[100:103], v[108:111], v[240:243], 0
  ds_read_b64_tr_b16 v[240:241], v80 offset:18432
  ds_read_b64_tr_b16 v[242:243], v80 offset:18688
  s_waitcnt lgkmcnt(6)
  v_mfma_f32_32x32x16_bf16 v[224:239], v[244:247], v[20:23], v[224:239]
  v_mfma_f32_16x16x32_bf16 v[100:103], v[108:111], v[244:247], v[100:103]
  ds_read_b64_tr_b16 v[244:245], v80 offset:19456
  ds_read_b64_tr_b16 v[246:247], v80 offset:19712
  s_waitcnt lgkmcnt(6)
  v_mfma_f32_32x32x16_bf16 v[224:239], v[248:251], v[24:27], v[224:239]
  v_mfma_f32_16x16x32_bf16 v[100:103], v[108:111], v[248:251], v[100:103]
  ds_read_b64_tr_b16 v[248:249], v80 offset:32768
  ds_read_b64_tr_b16 v[250:251], v80 offset:33024
  s_waitcnt lgkmcnt(6)
  v_mfma_f32_32x32x16_bf16 v[224:239], v[252:255], v[28:31], v[224:239]
  v_mfma_f32_16x16x32_bf16 v[100:103], v[108:111], v[252:255], v[100:103]
  ds_read_b64_tr_b16 v[252:253], v81 offset:2048
  ds_read_b64_tr_b16 v[254:255], v81 offset:2304
  s_waitcnt lgkmcnt(6)
  v_mfma_f32_32x32x16_bf16 v[224:239], v[240:243], v[32:35], v[224:239]
  v_mfma_f32_16x16x32_bf16 v[100:103], v[108:111], v[240:243], v[100:103]
  ds_read_b64_tr_b16 v[240:241], v82 offset:2048
  ds_read_b64_tr_b16 v[242:243], v82 offset:2304
  s_waitcnt lgkmcnt(6)
  v_mfma_f32_32x32x16_bf16 v[224:239], v[244:247], v[36:39], v[224:239]
  v_mfma_f32_16x16x32_bf16 v[100:103], v[108:111], v[244:247], v[100:103]
  ds_read_b64_tr_b16 v[244:245], v83 offset:2048
  ds_read_b64_tr_b16 v[246:247], v83 offset:2304
  s_waitcnt lgkmcnt(6)
  v_mfma_f32_32x32x16_bf16 v[224:239], v[248:251], v[40:43], v[224:239]
  v_mfma_f32_16x16x32_bf16 v[100:103], v[108:111], v[248:251], v[100:103]
  ds_read_b64_tr_b16 v[248:249], v81 offset:3072
  ds_read_b64_tr_b16 v[250:251], v81 offset:3328
  s_waitcnt lgkmcnt(6)
  v_mfma_f32_32x32x16_bf16 v[224:239], v[252:255], v[44:47], v[224:239]
  ds_read_b64_tr_b16 v[252:253], v82 offset:3072
  ds_read_b64_tr_b16 v[254:255], v82 offset:3328
  s_waitcnt lgkmcnt(6)
  v_mfma_f32_32x32x16_bf16 v[224:239], v[240:243], v[48:51], v[224:239]
  ds_read_b64_tr_b16 v[240:241], v83 offset:3072
  ds_read_b64_tr_b16 v[242:243], v83 offset:3328
  s_waitcnt lgkmcnt(6)
  v_mfma_f32_32x32x16_bf16 v[224:239], v[244:247], v[52:55], v[224:239]
  ds_write_b32 v91, v100
  s_mov_b64 exec, 1
  ds_add_u32 v88, v89
  s_mov_b64 exec, -1
  ds_read_b64_tr_b16 v[244:245], v81 offset:16384
  ds_read_b64_tr_b16 v[246:247], v81 offset:16640
  s_waitcnt lgkmcnt(8)
  v_mfma_f32_32x32x16_bf16 v[224:239], v[248:251], v[56:59], v[224:239]
  ds_read_b64_tr_b16 v[248:249], v82 offset:16384
  ds_read_b64_tr_b16 v[250:251], v82 offset:16640
  s_waitcnt lgkmcnt(8)
  v_mfma_f32_32x32x16_bf16 v[224:239], v[252:255], v[60:63], v[224:239]
  ds_read_b64_tr_b16 v[252:253], v83 offset:16384
  ds_read_b64_tr_b16 v[254:255], v83 offset:16640
  s_waitcnt lgkmcnt(8)
  v_mfma_f32_32x32x16_bf16 v[224:239], v[240:243], v[64:67], v[224:239]
  ds_read_b64_tr_b16 v[240:241], v81 offset:17408
  ds_read_b64_tr_b16 v[242:243], v81 offset:17664
  s_waitcnt lgkmcnt(6)
  v_mfma_f32_32x32x16_bf16 v[224:239], v[244:247], v[68:71], v[224:239]
  ds_read_b32 v87, v88
  ds_read_b64_tr_b16 v[244:245], v82 offset:17408
  ds_read_b64_tr_b16 v[246:247], v82 offset:17664
  s_waitcnt lgkmcnt(7)
  v_mfma_f32_32x32x16_bf16 v[224:239], v[248:251], v[72:75], v[224:239]
  ds_read_b64_tr_b16 v[248:249], v83 offset:17408
  ds_read_b64_tr_b16 v[250:251], v83 offset:17664
  s_waitcnt lgkmcnt(7)
  v_mfma_f32_32x32x16_bf16 v[224:239], v[252:255], v[76:79], v[224:239]
  ds_read_b64_tr_b16 v[252:253], v81 offset:18432
  ds_read_b64_tr_b16 v[254:255], v81 offset:18688
  s_waitcnt lgkmcnt(7)
  v_mfma_f32_32x32x16_bf16 v[224:239], v[240:243], v[176:179], v[224:239]
  s_waitcnt lgkmcnt(6)
  v_readfirstlane_b32 s58, v87
  s_nop 0
  s_cmp_lg_u32 s58, 8
  s_cbranch_scc1 L_cnt_spin
L_cnt_go:
  ds_read_b128 v[100:103], v92
  ds_read2st64_b32 v[98:99], v86 offset0:0 offset1:2
  ds_read_b64_tr_b16 v[240:241], v82 offset:18432
  ds_read_b64_tr_b16 v[242:243], v82 offset:18688
  s_waitcnt lgkmcnt(8)
  v_mfma_f32_32x32x16_bf16 v[224:239], v[244:247], v[180:183], v[224:239]
  ds_read_b64_tr_b16 v[244:245], v83 offset:18432
  ds_read_b64_tr_b16 v[246:247], v83 offset:18688
  s_waitcnt lgkmcnt(8)
  v_mfma_f32_32x32x16_bf16 v[224:239], v[248:251], v[184:187], v[224:239]
  ds_read_b64_tr_b16 v[248:249], v81 offset:19456
  ds_read_b64_tr_b16 v[250:251], v81 offset:19712
  s_waitcnt lgkmcnt(8)
  v_mfma_f32_32x32x16_bf16 v[224:239], v[252:255], v[188:191], v[224:239]
  s_waitcnt lgkmcnt(6)
  v_add_f32 v100, v100, v101
  v_add_f32 v102, v102, v103
  ds_read_b64_tr_b16 v[252:253], v82 offset:19456
  ds_read_b64_tr_b16 v[254:255], v82 offset:19712
  s_waitcnt lgkmcnt(6)
  v_mfma_f32_32x32x16_bf16 v[224:239], v[240:243], v[192:195], v[224:239]
  v_add_f32 v100, v100, v102
  ds_write_b32 v90, v100
  ds_read_b128 v[16:19], v94 offset:0
  ds_read_b128 v[20:23], v94 offset:32
  ds_read_b128 v[24:27], v94 offset:64
  ds_read_b128 v[28:31], v94 offset:96
  ds_read_b64_tr_b16 v[240:241], v83 offset:19456
  ds_read_b64_tr_b16 v[242:243], v83 offset:19712
  s_waitcnt lgkmcnt(11)
  v_mfma_f32_32x32x16_bf16 v[224:239], v[244:247], v[196:199], v[224:239]
  v_mul_f32 v98, 0x3e8b97f6, v98
  v_mul_f32 v99, 0x3e8b97f6, v99
  ds_read_b64_tr_b16 v[244:245], v81 offset:32768
  ds_read_b64_tr_b16 v[246:247], v81 offset:33024
  s_waitcnt lgkmcnt(11)
  v_mfma_f32_32x32x16_bf16 v[224:239], v[248:251], v[200:203], v[224:239]
  s_setprio 1
  ds_read_b64_tr_b16 v[248:249], v82 offset:32768
  ds_read_b64_tr_b16 v[250:251], v82 offset:33024
  s_waitcnt lgkmcnt(11)
  v_mfma_f32_32x32x16_bf16 v[224:239], v[252:255], v[204:207], v[224:239]
  ds_read_b64_tr_b16 v[252:253], v83 offset:32768
  ds_read_b64_tr_b16 v[254:255], v83 offset:33024
  s_waitcnt lgkmcnt(6)
  v_mfma_f32_32x32x16_bf16 v[224:239], v[240:243], v[208:211], v[224:239]
  s_waitcnt lgkmcnt(8)
  v_mul_f32 v16, v99, v16
  v_mul_f32 v17, v99, v17
  v_mul_f32 v18, v99, v18
  v_mul_f32 v19, v99, v19
  s_waitcnt lgkmcnt(4)
  v_mfma_f32_32x32x16_bf16 v[224:239], v[244:247], v[212:215], v[224:239]
  v_mul_f32 v20, v99, v20
  v_mul_f32 v21, v99, v21
  v_mul_f32 v22, v99, v22
  v_mul_f32 v23, v99, v23
  s_waitcnt lgkmcnt(2)
  v_mfma_f32_32x32x16_bf16 v[224:239], v[248:251], v[216:219], v[224:239]
  v_mul_f32 v24, v99, v24
  v_mul_f32 v25, v99, v25
  v_mul_f32 v26, v99, v26
  v_mul_f32 v27, v99, v27
  s_waitcnt lgkmcnt(0)
  v_mfma_f32_32x32x16_bf16 v[224:239], v[252:255], v[220:223], v[224:239]
  v_mul_f32 v28, v99, v28
  v_mul_f32 v29, v99, v29
  v_mul_f32 v30, v99, v30
  v_mul_f32 v31, v99, v31
  s_nop 7
  v_fma_f32 v224, v224, v98, -v16
  v_fma_f32 v225, v225, v98, -v17
  v_fma_f32 v226, v226, v98, -v18
  v_fma_f32 v227, v227, v98, -v19
  v_cvt_pk_bf16_f32 v100, v224, v225
  v_cvt_pk_bf16_f32 v101, v226, v227
  v_fma_f32 v228, v228, v98, -v20
  v_fma_f32 v229, v229, v98, -v21
  v_fma_f32 v230, v230, v98, -v22
  v_fma_f32 v231, v231, v98, -v23
  v_cvt_pk_bf16_f32 v102, v228, v229
  v_cvt_pk_bf16_f32 v103, v230, v231
  ds_write_b128 v93, v[100:103]
  v_fma_f32 v232, v232, v98, -v24
  v_fma_f32 v233, v233, v98, -v25
  v_fma_f32 v234, v234, v98, -v26
  v_fma_f32 v235, v235, v98, -v27
  v_cvt_pk_bf16_f32 v104, v232, v233
  v_cvt_pk_bf16_f32 v105, v234, v235
  v_fma_f32 v236, v236, v98, -v28
  v_fma_f32 v237, v237, v98, -v29
  v_fma_f32 v238, v238, v98, -v30
  v_fma_f32 v239, v239, v98, -v31
  s_mov_b32 exec_hi, 0
  v_cvt_pk_bf16_f32 v106, v236, v237
  v_cvt_pk_bf16_f32 v107, v238, v239
  s_mov_b32 exec_hi, -1
  ds_write_b128 v93, v[104:107] offset:1024
  s_waitcnt vmcnt(0)
  s_cmp_eq_u32 s80, 0
  s_cbranch_scc1 L_notask3_4
  v_mov_b32 v2, s48
  v_mov_b32 v3, 0
  s_lshl_b32 s58, s57, 4
  s_add_u32 s58, s58, 69632
  s_mov_b64 exec, 1
  buffer_store_dword v2, v3, s[36:39], s58 offen sc1
  s_mov_b64 exec, -1
L_notask3_4:
  s_mov_b64 exec, 0xffff
  buffer_load_dword v96, v85, s[36:39], 0 offen sc1
  s_mov_b64 exec, -1
  s_setprio 0
  s_cmp_lg_u32 s9, 0
  s_waitcnt lgkmcnt(0)
  s_barrier
  s_cbranch_scc1 L_attb0
  s_branch L_attb
L_wa:
  s_lshl_b32 s57, s50, 3
  s_add_u32 s57, s57, s52
  s_mov_b32 s80, 0
  s_lshl_b32 s51, s52, 1
  s_add_u32 s51, s51, s53
  s_lshl_b32 s73, s49, 10
  s_getreg_b32 s56, hwreg(HW_REG_XCC_ID, 0, 4)
  v_and_b32 v27, 31, v1
  v_lshrrev_b32 v28, 5, v1
  v_bfe_u32 v9, v27, 1, 3
  v_xor_b32 v9, v9, v28
  s_lshl_b32 s58, s54, 1
  v_xor_b32 v9, s58, v9
  v_lshlrev_b32 v9, 4, v9
  v_lshl_add_u32 v8, v27, 7, v9
  s_lshl_b32 s58, s54, 12
  v_add_u32 v8, s58, v8
  v_xor_b32 v9, 32, v8
  v_xor_b32 v10, 64, v8
  v_xor_b32 v11, 96, v8
  v_add_u32 v12, 0x10000, v8
  v_add_u32 v13, 0x10000, v9
  v_add_u32 v14, 0x10000, v10
  v_add_u32 v15, 0x10000, v11
  v_bfe_u32 v29, v1, 2, 2
  v_and_b32 v3, 3, v1
  v_bfe_u32 v30, v1, 4, 1
  v_lshlrev_b32 v30, 5, v30
  v_lshl_add_u32 v30, v3, 3, v30
  v_lshl_add_u32 v31, v28, 3, v29
  s_lshl_b32 s58, s52, 8
  s_add_u32 s58, s58, 4096
  v_lshl_add_u32 v84, v27, 3, s58
  s_lshl_b32 s58, s55, 3
  s_add_u32 s81, s58, s50
  v_and_b32 v2, 7, v1
  v_add_u32 v2, s81, v2
  v_and_b32 v2, 15, v2
  v_bfe_u32 v3, v1, 3, 1
  v_lshl_add_u32 v2, v3, 4, v2
  s_lshl_b32 s58, s52, 2
  s_add_u32 s58, s58, s54
  s_lshl_b32 s58, s58, 7
  s_add_u32 s8, s58, 36864
  v_lshl_add_u32 v85, v2, 2, s8
  v_lshrrev_b32 v2, 2, v1
  v_lshrrev_b32 v3, 4, v1
  v_xor_b32 v2, v2, v3
  v_and_b32 v2, 1, v2
  v_add_u32 v2, -1, v2
  v_and_b32 v108, 0x3f803f80, v2
  v_mov_b32 v109, v108
  v_mov_b32 v110, v108
  v_mov_b32 v111, v108
  s_add_u32 s4, s54, 1
  s_and_b32 s4, s4, 3
  s_lshl_b32 s4, s4, 11
  s_add_u32 s5, s54, 2
  s_and_b32 s5, s5, 3
  s_lshl_b32 s5, s5, 11
  s_add_u32 s6, s54, 3
  s_and_b32 s6, s6, 3
  s_lshl_b32 s6, s6, 11
  s_add_u32 s7, s54, 4
  s_and_b32 s7, s7, 3
  s_lshl_b32 s7, s7, 11
  s_lshl_b32 s72, s55, 16
  s_lshl_b32 s83, s49, 2
  s_mul_i32 s58, s55, s54
  s_sub_u32 s3, s83, s58
  s_lshl_b32 s83, s3, 10
  s_add_u32 s83, s83, 1179648
  s_mul_i32 s58, s50, 147
  s_lshr_b32 s58, s58, 10
  s_mul_i32 s58, s58, 7
  s_sub_u32 s58, s50, s58
  s_cmp_eq_u32 s58, s52
  s_cselect_b32 s9, 0, 2
  s_mul_i32 s9, s9, s53
  s_cmp_lt_u32 s91, 28
  s_cselect_b32 s58, 1, 2
  s_cmp_eq_u32 s52, 7
  s_cselect_b32 s9, s58, s9
  s_mul_i32 s58, s53, 7
  s_or_b32 s2, s57, s58
  s_lshl_b32 s58, s51, 6
  s_add_u32 s58, s58, s54
  s_lshl_b32 s58, s58, 12
  s_add_u32 s58, s58, 6291456
  s_add_u32 s59, s81, 0
  s_and_b32 s59, s59, 15
  s_lshl_b32 s59, s59, 14
  s_add_u32 s64, s58, s59
  s_add_u32 s59, s81, 1
  s_and_b32 s59, s59, 15
  s_lshl_b32 s59, s59, 14
  s_add_u32 s65, s58, s59
  s_add_u32 s59, s81, 2
  s_and_b32 s59, s59, 15
  s_lshl_b32 s59, s59, 14
  s_add_u32 s66, s58, s59
  s_add_u32 s59, s81, 3
  s_and_b32 s59, s59, 15
  s_lshl_b32 s59, s59, 14
  s_add_u32 s67, s58, s59
  s_add_u32 s59, s81, 4
  s_and_b32 s59, s59, 15
  s_lshl_b32 s59, s59, 14
  s_add_u32 s68, s58, s59
  s_add_u32 s59, s81, 5
  s_and_b32 s59, s59, 15
  s_lshl_b32 s59, s59, 14
  s_add_u32 s69, s58, s59
  s_add_u32 s59, s81, 6
  s_and_b32 s59, s59, 15
  s_lshl_b32 s59, s59, 14
  s_add_u32 s70, s58, s59
  s_add_u32 s59, s81, 7
  s_and_b32 s59, s59, 15
  s_lshl_b32 s59, s59, 14
  s_add_u32 s71, s58, s59
  s_lshl_b32 s60, s53, 4
  s_add_u32 s60, s60, s50
  s_lshl_b32 s60, s60, 2
  s_add_u32 s60, s60, s8
  v_lshrrev_b32 v2, 1, v29
  v_lshlrev_b32 v2, 6, v2
  v_xor_b32 v16, v30, v2
  v_add_u32 v20, 56, v30
  v_xor_b32 v20, v20, v2
  s_lshl_b32 s58, s54, 11
  s_add_u32 s58, s58, 114688
  v_lshl_add_u32 v2, v31, 7, s58
  v_add_u32 v16, v16, v2
  v_add_u32 v20, v20, v2
  v_xor_b32 v17, 2048, v16
  v_xor_b32 v18, 4096, v16
  v_xor_b32 v19, 6144, v16
  v_xor_b32 v21, 2048, v20
  v_xor_b32 v22, 4096, v20
  v_xor_b32 v23, 6144, v20
  v_mov_b32 v24, 0
  v_mov_b32 v25, 0
  v_mov_b32 v26, 0x3f803f80
  v_mov_b32 v80, 0
  v_lshlrev_b32 v87, 4, v1
  v_add_u32 v87, 34816, v87
  s_lshl_b32 s59, s54, 2
  v_add_u32 v88, s59, v87
  s_lshl_b32 s58, s54, 7
  s_add_u32 s58, s58, 33792
  v_lshl_add_u32 v86, v27, 2, s58
  v_lshl_add_u32 v86, v28, 9, v86
  v_lshl_add_u32 v91, v28, 4, s58
  s_lshl_b32 s58, s52, 7
  s_lshl_b32 s59, s50, 2
  s_add_u32 s58, s58, s59
  s_add_u32 s58, s58, s54
  s_lshl_b32 s58, s58, 12
  s_lshl_b32 s59, s53, 11
  s_add_u32 s58, s58, s59
  s_add_u32 s62, s58, 6291456
  s_add_u32 s63, s62, 262144
  s_cmp_eq_u32 s53, 1
  s_cbranch_scc1 L_p1v
  v_and_b32 v2, 0x33, v1
  v_bfe_u32 v3, v1, 2, 1
  v_lshl_or_b32 v2, v3, 3, v2
  v_bfe_u32 v3, v1, 3, 1
  v_lshl_or_b32 v2, v3, 2, v2
  v_lshlrev_b32 v90, 4, v2
  v_mov_b32 v70, 0
  v_mov_b32 v71, 0
  v_mov_b32 v78, 0
  v_mov_b32 v79, 0
  s_lshl_b32 s58, s54, 11
  s_sub_u32 s58, s58, 114688
  v_add_u32 v92, s58, v16
  v_xor_b32 v93, 4096, v92
  v_xor_b32 v94, 8192, v92
  v_xor_b32 v95, 12288, v92
  s_lshl_b32 s58, s54, 11
  s_sub_u32 s58, s58, 114688
  v_add_u32 v28, s58, v20
  v_xor_b32 v29, 4096, v28
  v_xor_b32 v30, 8192, v28
  v_xor_b32 v31, 12288, v28
  s_lshl_b32 s58, s54, 2
  s_add_u32 s58, s58, 37888
  v_mov_b32 v81, s58
  v_mov_b32 v83, 37952
  v_mov_b32 v89, 1
  v_lshrrev_b32 v27, 5, v1
  v_add_u32 v27, -1, v27
  s_waitcnt vmcnt(0)
  ds_read_b128 v[112:115], v8 offset:0
  ds_read_b128 v[116:119], v9 offset:0
  ds_read_b128 v[120:123], v10 offset:0
  ds_read_b128 v[124:127], v11 offset:0
  s_waitcnt lgkmcnt(0)
  v_dot2c_f32_bf16 v24, v112, v26
  v_dot2c_f32_bf16 v25, v112, v112
  v_dot2c_f32_bf16 v24, v113, v26
  v_dot2c_f32_bf16 v25, v113, v113
  v_dot2c_f32_bf16 v24, v114, v26
  v_dot2c_f32_bf16 v25, v114, v114
  v_dot2c_f32_bf16 v24, v115, v26
  v_dot2c_f32_bf16 v25, v115, v115
  v_dot2c_f32_bf16 v24, v116, v26
  v_dot2c_f32_bf16 v25, v116, v116
  v_dot2c_f32_bf16 v24, v117, v26
  v_dot2c_f32_bf16 v25, v117, v117
  v_dot2c_f32_bf16 v24, v118, v26
  v_dot2c_f32_bf16 v25, v118, v118
  v_dot2c_f32_bf16 v24, v119, v26
  v_dot2c_f32_bf16 v25, v119, v119
  v_dot2c_f32_bf16 v24, v120, v26
  v_dot2c_f32_bf16 v25, v120, v120
  v_dot2c_f32_bf16 v24, v121, v26
  v_dot2c_f32_bf16 v25, v121, v121
  v_dot2c_f32_bf16 v24, v122, v26
  v_dot2c_f32_bf16 v25, v122, v122
  v_dot2c_f32_bf16 v24, v123, v26
  v_dot2c_f32_bf16 v25, v123, v123
  v_dot2c_f32_bf16 v24, v124, v26
  v_dot2c_f32_bf16 v25, v124, v124
  v_dot2c_f32_bf16 v24, v125, v26
  v_dot2c_f32_bf16 v25, v125, v125
  v_dot2c_f32_bf16 v24, v126, v26
  v_dot2c_f32_bf16 v25, v126, v126
  v_dot2c_f32_bf16 v24, v127, v26
  v_dot2c_f32_bf16 v25, v127, v127
  s_add_u32 s48, s48, 0x9e3779b9
  s_barrier
  ds_read_b64_tr_b16 v[224:225], v16 offset:0
  ds_read_b64_tr_b16 v[226:227], v16 offset:512
  ds_read_b64_tr_b16 v[228:229], v20 offset:0
  ds_read_b64_tr_b16 v[230:231], v20 offset:512
  ds_read_b64_tr_b16 v[232:233], v17 offset:0
  ds_read_b64_tr_b16 v[234:235], v17 offset:512
  ds_read_b64_tr_b16 v[236:237], v21 offset:0
  ds_read_b64_tr_b16 v[238:239], v21 offset:512
  ds_read_b64_tr_b16 v[240:241], v18 offset:0
  ds_read_b64_tr_b16 v[242:243], v18 offset:512
  ds_read_b64_tr_b16 v[244:245], v22 offset:0
  ds_read_b64_tr_b16 v[246:247], v22 offset:512
  s_waitcnt lgkmcnt(10)
  v_mfma_f32_32x32x16_bf16 v[32:47], v[224:227], v[112:115], 0
  v_mfma_f32_16x16x32_bf16 v[100:103], v[108:111], v[224:227], 0
  ds_read_b64_tr_b16 v[248:249], v19 offset:0
  ds_read_b64_tr_b16 v[250:251], v19 offset:512
  s_waitcnt lgkmcnt(10)
  v_mfma_f32_32x32x16_bf16 v[48:63], v[228:231], v[112:115], 0
  v_mfma_f32_16x16x32_bf16 v[104:107], v[108:111], v[228:231], 0
  ds_read_b64_tr_b16 v[252:253], v23 offset:0
  ds_read_b64_tr_b16 v[254:255], v23 offset:512
  s_waitcnt lgkmcnt(10)
  v_mfma_f32_32x32x16_bf16 v[32:47], v[232:235], v[116:119], v[32:47]
  s_barrier
  ds_read_b128 v[128:131], v8 offset:16384
  ds_read_b128 v[132:135], v9 offset:16384
  ds_read_b128 v[136:139], v10 offset:16384
  ds_read_b128 v[140:143], v11 offset:16384
  ds_read_b64_tr_b16 v[224:225], v16 offset:8192
  ds_read_b64_tr_b16 v[226:227], v16 offset:8704
  s_waitcnt lgkmcnt(14)
  v_mfma_f32_32x32x16_bf16 v[48:63], v[236:239], v[116:119], v[48:63]
  ds_read_b64_tr_b16 v[228:229], v20 offset:8192
  ds_read_b64_tr_b16 v[230:231], v20 offset:8704
  s_waitcnt lgkmcnt(14)
  v_mfma_f32_32x32x16_bf16 v[32:47], v[240:243], v[120:123], v[32:47]
  ds_read_b64_tr_b16 v[232:233], v17 offset:8192
  ds_read_b64_tr_b16 v[234:235], v17 offset:8704
  s_waitcnt lgkmcnt(14)
  v_mfma_f32_32x32x16_bf16 v[48:63], v[244:247], v[120:123], v[48:63]
  ds_read_b64_tr_b16 v[236:237], v21 offset:8192
  ds_read_b64_tr_b16 v[238:239], v21 offset:8704
  s_waitcnt lgkmcnt(14)
  v_mfma_f32_32x32x16_bf16 v[32:47], v[248:251], v[124:127], v[32:47]
  ds_read_b64_tr_b16 v[240:241], v18 offset:8192
  ds_read_b64_tr_b16 v[242:243], v18 offset:8704
  s_waitcnt lgkmcnt(14)
  v_mfma_f32_32x32x16_bf16 v[48:63], v[252:255], v[124:127], v[48:63]
  s_waitcnt lgkmcnt(10)
  v_dot2c_f32_bf16 v24, v128, v26
  v_dot2c_f32_bf16 v25, v128, v128
  v_dot2c_f32_bf16 v24, v129, v26
  v_dot2c_f32_bf16 v25, v129, v129
  v_dot2c_f32_bf16 v24, v130, v26
  v_dot2c_f32_bf16 v25, v130, v130
  v_dot2c_f32_bf16 v24, v131, v26
  v_dot2c_f32_bf16 v25, v131, v131
  v_dot2c_f32_bf16 v24, v132, v26
  v_dot2c_f32_bf16 v25, v132, v132
  v_dot2c_f32_bf16 v24, v133, v26
  v_dot2c_f32_bf16 v25, v133, v133
  v_dot2c_f32_bf16 v24, v134, v26
  v_dot2c_f32_bf16 v25, v134, v134
  v_dot2c_f32_bf16 v24, v135, v26
  v_dot2c_f32_bf16 v25, v135, v135
  v_dot2c_f32_bf16 v24, v136, v26
  v_dot2c_f32_bf16 v25, v136, v136
  v_dot2c_f32_bf16 v24, v137, v26
  v_dot2c_f32_bf16 v25, v137, v137
  v_dot2c_f32_bf16 v24, v138, v26
  v_dot2c_f32_bf16 v25, v138, v138
  v_dot2c_f32_bf16 v24, v139, v26
  v_dot2c_f32_bf16 v25, v139, v139
  v_dot2c_f32_bf16 v24, v140, v26
  v_dot2c_f32_bf16 v25, v140, v140
  v_dot2c_f32_bf16 v24, v141, v26
  v_dot2c_f32_bf16 v25, v141, v141
  v_dot2c_f32_bf16 v24, v142, v26
  v_dot2c_f32_bf16 v25, v142, v142
  v_dot2c_f32_bf16 v24, v143, v26
  v_dot2c_f32_bf16 v25, v143, v143
  ds_read_b64_tr_b16 v[244:245], v22 offset:8192
  ds_read_b64_tr_b16 v[246:247], v22 offset:8704
  s_waitcnt lgkmcnt(10)
  v_mfma_f32_32x32x16_bf16 v[32:47], v[224:227], v[128:131], v[32:47]
  v_mfma_f32_16x16x32_bf16 v[100:103], v[108:111], v[224:227], v[100:103]
  ds_read_b64_tr_b16 v[248:249], v19 offset:8192
  ds_read_b64_tr_b16 v[250:251], v19 offset:8704
  s_waitcnt lgkmcnt(10)
  v_mfma_f32_32x32x16_bf16 v[48:63], v[228:231], v[128:131], v[48:63]
  v_mfma_f32_16x16x32_bf16 v[104:107], v[108:111], v[228:231], v[104:107]
  ds_read_b64_tr_b16 v[252:253], v23 offset:8192
  ds_read_b64_tr_b16 v[254:255], v23 offset:8704
  s_waitcnt lgkmcnt(10)
  v_mfma_f32_32x32x16_bf16 v[32:47], v[232:235], v[132:135], v[32:47]
  s_barrier
  ds_read_b128 v[144:147], v8 offset:32768
  ds_read_b128 v[148:151], v9 offset:32768
  ds_read_b128 v[152:155], v10 offset:32768
  ds_read_b128 v[156:159], v11 offset:32768
  ds_read_b64_tr_b16 v[224:225], v16 offset:16384
  ds_read_b64_tr_b16 v[226:227], v16 offset:16896
  s_waitcnt lgkmcnt(14)
  v_mfma_f32_32x32x16_bf16 v[48:63], v[236:239], v[132:135], v[48:63]
  ds_read_b64_tr_b16 v[228:229], v20 offset:16384
  ds_read_b64_tr_b16 v[230:231], v20 offset:16896
  s_waitcnt lgkmcnt(14)
  v_mfma_f32_32x32x16_bf16 v[32:47], v[240:243], v[136:139], v[32:47]
  ds_read_b64_tr_b16 v[232:233], v17 offset:16384
  ds_read_b64_tr_b16 v[234:235], v17 offset:16896
  s_waitcnt lgkmcnt(14)
  v_mfma_f32_32x32x16_bf16 v[48:63], v[244:247], v[136:139], v[48:63]
  ds_read_b64_tr_b16 v[236:237], v21 offset:16384
  ds_read_b64_tr_b16 v[238:239], v21 offset:16896
  s_waitcnt lgkmcnt(14)
  v_mfma_f32_32x32x16_bf16 v[32:47], v[248:251], v[140:143], v[32:47]
  ds_read_b64_tr_b16 v[240:241], v18 offset:16384
  ds_read_b64_tr_b16 v[242:243], v18 offset:16896
  s_waitcnt lgkmcnt(14)
  v_mfma_f32_32x32x16_bf16 v[48:63], v[252:255], v[140:143], v[48:63]
  s_waitcnt lgkmcnt(10)
  v_dot2c_f32_bf16 v24, v144, v26
  v_dot2c_f32_bf16 v25, v144, v144
  v_dot2c_f32_bf16 v24, v145, v26
  v_dot2c_f32_bf16 v25, v145, v145
  v_dot2c_f32_bf16 v24, v146, v26
  v_dot2c_f32_bf16 v25, v146, v146
  v_dot2c_f32_bf16 v24, v147, v26
  v_dot2c_f32_bf16 v25, v147, v147
  v_dot2c_f32_bf16 v24, v148, v26
  v_dot2c_f32_bf16 v25, v148, v148
  v_dot2c_f32_bf16 v24, v149, v26
  v_dot2c_f32_bf16 v25, v149, v149
  v_dot2c_f32_bf16 v24, v150, v26
  v_dot2c_f32_bf16 v25, v150, v150
  v_dot2c_f32_bf16 v24, v151, v26
  v_dot2c_f32_bf16 v25, v151, v151
  v_dot2c_f32_bf16 v24, v152, v26
  v_dot2c_f32_bf16 v25, v152, v152
  v_dot2c_f32_bf16 v24, v153, v26
  v_dot2c_f32_bf16 v25, v153, v153
  v_dot2c_f32_bf16 v24, v154, v26
  v_dot2c_f32_bf16 v25, v154, v154
  v_dot2c_f32_bf16 v24, v155, v26
  v_dot2c_f32_bf16 v25, v155, v155
  v_dot2c_f32_bf16 v24, v156, v26
  v_dot2c_f32_bf16 v25, v156, v156
  v_dot2c_f32_bf16 v24, v157, v26
  v_dot2c_f32_bf16 v25, v157, v157
  v_dot2c_f32_bf16 v24, v158, v26
  v_dot2c_f32_bf16 v25, v158, v158
  v_dot2c_f32_bf16 v24, v159, v26
  v_dot2c_f32_bf16 v25, v159, v159
  ds_read_b64_tr_b16 v[244:245], v22 offset:16384
  ds_read_b64_tr_b16 v[246:247], v22 offset:16896
  s_waitcnt lgkmcnt(10)
  v_mfma_f32_32x32x16_bf16 v[32:47], v[224:227], v[144:147], v[32:47]
  v_mfma_f32_16x16x32_bf16 v[100:103], v[108:111], v[224:227], v[100:103]
  ds_read_b64_tr_b16 v[248:249], v19 offset:16384
  ds_read_b64_tr_b16 v[250:251], v19 offset:16896
  s_waitcnt lgkmcnt(10)
  v_mfma_f32_32x32x16_bf16 v[48:63], v[228:231], v[144:147], v[48:63]
  v_mfma_f32_16x16x32_bf16 v[104:107], v[108:111], v[228:231], v[104:107]
  ds_read_b64_tr_b16 v[252:253], v23 offset:16384
  ds_read_b64_tr_b16 v[254:255], v23 offset:16896
  s_waitcnt lgkmcnt(10)
  v_mfma_f32_32x32x16_bf16 v[32:47], v[232:235], v[148:151], v[32:47]
  v_mov_b32 v129, 0
  v_mov_b32 v130, 0
  s_barrier
  ds_read_b128 v[160:163], v8 offset:49152
  ds_read_b128 v[164:167], v9 offset:49152
  ds_read_b128 v[168:171], v10 offset:49152
  ds_read_b128 v[172:175], v11 offset:49152
  ds_read_b64_tr_b16 v[224:225], v16 offset:24576
  ds_read_b64_tr_b16 v[226:227], v16 offset:25088
  s_waitcnt lgkmcnt(14)
  v_mfma_f32_32x32x16_bf16 v[48:63], v[236:239], v[148:151], v[48:63]
  v_mov_b32 v131, 0
  v_mov_b32 v133, 0
  ds_read_b64_tr_b16 v[228:229], v20 offset:24576
  ds_read_b64_tr_b16 v[230:231], v20 offset:25088
  s_waitcnt lgkmcnt(14)
  v_mfma_f32_32x32x16_bf16 v[32:47], v[240:243], v[152:155], v[32:47]
  v_mov_b32 v134, 0
  v_mov_b32 v135, 0
  ds_read_b64_tr_b16 v[232:233], v17 offset:24576
  ds_read_b64_tr_b16 v[234:235], v17 offset:25088
  s_waitcnt lgkmcnt(14)
  v_mfma_f32_32x32x16_bf16 v[48:63], v[244:247], v[152:155], v[48:63]
  v_mov_b32 v137, 0
  v_mov_b32 v138, 0
  ds_read_b64_tr_b16 v[236:237], v21 offset:24576
  ds_read_b64_tr_b16 v[238:239], v21 offset:25088
  s_waitcnt lgkmcnt(14)
  v_mfma_f32_32x32x16_bf16 v[32:47], v[248:251], v[156:159], v[32:47]
  v_mov_b32 v139, 0
  ds_read_b64_tr_b16 v[240:241], v18 offset:24576
  ds_read_b64_tr_b16 v[242:243], v18 offset:25088
  s_waitcnt lgkmcnt(14)
  v_mfma_f32_32x32x16_bf16 v[48:63], v[252:255], v[156:159], v[48:63]
  s_waitcnt lgkmcnt(10)
  v_dot2c_f32_bf16 v24, v160, v26
  v_dot2c_f32_bf16 v25, v160, v160
  v_dot2c_f32_bf16 v24, v161, v26
  v_dot2c_f32_bf16 v25, v161, v161
  v_dot2c_f32_bf16 v24, v162, v26
  v_dot2c_f32_bf16 v25, v162, v162
  v_dot2c_f32_bf16 v24, v163, v26
  v_dot2c_f32_bf16 v25, v163, v163
  v_dot2c_f32_bf16 v24, v164, v26
  v_dot2c_f32_bf16 v25, v164, v164
  v_dot2c_f32_bf16 v24, v165, v26
  v_dot2c_f32_bf16 v25, v165, v165
  v_dot2c_f32_bf16 v24, v166, v26
  v_dot2c_f32_bf16 v25, v166, v166
  v_dot2c_f32_bf16 v24, v167, v26
  v_dot2c_f32_bf16 v25, v167, v167
  v_dot2c_f32_bf16 v24, v168, v26
  v_dot2c_f32_bf16 v25, v168, v168
  v_dot2c_f32_bf16 v24, v169, v26
  v_dot2c_f32_bf16 v25, v169, v169
  v_dot2c_f32_bf16 v24, v170, v26
  v_dot2c_f32_bf16 v25, v170, v170
  v_dot2c_f32_bf16 v24, v171, v26
  v_dot2c_f32_bf16 v25, v171, v171
  v_dot2c_f32_bf16 v24, v172, v26
  v_dot2c_f32_bf16 v25, v172, v172
  v_dot2c_f32_bf16 v24, v173, v26
  v_dot2c_f32_bf16 v25, v173, v173
  v_dot2c_f32_bf16 v24, v174, v26
  v_dot2c_f32_bf16 v25, v174, v174
  v_dot2c_f32_bf16 v24, v175, v26
  v_dot2c_f32_bf16 v25, v175, v175
  ds_read_b64_tr_b16 v[244:245], v22 offset:24576
  ds_read_b64_tr_b16 v[246:247], v22 offset:25088
  s_waitcnt lgkmcnt(10)
  v_mfma_f32_32x32x16_bf16 v[32:47], v[224:227], v[160:163], v[32:47]
  v_mfma_f32_16x16x32_bf16 v[100:103], v[108:111], v[224:227], v[100:103]
  ds_read_b64_tr_b16 v[248:249], v19 offset:24576
  ds_read_b64_tr_b16 v[250:251], v19 offset:25088
  s_waitcnt lgkmcnt(10)
  v_mfma_f32_32x32x16_bf16 v[48:63], v[228:231], v[160:163], v[48:63]
  v_mfma_f32_16x16x32_bf16 v[104:107], v[108:111], v[228:231], v[104:107]
  ds_read_b64_tr_b16 v[252:253], v23 offset:24576
  ds_read_b64_tr_b16 v[254:255], v23 offset:25088
  s_waitcnt lgkmcnt(10)
  v_mfma_f32_32x32x16_bf16 v[32:47], v[232:235], v[164:167], v[32:47]
  s_barrier
  ds_read_b128 v[176:179], v12 offset:0
  ds_read_b128 v[180:183], v13 offset:0
  ds_read_b128 v[184:187], v14 offset:0
  ds_read_b128 v[188:191], v15 offset:0
  ds_read_b64_tr_b16 v[224:225], v16 offset:32768
  ds_read_b64_tr_b16 v[226:227], v16 offset:33280
  s_waitcnt lgkmcnt(14)
  v_mfma_f32_32x32x16_bf16 v[48:63], v[236:239], v[164:167], v[48:63]
  ds_read_b64_tr_b16 v[228:229], v20 offset:32768
  ds_read_b64_tr_b16 v[230:231], v20 offset:33280
  s_waitcnt lgkmcnt(14)
  v_mfma_f32_32x32x16_bf16 v[32:47], v[240:243], v[168:171], v[32:47]
  ds_read_b64_tr_b16 v[232:233], v17 offset:32768
  ds_read_b64_tr_b16 v[234:235], v17 offset:33280
  s_waitcnt lgkmcnt(14)
  v_mfma_f32_32x32x16_bf16 v[48:63], v[244:247], v[168:171], v[48:63]
  ds_read_b64_tr_b16 v[236:237], v21 offset:32768
  ds_read_b64_tr_b16 v[238:239], v21 offset:33280
  s_waitcnt lgkmcnt(14)
  v_mfma_f32_32x32x16_bf16 v[32:47], v[248:251], v[172:175], v[32:47]
  ds_read_b64_tr_b16 v[240:241], v18 offset:32768
  ds_read_b64_tr_b16 v[242:243], v18 offset:33280
  s_waitcnt lgkmcnt(14)
  v_mfma_f32_32x32x16_bf16 v[48:63], v[252:255], v[172:175], v[48:63]
  s_waitcnt lgkmcnt(10)
  v_dot2c_f32_bf16 v24, v176, v26
  v_dot2c_f32_bf16 v25, v176, v176
  v_dot2c_f32_bf16 v24, v177, v26
  v_dot2c_f32_bf16 v25, v177, v177
  v_dot2c_f32_bf16 v24, v178, v26
  v_dot2c_f32_bf16 v25, v178, v178
  v_dot2c_f32_bf16 v24, v179, v26
  v_dot2c_f32_bf16 v25, v179, v179
  v_dot2c_f32_bf16 v24, v180, v26
  v_dot2c_f32_bf16 v25, v180, v180
  v_dot2c_f32_bf16 v24, v181, v26
  v_dot2c_f32_bf16 v25, v181, v181
  v_dot2c_f32_bf16 v24, v182, v26
  v_dot2c_f32_bf16 v25, v182, v182
  v_dot2c_f32_bf16 v24, v183, v26
  v_dot2c_f32_bf16 v25, v183, v183
  v_dot2c_f32_bf16 v24, v184, v26
  v_dot2c_f32_bf16 v25, v184, v184
  v_dot2c_f32_bf16 v24, v185, v26
  v_dot2c_f32_bf16 v25, v185, v185
  v_dot2c_f32_bf16 v24, v186, v26
  v_dot2c_f32_bf16 v25, v186, v186
  v_dot2c_f32_bf16 v24, v187, v26
  v_dot2c_f32_bf16 v25, v187, v187
  v_dot2c_f32_bf16 v24, v188, v26
  v_dot2c_f32_bf16 v25, v188, v188
  v_dot2c_f32_bf16 v24, v189, v26
  v_dot2c_f32_bf16 v25, v189, v189
  v_dot2c_f32_bf16 v24, v190, v26
  v_dot2c_f32_bf16 v25, v190, v190
  v_dot2c_f32_bf16 v24, v191, v26
  v_dot2c_f32_bf16 v25, v191, v191
  ds_read_b64_tr_b16 v[244:245], v22 offset:32768
  ds_read_b64_tr_b16 v[246:247], v22 offset:33280
  s_waitcnt lgkmcnt(10)
  v_mfma_f32_32x32x16_bf16 v[32:47], v[224:227], v[176:179], v[32:47]
  v_mfma_f32_16x16x32_bf16 v[100:103], v[108:111], v[224:227], v[100:103]
  ds_read_b64_tr_b16 v[248:249], v19 offset:32768
  ds_read_b64_tr_b16 v[250:251], v19 offset:33280
  s_waitcnt lgkmcnt(10)
  v_mfma_f32_32x32x16_bf16 v[48:63], v[228:231], v[176:179], v[48:63]
  v_mfma_f32_16x16x32_bf16 v[104:107], v[108:111], v[228:231], v[104:107]
  ds_read_b64_tr_b16 v[252:253], v23 offset:32768
  ds_read_b64_tr_b16 v[254:255], v23 offset:33280
  s_waitcnt lgkmcnt(10)
  v_mfma_f32_32x32x16_bf16 v[32:47], v[232:235], v[180:183], v[32:47]
  s_barrier
  ds_read_b128 v[192:195], v12 offset:16384
  ds_read_b128 v[196:199], v13 offset:16384
  ds_read_b128 v[200:203], v14 offset:16384
  ds_read_b128 v[204:207], v15 offset:16384
  ds_read_b64_tr_b16 v[224:225], v16 offset:40960
  ds_read_b64_tr_b16 v[226:227], v16 offset:41472
  s_waitcnt lgkmcnt(14)
  v_mfma_f32_32x32x16_bf16 v[48:63], v[236:239], v[180:183], v[48:63]
  ds_read_b64_tr_b16 v[228:229], v20 offset:40960
  ds_read_b64_tr_b16 v[230:231], v20 offset:41472
  s_waitcnt lgkmcnt(14)
  v_mfma_f32_32x32x16_bf16 v[32:47], v[240:243], v[184:187], v[32:47]
  ds_read_b64_tr_b16 v[232:233], v17 offset:40960
  ds_read_b64_tr_b16 v[234:235], v17 offset:41472
  s_waitcnt lgkmcnt(14)
  v_mfma_f32_32x32x16_bf16 v[48:63], v[244:247], v[184:187], v[48:63]
  ds_read_b64_tr_b16 v[236:237], v21 offset:40960
  ds_read_b64_tr_b16 v[238:239], v21 offset:41472
  s_waitcnt lgkmcnt(14)
  v_mfma_f32_32x32x16_bf16 v[32:47], v[248:251], v[188:191], v[32:47]
  ds_read_b64_tr_b16 v[240:241], v18 offset:40960
  ds_read_b64_tr_b16 v[242:243], v18 offset:41472
  s_waitcnt lgkmcnt(14)
  v_mfma_f32_32x32x16_bf16 v[48:63], v[252:255], v[188:191], v[48:63]
  s_waitcnt lgkmcnt(10)
  v_dot2c_f32_bf16 v24, v192, v26
  v_dot2c_f32_bf16 v25, v192, v192
  v_dot2c_f32_bf16 v24, v193, v26
  v_dot2c_f32_bf16 v25, v193, v193
  v_dot2c_f32_bf16 v24, v194, v26
  v_dot2c_f32_bf16 v25, v194, v194
  v_dot2c_f32_bf16 v24, v195, v26
  v_dot2c_f32_bf16 v25, v195, v195
  v_dot2c_f32_bf16 v24, v196, v26
  v_dot2c_f32_bf16 v25, v196, v196
  v_dot2c_f32_bf16 v24, v197, v26
  v_dot2c_f32_bf16 v25, v197, v197
  v_dot2c_f32_bf16 v24, v198, v26
  v_dot2c_f32_bf16 v25, v198, v198
  v_dot2c_f32_bf16 v24, v199, v26
  v_dot2c_f32_bf16 v25, v199, v199
  v_dot2c_f32_bf16 v24, v200, v26
  v_dot2c_f32_bf16 v25, v200, v200
  v_dot2c_f32_bf16 v24, v201, v26
  v_dot2c_f32_bf16 v25, v201, v201
  v_dot2c_f32_bf16 v24, v202, v26
  v_dot2c_f32_bf16 v25, v202, v202
  v_dot2c_f32_bf16 v24, v203, v26
  v_dot2c_f32_bf16 v25, v203, v203
  v_dot2c_f32_bf16 v24, v204, v26
  v_dot2c_f32_bf16 v25, v204, v204
  v_dot2c_f32_bf16 v24, v205, v26
  v_dot2c_f32_bf16 v25, v205, v205
  v_dot2c_f32_bf16 v24, v206, v26
  v_dot2c_f32_bf16 v25, v206, v206
  v_dot2c_f32_bf16 v24, v207, v26
  v_dot2c_f32_bf16 v25, v207, v207
  ds_read_b64_tr_b16 v[244:245], v22 offset:40960
  ds_read_b64_tr_b16 v[246:247], v22 offset:41472
  s_waitcnt lgkmcnt(10)
  v_mfma_f32_32x32x16_bf16 v[32:47], v[224:227], v[192:195], v[32:47]
  v_mfma_f32_16x16x32_bf16 v[100:103], v[108:111], v[224:227], v[100:103]
  ds_read_b64_tr_b16 v[248:249], v19 offset:40960
  ds_read_b64_tr_b16 v[250:251], v19 offset:41472
  s_waitcnt lgkmcnt(10)
  v_mfma_f32_32x32x16_bf16 v[48:63], v[228:231], v[192:195], v[48:63]
  v_mfma_f32_16x16x32_bf16 v[104:107], v[108:111], v[228:231], v[104:107]
  ds_read_b64_tr_b16 v[252:253], v23 offset:40960
  ds_read_b64_tr_b16 v[254:255], v23 offset:41472
  s_waitcnt lgkmcnt(10)
  v_mfma_f32_32x32x16_bf16 v[32:47], v[232:235], v[196:199], v[32:47]
  s_barrier
  ds_read_b128 v[208:211], v12 offset:32768
  ds_read_b128 v[212:215], v13 offset:32768
  ds_read_b128 v[216:219], v14 offset:32768
  ds_read_b128 v[220:223], v15 offset:32768
  ds_read_b64_tr_b16 v[224:225], v92 offset:0
  ds_read_b64_tr_b16 v[226:227], v92 offset:512
  s_waitcnt lgkmcnt(14)
  v_mfma_f32_32x32x16_bf16 v[48:63], v[236:239], v[196:199], v[48:63]
  ds_read_b64_tr_b16 v[228:229], v28 offset:0
  ds_read_b64_tr_b16 v[230:231], v28 offset:512
  s_waitcnt lgkmcnt(14)
  v_mfma_f32_32x32x16_bf16 v[32:47], v[240:243], v[200:203], v[32:47]
  ds_read_b64_tr_b16 v[232:233], v93 offset:0
  ds_read_b64_tr_b16 v[234:235], v93 offset:512
  s_waitcnt lgkmcnt(14)
  v_mfma_f32_32x32x16_bf16 v[48:63], v[244:247], v[200:203], v[48:63]
  ds_read_b64_tr_b16 v[236:237], v94 offset:0
  ds_read_b64_tr_b16 v[238:239], v94 offset:512
  s_waitcnt lgkmcnt(14)
  v_mfma_f32_32x32x16_bf16 v[32:47], v[248:251], v[204:207], v[32:47]
  ds_read_b64_tr_b16 v[240:241], v95 offset:0
  ds_read_b64_tr_b16 v[242:243], v95 offset:512
  s_waitcnt lgkmcnt(14)
  v_mfma_f32_32x32x16_bf16 v[48:63], v[252:255], v[204:207], v[48:63]
  s_waitcnt lgkmcnt(6)
  v_mfma_f32_16x16x32_bf16 v[100:103], v[108:111], v[224:227], v[100:103]
  v_mfma_f32_16x16x32_bf16 v[104:107], v[108:111], v[228:231], v[104:107]
  s_waitcnt lgkmcnt(10)
  v_dot2c_f32_bf16 v24, v208, v26
  v_dot2c_f32_bf16 v25, v208, v208
  v_dot2c_f32_bf16 v24, v209, v26
  v_dot2c_f32_bf16 v25, v209, v209
  v_dot2c_f32_bf16 v24, v210, v26
  v_dot2c_f32_bf16 v25, v210, v210
  v_dot2c_f32_bf16 v24, v211, v26
  v_dot2c_f32_bf16 v25, v211, v211
  v_dot2c_f32_bf16 v24, v212, v26
  v_dot2c_f32_bf16 v25, v212, v212
  v_dot2c_f32_bf16 v24, v213, v26
  v_dot2c_f32_bf16 v25, v213, v213
  v_dot2c_f32_bf16 v24, v214, v26
  v_dot2c_f32_bf16 v25, v214, v214
  v_dot2c_f32_bf16 v24, v215, v26
  v_dot2c_f32_bf16 v25, v215, v215
  v_dot2c_f32_bf16 v24, v216, v26
  v_dot2c_f32_bf16 v25, v216, v216
  v_dot2c_f32_bf16 v24, v217, v26
  v_dot2c_f32_bf16 v25, v217, v217
  v_dot2c_f32_bf16 v24, v218, v26
  v_dot2c_f32_bf16 v25, v218, v218
  v_dot2c_f32_bf16 v24, v219, v26
  v_dot2c_f32_bf16 v25, v219, v219
  v_dot2c_f32_bf16 v24, v220, v26
  v_dot2c_f32_bf16 v25, v220, v220
  v_dot2c_f32_bf16 v24, v221, v26
  v_dot2c_f32_bf16 v25, v221, v221
  v_dot2c_f32_bf16 v24, v222, v26
  v_dot2c_f32_bf16 v25, v222, v222
  v_dot2c_f32_bf16 v24, v223, v26
  v_dot2c_f32_bf16 v25, v223, v223
  s_mov_b32 exec_lo, 0
  v_mov_b32 v100, v104
  s_mov_b32 exec_lo, -1
  ds_write_b32 v88, v100
  ds_read_b64_tr_b16 v[244:245], v29 offset:0
  ds_read_b64_tr_b16 v[246:247], v29 offset:512
  s_waitcnt lgkmcnt(11)
  v_mfma_f32_32x32x16_bf16 v[32:47], v[224:227], v[208:211], v[32:47]
  s_waitcnt lgkmcnt(2)
  s_barrier
  ds_read_b128 v[100:103], v87
  ds_read_b32 v96, v81
  v_mov_b32 v2, v24
  v_mov_b32 v3, v25
  s_nop 0
  v_permlane32_swap_b32 v2, v24
  ds_read_b64_tr_b16 v[248:249], v30 offset:0
  ds_read_b64_tr_b16 v[250:251], v30 offset:512
  s_waitcnt lgkmcnt(13)
  v_mfma_f32_32x32x16_bf16 v[48:63], v[228:231], v[208:211], v[48:63]
  v_permlane32_swap_b32 v3, v25
  v_add_f32 v24, v24, v2
  v_add_f32 v25, v25, v3
  v_mul_f32 v98, 0x3b124925, v24
  ds_read_b64_tr_b16 v[252:253], v31 offset:0
  ds_read_b64_tr_b16 v[254:255], v31 offset:512
  s_waitcnt lgkmcnt(13)
  v_mfma_f32_32x32x16_bf16 v[32:47], v[232:235], v[212:215], v[32:47]
  v_mul_f32 v2, 0x3b124925, v25
  v_cvt_pk_bf16_f32 v3, -v98, -v98
  v_fma_f32 v2, -v98, v98, v2
  v_max_f32 v2, 0, v2
  v_and_b32 v132, v27, v3
  s_waitcnt lgkmcnt(11)
  v_mfma_f32_32x32x16_bf16 v[32:47], v[236:239], v[216:219], v[32:47]
  v_cvt_pk_bf16_f32 v2, v2, v2
  v_bfi_b32 v136, v27, v80, v3
  v_lshlrev_b32 v2, 16, v2
  s_waitcnt lgkmcnt(4)
  v_add_f32 v2, 0x3727c5ac, v2
  s_waitcnt lgkmcnt(9)
  v_mfma_f32_32x32x16_bf16 v[32:47], v[240:243], v[220:223], v[32:47]
  v_add_f32 v100, v100, v101
  v_cvt_pk_bf16_f32 v2, v2, v2
  v_add_f32 v102, v102, v103
  v_lshlrev_b32 v2, 16, v2
  v_add_f32 v100, v100, v102
  s_waitcnt lgkmcnt(6)
  v_mfma_f32_32x32x16_bf16 v[48:63], v[244:247], v[212:215], v[48:63]
  v_sqrt_f32 v2, v2
  v_cvt_pk_bf16_f32 v101, v100, v100
  v_and_b32 v98, 0xffff0000, v3
  v_lshlrev_b32 v101, 16, v101
  v_cvt_pk_bf16_f32 v2, v2, v2
  s_waitcnt lgkmcnt(2)
  v_mfma_f32_32x32x16_bf16 v[48:63], v[248:251], v[216:219], v[48:63]
  v_sub_f32 v100, v100, v101
  v_lshlrev_b32 v2, 16, v2
  v_cvt_pk_bf16_f32 v128, v101, v100
  v_rcp_f32 v99, v2
  v_readfirstlane_b32 s74, v96
  s_waitcnt lgkmcnt(0)
  v_mfma_f32_32x32x16_bf16 v[48:63], v[252:255], v[220:223], v[48:63]
  s_nop 0
  s_nop 0
  v_mfma_f32_32x32x16_bf16 v[32:47], v[128:131], v[132:135], v[32:47]
  v_mul_f32 v82, -v98, v99
  v_mfma_f32_32x32x16_bf16 v[48:63], v[128:131], v[136:139], v[48:63]
  v_bfi_b32 v82, v27, v99, v82
  ds_write_b32 v86, v82
  s_mov_b64 exec, 1
  ds_add_u32 v83, v89
  s_mov_b64 exec, -1
  v_mov_b32 v144, 0
  v_mov_b32 v145, 0
  v_mov_b32 v146, 0
  v_mov_b32 v147, 0
  v_mov_b32 v148, 0
  v_mul_f32 v32, v32, v99
  v_mul_f32 v33, v33, v99
  v_mul_f32 v34, v34, v99
  v_mul_f32 v35, v35, v99
  v_cvt_pk_bf16_f32 v64, v32, v33
  v_cvt_pk_bf16_f32 v65, v34, v35
  v_mul_f32 v36, v36, v99
  v_mul_f32 v37, v37, v99
  v_mul_f32 v38, v38, v99
  v_mul_f32 v39, v39, v99
  v_cvt_pk_bf16_f32 v66, v36, v37
  v_cvt_pk_bf16_f32 v67, v38, v39
  v_mul_f32 v40, v40, v99
  v_mul_f32 v41, v41, v99
  v_mul_f32 v42, v42, v99
  v_mul_f32 v43, v43, v99
  v_cvt_pk_bf16_f32 v68, v40, v41
  v_cvt_pk_bf16_f32 v69, v42, v43
  v_mul_f32 v44, v44, v99
  v_mul_f32 v45, v45, v99
  v_mul_f32 v46, v46, v99
  v_mul_f32 v47, v47, v99
  s_mov_b32 exec_hi, 0
  v_cvt_pk_bf16_f32 v70, v44, v45
  v_cvt_pk_bf16_f32 v71, v46, v47
  s_mov_b64 exec, -1
  s_cmp_eq_u32 s74, 0
  s_cbranch_scc1 L_sts_5
  buffer_store_dwordx4 v[64:67], v90, s[36:39], s62 offen offset:0
  buffer_store_dwordx4 v[68:71], v90, s[36:39], s62 offen offset:1024
L_std_6:
  v_mul_f32 v48, v48, v99
  v_mul_f32 v49, v49, v99
  v_mul_f32 v50, v50, v99
  v_mul_f32 v51, v51, v99
  v_cvt_pk_bf16_f32 v72, v48, v49
  v_cvt_pk_bf16_f32 v73, v50, v51
  v_mul_f32 v52, v52, v99
  v_mul_f32 v53, v53, v99
  v_mul_f32 v54, v54, v99
  v_mul_f32 v55, v55, v99
  v_cvt_pk_bf16_f32 v74, v52, v53
  v_cvt_pk_bf16_f32 v75, v54, v55
  v_mul_f32 v56, v56, v99
  v_mul_f32 v57, v57, v99
  v_mul_f32 v58, v58, v99
  v_mul_f32 v59, v59, v99
  v_cvt_pk_bf16_f32 v76, v56, v57
  v_cvt_pk_bf16_f32 v77, v58, v59
  v_mul_f32 v60, v60, v99
  v_mul_f32 v61, v61, v99
  v_mul_f32 v62, v62, v99
  v_mul_f32 v63, v63, v99
  s_mov_b32 exec_hi, 0
  v_cvt_pk_bf16_f32 v78, v60, v61
  v_cvt_pk_bf16_f32 v79, v62, v63
  s_mov_b64 exec, -1
  s_cmp_eq_u32 s74, 0
  s_cbranch_scc1 L_sts_7
  buffer_store_dwordx4 v[72:75], v90, s[36:39], s63 offen offset:0
  buffer_store_dwordx4 v[76:79], v90, s[36:39], s63 offen offset:1024
L_std_8:
  s_branch L_p1j
L_p1v:
  v_lshlrev_b32 v90, 4, v1
  v_cmp_eq_u32 vcc, 28, v27
  s_mov_b32 s81, 0x0fffffff
  s_nop 0
  v_cndmask_b32 v64, v80, v26, vcc
  v_mov_b32 v65, v64
  v_mov_b32 v66, v64
  v_mov_b32 v67, v64
  v_mov_b32 v68, v64
  v_mov_b32 v69, v64
  v_mov_b32 v70, v64
  v_mov_b32 v71, v64
  v_mov_b32 v72, v64
  v_mov_b32 v73, v64
  v_mov_b32 v74, v64
  v_mov_b32 v75, v64
  v_mov_b32 v76, v64
  v_mov_b32 v77, v64
  v_mov_b32 v78, v64
  v_mov_b32 v79, v64
  s_lshl_b32 s58, s54, 11
  s_sub_u32 s58, s58, 114688
  v_add_u32 v92, s58, v16
  v_xor_b32 v93, 4096, v92
  v_xor_b32 v94, 8192, v92
  v_xor_b32 v95, 12288, v92
  s_lshl_b32 s58, s54, 11
  s_sub_u32 s58, s58, 114688
  v_add_u32 v28, s58, v20
  v_xor_b32 v29, 4096, v28
  v_xor_b32 v30, 8192, v28
  v_xor_b32 v31, 12288, v28
  s_lshl_b32 s58, s54, 2
  s_add_u32 s58, s58, 37888
  v_mov_b32 v81, s58
  v_mov_b32 v83, 37952
  v_mov_b32 v89, 1
  v_lshrrev_b32 v27, 5, v1
  v_add_u32 v27, -1, v27
  s_waitcnt vmcnt(0)
  ds_read_b128 v[112:115], v8 offset:0
  ds_read_b128 v[116:119], v9 offset:0
  ds_read_b128 v[120:123], v10 offset:0
  ds_read_b128 v[124:127], v11 offset:0
  s_waitcnt lgkmcnt(0)
  v_dot2c_f32_bf16 v24, v112, v26
  v_dot2c_f32_bf16 v25, v112, v112
  v_dot2c_f32_bf16 v24, v113, v26
  v_dot2c_f32_bf16 v25, v113, v113
  v_dot2c_f32_bf16 v24, v114, v26
  v_dot2c_f32_bf16 v25, v114, v114
  v_dot2c_f32_bf16 v24, v115, v26
  v_dot2c_f32_bf16 v25, v115, v115
  v_dot2c_f32_bf16 v24, v116, v26
  v_dot2c_f32_bf16 v25, v116, v116
  v_dot2c_f32_bf16 v24, v117, v26
  v_dot2c_f32_bf16 v25, v117, v117
  v_dot2c_f32_bf16 v24, v118, v26
  v_dot2c_f32_bf16 v25, v118, v118
  v_dot2c_f32_bf16 v24, v119, v26
  v_dot2c_f32_bf16 v25, v119, v119
  v_dot2c_f32_bf16 v24, v120, v26
  v_dot2c_f32_bf16 v25, v120, v120
  v_dot2c_f32_bf16 v24, v121, v26
  v_dot2c_f32_bf16 v25, v121, v121
  v_dot2c_f32_bf16 v24, v122, v26
  v_dot2c_f32_bf16 v25, v122, v122
  v_dot2c_f32_bf16 v24, v123, v26
  v_dot2c_f32_bf16 v25, v123, v123
  v_dot2c_f32_bf16 v24, v124, v26
  v_dot2c_f32_bf16 v25, v124, v124
  v_dot2c_f32_bf16 v24, v125, v26
  v_dot2c_f32_bf16 v25, v125, v125
  v_dot2c_f32_bf16 v24, v126, v26
  v_dot2c_f32_bf16 v25, v126, v126
  v_dot2c_f32_bf16 v24, v127, v26
  v_dot2c_f32_bf16 v25, v127, v127
  s_add_u32 s48, s48, 0x9e3779b9
  s_barrier
  ds_read_b64_tr_b16 v[224:225], v16 offset:0
  ds_read_b64_tr_b16 v[226:227], v16 offset:512
  ds_read_b64_tr_b16 v[228:229], v20 offset:0
  ds_read_b64_tr_b16 v[230:231], v20 offset:512
  ds_read_b64_tr_b16 v[232:233], v17 offset:0
  ds_read_b64_tr_b16 v[234:235], v17 offset:512
  ds_read_b64_tr_b16 v[236:237], v21 offset:0
  ds_read_b64_tr_b16 v[238:239], v21 offset:512
  ds_read_b64_tr_b16 v[240:241], v18 offset:0
  ds_read_b64_tr_b16 v[242:243], v18 offset:512
  ds_read_b64_tr_b16 v[244:245], v22 offset:0
  ds_read_b64_tr_b16 v[246:247], v22 offset:512
  s_waitcnt lgkmcnt(10)
  v_mfma_f32_32x32x16_bf16 v[32:47], v[112:115], v[224:227], 0
  v_mfma_f32_16x16x32_bf16 v[100:103], v[108:111], v[224:227], 0
  ds_read_b64_tr_b16 v[248:249], v19 offset:0
  ds_read_b64_tr_b16 v[250:251], v19 offset:512
  s_waitcnt lgkmcnt(10)
  v_mfma_f32_32x32x16_bf16 v[48:63], v[112:115], v[228:231], 0
  v_mfma_f32_16x16x32_bf16 v[104:107], v[108:111], v[228:231], 0
  ds_read_b64_tr_b16 v[252:253], v23 offset:0
  ds_read_b64_tr_b16 v[254:255], v23 offset:512
  s_waitcnt lgkmcnt(10)
  v_mfma_f32_32x32x16_bf16 v[32:47], v[116:119], v[232:235], v[32:47]
  s_barrier
  ds_read_b128 v[128:131], v8 offset:16384
  ds_read_b128 v[132:135], v9 offset:16384
  ds_read_b128 v[136:139], v10 offset:16384
  ds_read_b128 v[140:143], v11 offset:16384
  ds_read_b64_tr_b16 v[224:225], v16 offset:8192
  ds_read_b64_tr_b16 v[226:227], v16 offset:8704
  s_waitcnt lgkmcnt(14)
  v_mfma_f32_32x32x16_bf16 v[48:63], v[116:119], v[236:239], v[48:63]
  ds_read_b64_tr_b16 v[228:229], v20 offset:8192
  ds_read_b64_tr_b16 v[230:231], v20 offset:8704
  s_waitcnt lgkmcnt(14)
  v_mfma_f32_32x32x16_bf16 v[32:47], v[120:123], v[240:243], v[32:47]
  ds_read_b64_tr_b16 v[232:233], v17 offset:8192
  ds_read_b64_tr_b16 v[234:235], v17 offset:8704
  s_waitcnt lgkmcnt(14)
  v_mfma_f32_32x32x16_bf16 v[48:63], v[120:123], v[244:247], v[48:63]
  ds_read_b64_tr_b16 v[236:237], v21 offset:8192
  ds_read_b64_tr_b16 v[238:239], v21 offset:8704
  s_waitcnt lgkmcnt(14)
  v_mfma_f32_32x32x16_bf16 v[32:47], v[124:127], v[248:251], v[32:47]
  ds_read_b64_tr_b16 v[240:241], v18 offset:8192
  ds_read_b64_tr_b16 v[242:243], v18 offset:8704
  s_waitcnt lgkmcnt(14)
  v_mfma_f32_32x32x16_bf16 v[48:63], v[124:127], v[252:255], v[48:63]
  s_waitcnt lgkmcnt(10)
  v_dot2c_f32_bf16 v24, v128, v26
  v_dot2c_f32_bf16 v25, v128, v128
  v_dot2c_f32_bf16 v24, v129, v26
  v_dot2c_f32_bf16 v25, v129, v129
  v_dot2c_f32_bf16 v24, v130, v26
  v_dot2c_f32_bf16 v25, v130, v130
  v_dot2c_f32_bf16 v24, v131, v26
  v_dot2c_f32_bf16 v25, v131, v131
  v_dot2c_f32_bf16 v24, v132, v26
  v_dot2c_f32_bf16 v25, v132, v132
  v_dot2c_f32_bf16 v24, v133, v26
  v_dot2c_f32_bf16 v25, v133, v133
  v_dot2c_f32_bf16 v24, v134, v26
  v_dot2c_f32_bf16 v25, v134, v134
  v_dot2c_f32_bf16 v24, v135, v26
  v_dot2c_f32_bf16 v25, v135, v135
  v_dot2c_f32_bf16 v24, v136, v26
  v_dot2c_f32_bf16 v25, v136, v136
  v_dot2c_f32_bf16 v24, v137, v26
  v_dot2c_f32_bf16 v25, v137, v137
  v_dot2c_f32_bf16 v24, v138, v26
  v_dot2c_f32_bf16 v25, v138, v138
  v_dot2c_f32_bf16 v24, v139, v26
  v_dot2c_f32_bf16 v25, v139, v139
  v_dot2c_f32_bf16 v24, v140, v26
  v_dot2c_f32_bf16 v25, v140, v140
  v_dot2c_f32_bf16 v24, v141, v26
  v_dot2c_f32_bf16 v25, v141, v141
  v_dot2c_f32_bf16 v24, v142, v26
  v_dot2c_f32_bf16 v25, v142, v142
  v_dot2c_f32_bf16 v24, v143, v26
  v_dot2c_f32_bf16 v25, v143, v143
  ds_read_b64_tr_b16 v[244:245], v22 offset:8192
  ds_read_b64_tr_b16 v[246:247], v22 offset:8704
  s_waitcnt lgkmcnt(10)
  v_mfma_f32_32x32x16_bf16 v[32:47], v[128:131], v[224:227], v[32:47]
  v_mfma_f32_16x16x32_bf16 v[100:103], v[108:111], v[224:227], v[100:103]
  ds_read_b64_tr_b16 v[248:249], v19 offset:8192
  ds_read_b64_tr_b16 v[250:251], v19 offset:8704
  s_waitcnt lgkmcnt(10)
  v_mfma_f32_32x32x16_bf16 v[48:63], v[128:131], v[228:231], v[48:63]
  v_mfma_f32_16x16x32_bf16 v[104:107], v[108:111], v[228:231], v[104:107]
  ds_read_b64_tr_b16 v[252:253], v23 offset:8192
  ds_read_b64_tr_b16 v[254:255], v23 offset:8704
  s_waitcnt lgkmcnt(10)
  v_mfma_f32_32x32x16_bf16 v[32:47], v[132:135], v[232:235], v[32:47]
  s_barrier
  ds_read_b128 v[144:147], v8 offset:32768
  ds_read_b128 v[148:151], v9 offset:32768
  ds_read_b128 v[152:155], v10 offset:32768
  ds_read_b128 v[156:159], v11 offset:32768
  ds_read_b64_tr_b16 v[224:225], v16 offset:16384
  ds_read_b64_tr_b16 v[226:227], v16 offset:16896
  s_waitcnt lgkmcnt(14)
  v_mfma_f32_32x32x16_bf16 v[48:63], v[132:135], v[236:239], v[48:63]
  ds_read_b64_tr_b16 v[228:229], v20 offset:16384
  ds_read_b64_tr_b16 v[230:231], v20 offset:16896
  s_waitcnt lgkmcnt(14)
  v_mfma_f32_32x32x16_bf16 v[32:47], v[136:139], v[240:243], v[32:47]
  ds_read_b64_tr_b16 v[232:233], v17 offset:16384
  ds_read_b64_tr_b16 v[234:235], v17 offset:16896
  s_waitcnt lgkmcnt(14)
  v_mfma_f32_32x32x16_bf16 v[48:63], v[136:139], v[244:247], v[48:63]
  ds_read_b64_tr_b16 v[236:237], v21 offset:16384
  ds_read_b64_tr_b16 v[238:239], v21 offset:16896
  s_waitcnt lgkmcnt(14)
  v_mfma_f32_32x32x16_bf16 v[32:47], v[140:143], v[248:251], v[32:47]
  ds_read_b64_tr_b16 v[240:241], v18 offset:16384
  ds_read_b64_tr_b16 v[242:243], v18 offset:16896
  s_waitcnt lgkmcnt(14)
  v_mfma_f32_32x32x16_bf16 v[48:63], v[140:143], v[252:255], v[48:63]
  s_waitcnt lgkmcnt(10)
  v_dot2c_f32_bf16 v24, v144, v26
  v_dot2c_f32_bf16 v25, v144, v144
  v_dot2c_f32_bf16 v24, v145, v26
  v_dot2c_f32_bf16 v25, v145, v145
  v_dot2c_f32_bf16 v24, v146, v26
  v_dot2c_f32_bf16 v25, v146, v146
  v_dot2c_f32_bf16 v24, v147, v26
  v_dot2c_f32_bf16 v25, v147, v147
  v_dot2c_f32_bf16 v24, v148, v26
  v_dot2c_f32_bf16 v25, v148, v148
  v_dot2c_f32_bf16 v24, v149, v26
  v_dot2c_f32_bf16 v25, v149, v149
  v_dot2c_f32_bf16 v24, v150, v26
  v_dot2c_f32_bf16 v25, v150, v150
  v_dot2c_f32_bf16 v24, v151, v26
  v_dot2c_f32_bf16 v25, v151, v151
  v_dot2c_f32_bf16 v24, v152, v26
  v_dot2c_f32_bf16 v25, v152, v152
  v_dot2c_f32_bf16 v24, v153, v26
  v_dot2c_f32_bf16 v25, v153, v153
  v_dot2c_f32_bf16 v24, v154, v26
  v_dot2c_f32_bf16 v25, v154, v154
  v_dot2c_f32_bf16 v24, v155, v26
  v_dot2c_f32_bf16 v25, v155, v155
  v_dot2c_f32_bf16 v24, v156, v26
  v_dot2c_f32_bf16 v25, v156, v156
  v_dot2c_f32_bf16 v24, v157, v26
  v_dot2c_f32_bf16 v25, v157, v157
  v_dot2c_f32_bf16 v24, v158, v26
  v_dot2c_f32_bf16 v25, v158, v158
  v_dot2c_f32_bf16 v24, v159, v26
  v_dot2c_f32_bf16 v25, v159, v159
  ds_read_b64_tr_b16 v[244:245], v22 offset:16384
  ds_read_b64_tr_b16 v[246:247], v22 offset:16896
  s_waitcnt lgkmcnt(10)
  v_mfma_f32_32x32x16_bf16 v[32:47], v[144:147], v[224:227], v[32:47]
  v_mfma_f32_16x16x32_bf16 v[100:103], v[108:111], v[224:227], v[100:103]
  ds_read_b64_tr_b16 v[248:249], v19 offset:16384
  ds_read_b64_tr_b16 v[250:251], v19 offset:16896
  s_waitcnt lgkmcnt(10)
  v_mfma_f32_32x32x16_bf16 v[48:63], v[144:147], v[228:231], v[48:63]
  v_mfma_f32_16x16x32_bf16 v[104:107], v[108:111], v[228:231], v[104:107]
  ds_read_b64_tr_b16 v[252:253], v23 offset:16384
  ds_read_b64_tr_b16 v[254:255], v23 offset:16896
  s_waitcnt lgkmcnt(10)
  v_mfma_f32_32x32x16_bf16 v[32:47], v[148:151], v[232:235], v[32:47]
  v_mov_b32 v129, 0
  v_mov_b32 v130, 0
  s_barrier
  ds_read_b128 v[160:163], v8 offset:49152
  ds_read_b128 v[164:167], v9 offset:49152
  ds_read_b128 v[168:171], v10 offset:49152
  ds_read_b128 v[172:175], v11 offset:49152
  ds_read_b64_tr_b16 v[224:225], v16 offset:24576
  ds_read_b64_tr_b16 v[226:227], v16 offset:25088
  s_waitcnt lgkmcnt(14)
  v_mfma_f32_32x32x16_bf16 v[48:63], v[148:151], v[236:239], v[48:63]
  v_mov_b32 v131, 0
  v_mov_b32 v133, 0
  ds_read_b64_tr_b16 v[228:229], v20 offset:24576
  ds_read_b64_tr_b16 v[230:231], v20 offset:25088
  s_waitcnt lgkmcnt(14)
  v_mfma_f32_32x32x16_bf16 v[32:47], v[152:155], v[240:243], v[32:47]
  v_mov_b32 v134, 0
  v_mov_b32 v135, 0
  ds_read_b64_tr_b16 v[232:233], v17 offset:24576
  ds_read_b64_tr_b16 v[234:235], v17 offset:25088
  s_waitcnt lgkmcnt(14)
  v_mfma_f32_32x32x16_bf16 v[48:63], v[152:155], v[244:247], v[48:63]
  v_mov_b32 v137, 0
  v_mov_b32 v138, 0
  ds_read_b64_tr_b16 v[236:237], v21 offset:24576
  ds_read_b64_tr_b16 v[238:239], v21 offset:25088
  s_waitcnt lgkmcnt(14)
  v_mfma_f32_32x32x16_bf16 v[32:47], v[156:159], v[248:251], v[32:47]
  v_mov_b32 v139, 0
  ds_read_b64_tr_b16 v[240:241], v18 offset:24576
  ds_read_b64_tr_b16 v[242:243], v18 offset:25088
  s_waitcnt lgkmcnt(14)
  v_mfma_f32_32x32x16_bf16 v[48:63], v[156:159], v[252:255], v[48:63]
  s_waitcnt lgkmcnt(10)
  v_dot2c_f32_bf16 v24, v160, v26
  v_dot2c_f32_bf16 v25, v160, v160
  v_dot2c_f32_bf16 v24, v161, v26
  v_dot2c_f32_bf16 v25, v161, v161
  v_dot2c_f32_bf16 v24, v162, v26
  v_dot2c_f32_bf16 v25, v162, v162
  v_dot2c_f32_bf16 v24, v163, v26
  v_dot2c_f32_bf16 v25, v163, v163
  v_dot2c_f32_bf16 v24, v164, v26
  v_dot2c_f32_bf16 v25, v164, v164
  v_dot2c_f32_bf16 v24, v165, v26
  v_dot2c_f32_bf16 v25, v165, v165
  v_dot2c_f32_bf16 v24, v166, v26
  v_dot2c_f32_bf16 v25, v166, v166
  v_dot2c_f32_bf16 v24, v167, v26
  v_dot2c_f32_bf16 v25, v167, v167
  v_dot2c_f32_bf16 v24, v168, v26
  v_dot2c_f32_bf16 v25, v168, v168
  v_dot2c_f32_bf16 v24, v169, v26
  v_dot2c_f32_bf16 v25, v169, v169
  v_dot2c_f32_bf16 v24, v170, v26
  v_dot2c_f32_bf16 v25, v170, v170
  v_dot2c_f32_bf16 v24, v171, v26
  v_dot2c_f32_bf16 v25, v171, v171
  v_dot2c_f32_bf16 v24, v172, v26
  v_dot2c_f32_bf16 v25, v172, v172
  v_dot2c_f32_bf16 v24, v173, v26
  v_dot2c_f32_bf16 v25, v173, v173
  v_dot2c_f32_bf16 v24, v174, v26
  v_dot2c_f32_bf16 v25, v174, v174
  v_dot2c_f32_bf16 v24, v175, v26
  v_dot2c_f32_bf16 v25, v175, v175
  ds_read_b64_tr_b16 v[244:245], v22 offset:24576
  ds_read_b64_tr_b16 v[246:247], v22 offset:25088
  s_waitcnt lgkmcnt(10)
  v_mfma_f32_32x32x16_bf16 v[32:47], v[160:163], v[224:227], v[32:47]
  v_mfma_f32_16x16x32_bf16 v[100:103], v[108:111], v[224:227], v[100:103]
  ds_read_b64_tr_b16 v[248:249], v19 offset:24576
  ds_read_b64_tr_b16 v[250:251], v19 offset:25088
  s_waitcnt lgkmcnt(10)
  v_mfma_f32_32x32x16_bf16 v[48:63], v[160:163], v[228:231], v[48:63]
  v_mfma_f32_16x16x32_bf16 v[104:107], v[108:111], v[228:231], v[104:107]
  ds_read_b64_tr_b16 v[252:253], v23 offset:24576
  ds_read_b64_tr_b16 v[254:255], v23 offset:25088
  s_waitcnt lgkmcnt(10)
  v_mfma_f32_32x32x16_bf16 v[32:47], v[164:167], v[232:235], v[32:47]
  s_barrier
  ds_read_b128 v[176:179], v12 offset:0
  ds_read_b128 v[180:183], v13 offset:0
  ds_read_b128 v[184:187], v14 offset:0
  ds_read_b128 v[188:191], v15 offset:0
  ds_read_b64_tr_b16 v[224:225], v16 offset:32768
  ds_read_b64_tr_b16 v[226:227], v16 offset:33280
  s_waitcnt lgkmcnt(14)
  v_mfma_f32_32x32x16_bf16 v[48:63], v[164:167], v[236:239], v[48:63]
  ds_read_b64_tr_b16 v[228:229], v20 offset:32768
  ds_read_b64_tr_b16 v[230:231], v20 offset:33280
  s_waitcnt lgkmcnt(14)
  v_mfma_f32_32x32x16_bf16 v[32:47], v[168:171], v[240:243], v[32:47]
  ds_read_b64_tr_b16 v[232:233], v17 offset:32768
  ds_read_b64_tr_b16 v[234:235], v17 offset:33280
  s_waitcnt lgkmcnt(14)
  v_mfma_f32_32x32x16_bf16 v[48:63], v[168:171], v[244:247], v[48:63]
  ds_read_b64_tr_b16 v[236:237], v21 offset:32768
  ds_read_b64_tr_b16 v[238:239], v21 offset:33280
  s_waitcnt lgkmcnt(14)
  v_mfma_f32_32x32x16_bf16 v[32:47], v[172:175], v[248:251], v[32:47]
  ds_read_b64_tr_b16 v[240:241], v18 offset:32768
  ds_read_b64_tr_b16 v[242:243], v18 offset:33280
  s_waitcnt lgkmcnt(14)
  v_mfma_f32_32x32x16_bf16 v[48:63], v[172:175], v[252:255], v[48:63]
  s_waitcnt lgkmcnt(10)
  v_dot2c_f32_bf16 v24, v176, v26
  v_dot2c_f32_bf16 v25, v176, v176
  v_dot2c_f32_bf16 v24, v177, v26
  v_dot2c_f32_bf16 v25, v177, v177
  v_dot2c_f32_bf16 v24, v178, v26
  v_dot2c_f32_bf16 v25, v178, v178
  v_dot2c_f32_bf16 v24, v179, v26
  v_dot2c_f32_bf16 v25, v179, v179
  v_dot2c_f32_bf16 v24, v180, v26
  v_dot2c_f32_bf16 v25, v180, v180
  v_dot2c_f32_bf16 v24, v181, v26
  v_dot2c_f32_bf16 v25, v181, v181
  v_dot2c_f32_bf16 v24, v182, v26
  v_dot2c_f32_bf16 v25, v182, v182
  v_dot2c_f32_bf16 v24, v183, v26
  v_dot2c_f32_bf16 v25, v183, v183
  v_dot2c_f32_bf16 v24, v184, v26
  v_dot2c_f32_bf16 v25, v184, v184
  v_dot2c_f32_bf16 v24, v185, v26
  v_dot2c_f32_bf16 v25, v185, v185
  v_dot2c_f32_bf16 v24, v186, v26
  v_dot2c_f32_bf16 v25, v186, v186
  v_dot2c_f32_bf16 v24, v187, v26
  v_dot2c_f32_bf16 v25, v187, v187
  v_dot2c_f32_bf16 v24, v188, v26
  v_dot2c_f32_bf16 v25, v188, v188
  v_dot2c_f32_bf16 v24, v189, v26
  v_dot2c_f32_bf16 v25, v189, v189
  v_dot2c_f32_bf16 v24, v190, v26
  v_dot2c_f32_bf16 v25, v190, v190
  v_dot2c_f32_bf16 v24, v191, v26
  v_dot2c_f32_bf16 v25, v191, v191
  ds_read_b64_tr_b16 v[244:245], v22 offset:32768
  ds_read_b64_tr_b16 v[246:247], v22 offset:33280
  s_waitcnt lgkmcnt(10)
  v_mfma_f32_32x32x16_bf16 v[32:47], v[176:179], v[224:227], v[32:47]
  v_mfma_f32_16x16x32_bf16 v[100:103], v[108:111], v[224:227], v[100:103]
  ds_read_b64_tr_b16 v[248:249], v19 offset:32768
  ds_read_b64_tr_b16 v[250:251], v19 offset:33280
  s_waitcnt lgkmcnt(10)
  v_mfma_f32_32x32x16_bf16 v[48:63], v[176:179], v[228:231], v[48:63]
  v_mfma_f32_16x16x32_bf16 v[104:107], v[108:111], v[228:231], v[104:107]
  ds_read_b64_tr_b16 v[252:253], v23 offset:32768
  ds_read_b64_tr_b16 v[254:255], v23 offset:33280
  s_waitcnt lgkmcnt(10)
  v_mfma_f32_32x32x16_bf16 v[32:47], v[180:183], v[232:235], v[32:47]
  s_barrier
  ds_read_b128 v[192:195], v12 offset:16384
  ds_read_b128 v[196:199], v13 offset:16384
  ds_read_b128 v[200:203], v14 offset:16384
  ds_read_b128 v[204:207], v15 offset:16384
  ds_read_b64_tr_b16 v[224:225], v16 offset:40960
  ds_read_b64_tr_b16 v[226:227], v16 offset:41472
  s_waitcnt lgkmcnt(14)
  v_mfma_f32_32x32x16_bf16 v[48:63], v[180:183], v[236:239], v[48:63]
  ds_read_b64_tr_b16 v[228:229], v20 offset:40960
  ds_read_b64_tr_b16 v[230:231], v20 offset:41472
  s_waitcnt lgkmcnt(14)
  v_mfma_f32_32x32x16_bf16 v[32:47], v[184:187], v[240:243], v[32:47]
  ds_read_b64_tr_b16 v[232:233], v17 offset:40960
  ds_read_b64_tr_b16 v[234:235], v17 offset:41472
  s_waitcnt lgkmcnt(14)
  v_mfma_f32_32x32x16_bf16 v[48:63], v[184:187], v[244:247], v[48:63]
  ds_read_b64_tr_b16 v[236:237], v21 offset:40960
  ds_read_b64_tr_b16 v[238:239], v21 offset:41472
  s_waitcnt lgkmcnt(14)
  v_mfma_f32_32x32x16_bf16 v[32:47], v[188:191], v[248:251], v[32:47]
  ds_read_b64_tr_b16 v[240:241], v18 offset:40960
  ds_read_b64_tr_b16 v[242:243], v18 offset:41472
  s_waitcnt lgkmcnt(14)
  v_mfma_f32_32x32x16_bf16 v[48:63], v[188:191], v[252:255], v[48:63]
  s_waitcnt lgkmcnt(10)
  v_dot2c_f32_bf16 v24, v192, v26
  v_dot2c_f32_bf16 v25, v192, v192
  v_dot2c_f32_bf16 v24, v193, v26
  v_dot2c_f32_bf16 v25, v193, v193
  v_dot2c_f32_bf16 v24, v194, v26
  v_dot2c_f32_bf16 v25, v194, v194
  v_dot2c_f32_bf16 v24, v195, v26
  v_dot2c_f32_bf16 v25, v195, v195
  v_dot2c_f32_bf16 v24, v196, v26
  v_dot2c_f32_bf16 v25, v196, v196
  v_dot2c_f32_bf16 v24, v197, v26
  v_dot2c_f32_bf16 v25, v197, v197
  v_dot2c_f32_bf16 v24, v198, v26
  v_dot2c_f32_bf16 v25, v198, v198
  v_dot2c_f32_bf16 v24, v199, v26
  v_dot2c_f32_bf16 v25, v199, v199
  v_dot2c_f32_bf16 v24, v200, v26
  v_dot2c_f32_bf16 v25, v200, v200
  v_dot2c_f32_bf16 v24, v201, v26
  v_dot2c_f32_bf16 v25, v201, v201
  v_dot2c_f32_bf16 v24, v202, v26
  v_dot2c_f32_bf16 v25, v202, v202
  v_dot2c_f32_bf16 v24, v203, v26
  v_dot2c_f32_bf16 v25, v203, v203
  v_dot2c_f32_bf16 v24, v204, v26
  v_dot2c_f32_bf16 v25, v204, v204
  v_dot2c_f32_bf16 v24, v205, v26
  v_dot2c_f32_bf16 v25, v205, v205
  v_dot2c_f32_bf16 v24, v206, v26
  v_dot2c_f32_bf16 v25, v206, v206
  v_dot2c_f32_bf16 v24, v207, v26
  v_dot2c_f32_bf16 v25, v207, v207
  ds_read_b64_tr_b16 v[244:245], v22 offset:40960
  ds_read_b64_tr_b16 v[246:247], v22 offset:41472
  s_waitcnt lgkmcnt(10)
  v_mfma_f32_32x32x16_bf16 v[32:47], v[192:195], v[224:227], v[32:47]
  v_mfma_f32_16x16x32_bf16 v[100:103], v[108:111], v[224:227], v[100:103]
  ds_read_b64_tr_b16 v[248:249], v19 offset:40960
  ds_read_b64_tr_b16 v[250:251], v19 offset:41472
  s_waitcnt lgkmcnt(10)
  v_mfma_f32_32x32x16_bf16 v[48:63], v[192:195], v[228:231], v[48:63]
  v_mfma_f32_16x16x32_bf16 v[104:107], v[108:111], v[228:231], v[104:107]
  ds_read_b64_tr_b16 v[252:253], v23 offset:40960
  ds_read_b64_tr_b16 v[254:255], v23 offset:41472
  s_waitcnt lgkmcnt(10)
  v_mfma_f32_32x32x16_bf16 v[32:47], v[196:199], v[232:235], v[32:47]
  s_barrier
  ds_read_b128 v[208:211], v12 offset:32768
  ds_read_b128 v[212:215], v13 offset:32768
  ds_read_b128 v[216:219], v14 offset:32768
  ds_read_b128 v[220:223], v15 offset:32768
  ds_read_b64_tr_b16 v[224:225], v92 offset:0
  ds_read_b64_tr_b16 v[226:227], v92 offset:512
  s_waitcnt lgkmcnt(14)
  v_mfma_f32_32x32x16_bf16 v[48:63], v[196:199], v[236:239], v[48:63]
  ds_read_b64_tr_b16 v[228:229], v28 offset:0
  ds_read_b64_tr_b16 v[230:231], v28 offset:512
  s_waitcnt lgkmcnt(14)
  v_mfma_f32_32x32x16_bf16 v[32:47], v[200:203], v[240:243], v[32:47]
  ds_read_b64_tr_b16 v[232:233], v93 offset:0
  ds_read_b64_tr_b16 v[234:235], v93 offset:512
  s_waitcnt lgkmcnt(14)
  v_mfma_f32_32x32x16_bf16 v[48:63], v[200:203], v[244:247], v[48:63]
  ds_read_b64_tr_b16 v[236:237], v94 offset:0
  ds_read_b64_tr_b16 v[238:239], v94 offset:512
  s_waitcnt lgkmcnt(14)
  v_mfma_f32_32x32x16_bf16 v[32:47], v[204:207], v[248:251], v[32:47]
  ds_read_b64_tr_b16 v[240:241], v95 offset:0
  ds_read_b64_tr_b16 v[242:243], v95 offset:512
  s_waitcnt lgkmcnt(14)
  v_mfma_f32_32x32x16_bf16 v[48:63], v[204:207], v[252:255], v[48:63]
  s_waitcnt lgkmcnt(6)
  v_mfma_f32_16x16x32_bf16 v[100:103], v[108:111], v[224:227], v[100:103]
  v_mfma_f32_16x16x32_bf16 v[104:107], v[108:111], v[228:231], v[104:107]
  s_waitcnt lgkmcnt(10)
  v_dot2c_f32_bf16 v24, v208, v26
  v_dot2c_f32_bf16 v25, v208, v208
  v_dot2c_f32_bf16 v24, v209, v26
  v_dot2c_f32_bf16 v25, v209, v209
  v_dot2c_f32_bf16 v24, v210, v26
  v_dot2c_f32_bf16 v25, v210, v210
  v_dot2c_f32_bf16 v24, v211, v26
  v_dot2c_f32_bf16 v25, v211, v211
  v_dot2c_f32_bf16 v24, v212, v26
  v_dot2c_f32_bf16 v25, v212, v212
  v_dot2c_f32_bf16 v24, v213, v26
  v_dot2c_f32_bf16 v25, v213, v213
  v_dot2c_f32_bf16 v24, v214, v26
  v_dot2c_f32_bf16 v25, v214, v214
  v_dot2c_f32_bf16 v24, v215, v26
  v_dot2c_f32_bf16 v25, v215, v215
  v_dot2c_f32_bf16 v24, v216, v26
  v_dot2c_f32_bf16 v25, v216, v216
  v_dot2c_f32_bf16 v24, v217, v26
  v_dot2c_f32_bf16 v25, v217, v217
  v_dot2c_f32_bf16 v24, v218, v26
  v_dot2c_f32_bf16 v25, v218, v218
  v_dot2c_f32_bf16 v24, v219, v26
  v_dot2c_f32_bf16 v25, v219, v219
  v_dot2c_f32_bf16 v24, v220, v26
  v_dot2c_f32_bf16 v25, v220, v220
  v_dot2c_f32_bf16 v24, v221, v26
  v_dot2c_f32_bf16 v25, v221, v221
  v_dot2c_f32_bf16 v24, v222, v26
  v_dot2c_f32_bf16 v25, v222, v222
  v_dot2c_f32_bf16 v24, v223, v26
  v_dot2c_f32_bf16 v25, v223, v223
  s_mov_b32 exec_lo, 0
  v_mov_b32 v100, v104
  s_mov_b32 exec_lo, -1
  ds_write_b32 v88, v100
  ds_read_b64_tr_b16 v[244:245], v29 offset:0
  ds_read_b64_tr_b16 v[246:247], v29 offset:512
  s_waitcnt lgkmcnt(11)
  v_mfma_f32_32x32x16_bf16 v[32:47], v[208:211], v[224:227], v[32:47]
  s_waitcnt lgkmcnt(2)
  s_barrier
  ds_read_b128 v[100:103], v87
  ds_read_b32 v96, v81
  v_mov_b32 v2, v24
  v_mov_b32 v3, v25
  s_nop 0
  v_permlane32_swap_b32 v2, v24
  ds_read_b64_tr_b16 v[248:249], v30 offset:0
  ds_read_b64_tr_b16 v[250:251], v30 offset:512
  s_waitcnt lgkmcnt(13)
  v_mfma_f32_32x32x16_bf16 v[48:63], v[208:211], v[228:231], v[48:63]
  v_permlane32_swap_b32 v3, v25
  v_add_f32 v24, v24, v2
  v_add_f32 v25, v25, v3
  v_mul_f32 v98, 0x3b124925, v24
  ds_read_b64_tr_b16 v[252:253], v31 offset:0
  ds_read_b64_tr_b16 v[254:255], v31 offset:512
  s_waitcnt lgkmcnt(13)
  v_mfma_f32_32x32x16_bf16 v[32:47], v[212:215], v[232:235], v[32:47]
  v_mul_f32 v2, 0x3b124925, v25
  v_cvt_pk_bf16_f32 v3, -v98, -v98
  v_fma_f32 v2, -v98, v98, v2
  v_max_f32 v2, 0, v2
  v_and_b32 v132, v27, v3
  s_waitcnt lgkmcnt(11)
  v_mfma_f32_32x32x16_bf16 v[32:47], v[216:219], v[236:239], v[32:47]
  v_cvt_pk_bf16_f32 v2, v2, v2
  v_bfi_b32 v136, v27, v80, v3
  v_lshlrev_b32 v2, 16, v2
  s_waitcnt lgkmcnt(4)
  v_add_f32 v2, 0x3727c5ac, v2
  s_waitcnt lgkmcnt(9)
  v_mfma_f32_32x32x16_bf16 v[32:47], v[220:223], v[240:243], v[32:47]
  v_add_f32 v100, v100, v101
  v_cvt_pk_bf16_f32 v2, v2, v2
  v_add_f32 v102, v102, v103
  v_lshlrev_b32 v2, 16, v2
  v_add_f32 v100, v100, v102
  s_waitcnt lgkmcnt(6)
  v_mfma_f32_32x32x16_bf16 v[48:63], v[212:215], v[244:247], v[48:63]
  v_sqrt_f32 v2, v2
  v_cvt_pk_bf16_f32 v101, v100, v100
  v_and_b32 v98, 0xffff0000, v3
  v_lshlrev_b32 v101, 16, v101
  v_cvt_pk_bf16_f32 v2, v2, v2
  s_waitcnt lgkmcnt(2)
  v_mfma_f32_32x32x16_bf16 v[48:63], v[216:219], v[248:251], v[48:63]
  v_sub_f32 v100, v100, v101
  v_lshlrev_b32 v2, 16, v2
  v_cvt_pk_bf16_f32 v128, v101, v100
  v_rcp_f32 v99, v2
  v_readfirstlane_b32 s74, v96
  s_waitcnt lgkmcnt(0)
  v_mfma_f32_32x32x16_bf16 v[48:63], v[220:223], v[252:255], v[48:63]
  s_nop 0
  s_nop 0
  v_mfma_f32_32x32x16_bf16 v[32:47], v[132:135], v[128:131], v[32:47]
  v_mul_f32 v82, -v98, v99
  v_mfma_f32_32x32x16_bf16 v[48:63], v[136:139], v[128:131], v[48:63]
  v_bfi_b32 v82, v27, v99, v82
  ds_write_b32 v86, v82
  ds_read_b128 v[112:115], v91 offset:0
  ds_read_b128 v[116:119], v91 offset:32
  ds_read_b128 v[120:123], v91 offset:64
  ds_read_b128 v[124:127], v91 offset:96
  s_mov_b64 exec, 1
  ds_add_u32 v83, v89
  s_mov_b64 exec, -1
  s_waitcnt lgkmcnt(1)
  s_mov_b32 exec_lo, s81
  s_mov_b32 exec_hi, s81
  v_mul_f32 v32, v32, v112
  v_mul_f32 v33, v33, v113
  v_mul_f32 v34, v34, v114
  v_mul_f32 v35, v35, v115
  v_cvt_pk_bf16_f32 v64, v32, v33
  v_cvt_pk_bf16_f32 v65, v34, v35
  v_mul_f32 v36, v36, v116
  v_mul_f32 v37, v37, v117
  v_mul_f32 v38, v38, v118
  v_mul_f32 v39, v39, v119
  v_cvt_pk_bf16_f32 v66, v36, v37
  v_cvt_pk_bf16_f32 v67, v38, v39
  v_mul_f32 v40, v40, v120
  v_mul_f32 v41, v41, v121
  v_mul_f32 v42, v42, v122
  v_mul_f32 v43, v43, v123
  v_cvt_pk_bf16_f32 v68, v40, v41
  v_cvt_pk_bf16_f32 v69, v42, v43
  v_mul_f32 v44, v44, v124
  v_mul_f32 v45, v45, v125
  v_mul_f32 v46, v46, v126
  v_mul_f32 v47, v47, v127
  v_cvt_pk_bf16_f32 v70, v44, v45
  v_cvt_pk_bf16_f32 v71, v46, v47
  s_mov_b64 exec, -1
  s_cmp_eq_u32 s74, 0
  s_cbranch_scc1 L_sts_9
  buffer_store_dwordx4 v[64:67], v90, s[36:39], s62 offen offset:0
  buffer_store_dwordx4 v[68:71], v90, s[36:39], s62 offen offset:1024
L_std_10:
  s_mov_b32 exec_lo, s81
  s_mov_b32 exec_hi, s81
  v_mul_f32 v48, v48, v112
  v_mul_f32 v49, v49, v113
  v_mul_f32 v50, v50, v114
  v_mul_f32 v51, v51, v115
  v_cvt_pk_bf16_f32 v72, v48, v49
  v_cvt_pk_bf16_f32 v73, v50, v51
  v_mul_f32 v52, v52, v116
  v_mul_f32 v53, v53, v117
  v_mul_f32 v54, v54, v118
  v_mul_f32 v55, v55, v119
  v_cvt_pk_bf16_f32 v74, v52, v53
  v_cvt_pk_bf16_f32 v75, v54, v55
  v_mul_f32 v56, v56, v120
  v_mul_f32 v57, v57, v121
  v_mul_f32 v58, v58, v122
  v_mul_f32 v59, v59, v123
  v_cvt_pk_bf16_f32 v76, v56, v57
  v_cvt_pk_bf16_f32 v77, v58, v59
  v_mul_f32 v60, v60, v124
  v_mul_f32 v61, v61, v125
  v_mul_f32 v62, v62, v126
  v_mul_f32 v63, v63, v127
  v_cvt_pk_bf16_f32 v78, v60, v61
  v_cvt_pk_bf16_f32 v79, v62, v63
  s_mov_b64 exec, -1
  s_cmp_eq_u32 s74, 0
  s_cbranch_scc1 L_sts_11
  buffer_store_dwordx4 v[72:75], v90, s[36:39], s63 offen offset:0
  buffer_store_dwordx4 v[76:79], v90, s[36:39], s63 offen offset:1024
L_std_12:
L_p1j:
  v_lshlrev_b32 v15, 4, v1
  v_mov_b32 v2, s48
  v_mov_b32 v3, v85
  v_add_u32 v12, 155648, v15
  v_add_u32 v13, s72, v15
  v_mov_b32 v14, 0xdddddddd
  v_add_u32 v8, s4, v12
  v_lshl_add_u32 v4, s4, 3, v13
  v_add_u32 v9, s5, v12
  v_lshl_add_u32 v5, s5, 3, v13
  v_add_u32 v10, s6, v12
  v_lshl_add_u32 v6, s6, 3, v13
  v_add_u32 v11, s7, v12
  v_lshl_add_u32 v7, s7, 3, v13
  v_mov_b32 v112, 0
  v_mov_b32 v113, 0
  v_mov_b32 v114, 0
  v_mov_b32 v115, 0
  v_mov_b32 v116, 0
  v_mov_b32 v117, 0
  v_mov_b32 v118, 0
  v_mov_b32 v119, 0
  v_mov_b32 v120, 0
  v_mov_b32 v121, 0
  v_mov_b32 v122, 0
  v_mov_b32 v123, 0
  v_mov_b32 v124, 0
  v_mov_b32 v125, 0
  v_mov_b32 v126, 0
  v_mov_b32 v127, 0
  v_mov_b32 v128, 0
  v_mov_b32 v129, 0
  v_mov_b32 v130, 0
  v_mov_b32 v131, 0
  v_mov_b32 v132, 0
  v_mov_b32 v133, 0
  v_mov_b32 v134, 0
  v_mov_b32 v135, 0
  s_mov_b64 exec, 1
  s_cmp_eq_u32 s74, 0
  s_waitcnt vmcnt(0)
  s_cbranch_scc1 L_flag_slow
  buffer_store_dword v2, v80, s[36:39], s60 offen
L_flag_done:
  s_mov_b64 exec, 0xffff
  buffer_load_dword v2, v3, s[36:39], 0 offen sc1
  s_mov_b64 exec, -1
  s_cmp_lg_u32 s9, 0
  s_cbranch_scc1 L_atta0
  v_mov_b32 v136, 0
  v_mov_b32 v137, 0
  v_mov_b32 v138, 0
  v_mov_b32 v139, 0
  v_mov_b32 v140, 0
  v_mov_b32 v141, 0
  v_mov_b32 v142, 0
  v_mov_b32 v143, 0
  v_mov_b32 v144, 0
  v_mov_b32 v145, 0
  v_mov_b32 v146, 0
  v_mov_b32 v147, 0
  v_mov_b32 v148, 0
  v_mov_b32 v149, 0
  v_mov_b32 v150, 0
  v_mov_b32 v151, 0
  v_mov_b32 v152, 0
  v_mov_b32 v153, 0
  v_mov_b32 v154, 0
  v_mov_b32 v155, 0
  v_mov_b32 v156, 0
  v_mov_b32 v157, 0
  v_mov_b32 v158, 0
  v_mov_b32 v159, 0
  v_mov_b32 v160, 0
  v_mov_b32 v161, 0
  v_mov_b32 v162, 0
  v_mov_b32 v163, 0
  v_mov_b32 v164, 0
  v_mov_b32 v165, 0
  v_mov_b32 v166, 0
  v_mov_b32 v167, 0
  v_mov_b32 v168, 0
  v_mov_b32 v169, 0
  v_mov_b32 v170, 0
  v_mov_b32 v171, 0
  v_mov_b32 v172, 0
  v_mov_b32 v173, 0
  v_mov_b32 v174, 0
  v_mov_b32 v175, 0
  s_waitcnt vmcnt(0)
  v_cmp_ne_u32 s[76:77], s48, v2
  s_nop 0
  s_and_b32 s58, s76, 0x101
  s_cbranch_scc0 L_kv1ap_go
  s_mov_b64 exec, 0xffff
  s_mov_b32 s75, 0
L_kv1ap_poll:
  buffer_load_dword v2, v3, s[36:39], 0 offen sc1
  s_add_u32 s75, s75, 1
  s_waitcnt vmcnt(0)
  v_cmp_ne_u32 s[76:77], s48, v2
  s_nop 0
  s_and_b32 s58, s76, 0x101
  s_cbranch_scc0 L_kv1ap_ok
  s_cmp_ge_u32 s75, 262144
  s_cbranch_scc1 L_kv1ap_ok
  s_branch L_kv1ap_poll
L_kv1ap_ok:
  s_mov_b64 exec, -1
L_kv1ap_go:
  buffer_load_dwordx4 v[48:51], v15, s[36:39], s64 offen offset:0 sc1
  buffer_load_dwordx4 v[52:55], v15, s[36:39], s64 offen offset:1024 sc1
  buffer_load_dwordx4 v[56:59], v15, s[36:39], s64 offen offset:2048 sc1
  buffer_load_dwordx4 v[60:63], v15, s[36:39], s64 offen offset:3072 sc1
  s_barrier
  ds_read_b128 v[16:19], v8
  ds_read_b128 v[20:23], v8 offset:1024
  ds_read_b128 v[24:27], v9
  ds_read_b128 v[28:31], v9 offset:1024
  ds_read_b128 v[32:35], v10
  ds_read_b128 v[36:39], v10 offset:1024
  ds_read_b128 v[40:43], v11
  ds_read_b128 v[44:47], v11 offset:1024
  s_waitcnt vmcnt(2) lgkmcnt(6)
  v_mfma_f32_32x32x16_bf16 v[80:95], v[48:51], v[16:19], 0
  v_mfma_f32_32x32x16_bf16 v[80:95], v[52:55], v[20:23], v[80:95]
  s_mov_b64 exec, 0xffff
  buffer_load_dword v2, v3, s[36:39], 0 offen sc1
  s_mov_b64 exec, -1
  s_nop 7
  s_waitcnt lgkmcnt(0)
  v_exp_f32 v80, v80
  v_exp_f32 v81, v81
  v_exp_f32 v82, v82
  v_exp_f32 v83, v83
  v_exp_f32 v84, v84
  v_mfma_f32_32x32x16_bf16 v[96:111], v[48:51], v[24:27], 0
  v_exp_f32 v85, v85
  v_exp_f32 v86, v86
  v_exp_f32 v87, v87
  v_mfma_f32_32x32x16_bf16 v[96:111], v[52:55], v[28:31], v[96:111]
  v_exp_f32 v88, v88
  v_exp_f32 v89, v89
  v_exp_f32 v90, v90
  s_waitcnt vmcnt(1)
  v_smfmac_f32_32x32x32_bf16 v[112:127], v[56:59], v[80:87], v14
  v_exp_f32 v91, v91
  v_exp_f32 v92, v92
  v_exp_f32 v93, v93
  v_exp_f32 v94, v94
  v_exp_f32 v95, v95
  s_waitcnt vmcnt(0)
  v_cmp_ne_u32 s[76:77], s48, v2
  s_nop 0
  s_and_b32 s58, s76, 0xffff
  s_cbranch_scc0 L_kv2ap_go
  s_mov_b64 exec, 0xffff
  s_mov_b32 s75, 0
L_kv2ap_poll:
  buffer_load_dword v2, v3, s[36:39], 0 offen sc1
  s_add_u32 s75, s75, 1
  s_waitcnt vmcnt(0)
  v_cmp_ne_u32 s[76:77], s48, v2
  s_nop 0
  s_and_b32 s58, s76, 0xffff
  s_cbranch_scc0 L_kv2ap_ok
  s_cmp_ge_u32 s75, 262144
  s_cbranch_scc1 L_kv2ap_ok
  s_branch L_kv2ap_poll
L_kv2ap_ok:
  s_mov_b64 exec, -1
L_kv2ap_go:
  buffer_load_dwordx4 v[64:67], v15, s[36:39], s65 offen offset:0 sc1
  buffer_load_dwordx4 v[68:71], v15, s[36:39], s65 offen offset:1024 sc1
  buffer_load_dwordx4 v[72:75], v15, s[36:39], s65 offen offset:2048 sc1
  buffer_load_dwordx4 v[76:79], v15, s[36:39], s65 offen offset:3072 sc1
  v_exp_f32 v96, v96
  v_exp_f32 v97, v97
  v_smfmac_f32_32x32x32_bf16 v[112:127], v[60:63], v[88:95], v14
  v_exp_f32 v98, v98
  v_exp_f32 v99, v99
  v_exp_f32 v100, v100
  v_mfma_f32_32x32x16_bf16 v[80:95], v[48:51], v[32:35], 0
  v_exp_f32 v101, v101
  v_exp_f32 v102, v102
  v_exp_f32 v103, v103
  v_mfma_f32_32x32x16_bf16 v[80:95], v[52:55], v[36:39], v[80:95]
  buffer_load_dwordx4 v[176:179], v15, s[36:39], s66 offen offset:0 sc1
  buffer_load_dwordx4 v[180:183], v15, s[36:39], s66 offen offset:1024 sc1
  v_exp_f32 v104, v104
  v_exp_f32 v105, v105
  v_exp_f32 v106, v106
  v_smfmac_f32_32x32x32_bf16 v[128:143], v[56:59], v[96:103], v14
  v_exp_f32 v107, v107
  v_exp_f32 v108, v108
  v_exp_f32 v109, v109
  v_exp_f32 v110, v110
  v_exp_f32 v111, v111
  v_exp_f32 v80, v80
  v_exp_f32 v81, v81
  v_smfmac_f32_32x32x32_bf16 v[128:143], v[60:63], v[104:111], v14
  v_exp_f32 v82, v82
  v_exp_f32 v83, v83
  v_exp_f32 v84, v84
  v_mfma_f32_32x32x16_bf16 v[96:111], v[48:51], v[40:43], 0
  v_exp_f32 v85, v85
  v_exp_f32 v86, v86
  v_exp_f32 v87, v87
  v_mfma_f32_32x32x16_bf16 v[96:111], v[52:55], v[44:47], v[96:111]
  buffer_load_dwordx4 v[184:187], v15, s[36:39], s66 offen offset:2048 sc1
  buffer_load_dwordx4 v[188:191], v15, s[36:39], s66 offen offset:3072 sc1
  v_exp_f32 v88, v88
  v_exp_f32 v89, v89
  v_exp_f32 v90, v90
  v_smfmac_f32_32x32x32_bf16 v[144:159], v[56:59], v[80:87], v14
  v_exp_f32 v91, v91
  v_exp_f32 v92, v92
  v_exp_f32 v93, v93
  v_exp_f32 v94, v94
  v_exp_f32 v95, v95
  v_exp_f32 v96, v96
  v_exp_f32 v97, v97
  v_smfmac_f32_32x32x32_bf16 v[144:159], v[60:63], v[88:95], v14
  v_exp_f32 v98, v98
  v_exp_f32 v99, v99
  v_exp_f32 v100, v100
  s_waitcnt vmcnt(6)
  v_mfma_f32_32x32x16_bf16 v[80:95], v[64:67], v[16:19], 0
  v_exp_f32 v101, v101
  v_exp_f32 v102, v102
  v_exp_f32 v103, v103
  v_mfma_f32_32x32x16_bf16 v[80:95], v[68:71], v[20:23], v[80:95]
  buffer_load_dwordx4 v[192:195], v15, s[36:39], s67 offen offset:0 sc1
  buffer_load_dwordx4 v[196:199], v15, s[36:39], s67 offen offset:1024 sc1
  v_exp_f32 v104, v104
  v_exp_f32 v105, v105
  v_exp_f32 v106, v106
  v_smfmac_f32_32x32x32_bf16 v[160:175], v[56:59], v[96:103], v14
  v_exp_f32 v107, v107
  v_exp_f32 v108, v108
  v_exp_f32 v109, v109
  v_exp_f32 v110, v110
  v_exp_f32 v111, v111
  v_exp_f32 v80, v80
  v_exp_f32 v81, v81
  v_smfmac_f32_32x32x32_bf16 v[160:175], v[60:63], v[104:111], v14
  v_exp_f32 v82, v82
  v_exp_f32 v83, v83
  v_exp_f32 v84, v84
  v_mfma_f32_32x32x16_bf16 v[96:111], v[64:67], v[24:27], 0
  v_exp_f32 v85, v85
  v_exp_f32 v86, v86
  v_exp_f32 v87, v87
  v_mfma_f32_32x32x16_bf16 v[96:111], v[68:71], v[28:31], v[96:111]
  buffer_load_dwordx4 v[200:203], v15, s[36:39], s67 offen offset:2048 sc1
  buffer_load_dwordx4 v[204:207], v15, s[36:39], s67 offen offset:3072 sc1
  v_exp_f32 v88, v88
  v_exp_f32 v89, v89
  v_exp_f32 v90, v90
  s_waitcnt vmcnt(8)
  v_smfmac_f32_32x32x32_bf16 v[112:127], v[72:75], v[80:87], v14
  v_exp_f32 v91, v91
  v_exp_f32 v92, v92
  v_exp_f32 v93, v93
  v_exp_f32 v94, v94
  v_exp_f32 v95, v95
  v_exp_f32 v96, v96
  v_exp_f32 v97, v97
  v_smfmac_f32_32x32x32_bf16 v[112:127], v[76:79], v[88:95], v14
  v_exp_f32 v98, v98
  v_exp_f32 v99, v99
  v_exp_f32 v100, v100
  v_mfma_f32_32x32x16_bf16 v[80:95], v[64:67], v[32:35], 0
  v_exp_f32 v101, v101
  v_exp_f32 v102, v102
  v_exp_f32 v103, v103
  v_mfma_f32_32x32x16_bf16 v[80:95], v[68:71], v[36:39], v[80:95]
  buffer_load_dwordx4 v[208:211], v15, s[36:39], s68 offen offset:0 sc1
  buffer_load_dwordx4 v[212:215], v15, s[36:39], s68 offen offset:1024 sc1
  v_exp_f32 v104, v104
  v_exp_f32 v105, v105
  v_exp_f32 v106, v106
  v_smfmac_f32_32x32x32_bf16 v[128:143], v[72:75], v[96:103], v14
  v_exp_f32 v107, v107
  v_exp_f32 v108, v108
  v_exp_f32 v109, v109
  v_exp_f32 v110, v110
  v_exp_f32 v111, v111
  v_exp_f32 v80, v80
  v_exp_f32 v81, v81
  v_smfmac_f32_32x32x32_bf16 v[128:143], v[76:79], v[104:111], v14
  v_exp_f32 v82, v82
  v_exp_f32 v83, v83
  v_exp_f32 v84, v84
  v_mfma_f32_32x32x16_bf16 v[96:111], v[64:67], v[40:43], 0
  v_exp_f32 v85, v85
  v_exp_f32 v86, v86
  v_exp_f32 v87, v87
  v_mfma_f32_32x32x16_bf16 v[96:111], v[68:71], v[44:47], v[96:111]
  buffer_load_dwordx4 v[216:219], v15, s[36:39], s68 offen offset:2048 sc1
  buffer_load_dwordx4 v[220:223], v15, s[36:39], s68 offen offset:3072 sc1
  v_exp_f32 v88, v88
  v_exp_f32 v89, v89
  v_exp_f32 v90, v90
  v_smfmac_f32_32x32x32_bf16 v[144:159], v[72:75], v[80:87], v14
  v_exp_f32 v91, v91
  v_exp_f32 v92, v92
  v_exp_f32 v93, v93
  v_exp_f32 v94, v94
  v_exp_f32 v95, v95
  v_exp_f32 v96, v96
  v_exp_f32 v97, v97
  v_smfmac_f32_32x32x32_bf16 v[144:159], v[76:79], v[88:95], v14
  v_exp_f32 v98, v98
  v_exp_f32 v99, v99
  v_exp_f32 v100, v100
  s_waitcnt vmcnt(10)
  v_mfma_f32_32x32x16_bf16 v[80:95], v[176:179], v[16:19], 0
  v_exp_f32 v101, v101
  v_exp_f32 v102, v102
  v_exp_f32 v103, v103
  v_mfma_f32_32x32x16_bf16 v[80:95], v[180:183], v[20:23], v[80:95]
  buffer_load_dwordx4 v[224:227], v15, s[36:39], s69 offen offset:0 sc1
  buffer_load_dwordx4 v[228:231], v15, s[36:39], s69 offen offset:1024 sc1
  v_exp_f32 v104, v104
  v_exp_f32 v105, v105
  v_exp_f32 v106, v106
  v_smfmac_f32_32x32x32_bf16 v[160:175], v[72:75], v[96:103], v14
  v_exp_f32 v107, v107
  v_exp_f32 v108, v108
  v_exp_f32 v109, v109
  v_exp_f32 v110, v110
  v_exp_f32 v111, v111
  v_exp_f32 v80, v80
  v_exp_f32 v81, v81
  v_smfmac_f32_32x32x32_bf16 v[160:175], v[76:79], v[104:111], v14
  v_exp_f32 v82, v82
  v_exp_f32 v83, v83
  v_exp_f32 v84, v84
  v_mfma_f32_32x32x16_bf16 v[96:111], v[176:179], v[24:27], 0
  v_exp_f32 v85, v85
  v_exp_f32 v86, v86
  v_exp_f32 v87, v87
  v_mfma_f32_32x32x16_bf16 v[96:111], v[180:183], v[28:31], v[96:111]
  buffer_load_dwordx4 v[232:235], v15, s[36:39], s69 offen offset:2048 sc1
  buffer_load_dwordx4 v[236:239], v15, s[36:39], s69 offen offset:3072 sc1
  v_exp_f32 v88, v88
  v_exp_f32 v89, v89
  v_exp_f32 v90, v90
  s_waitcnt vmcnt(12)
  v_smfmac_f32_32x32x32_bf16 v[112:127], v[184:187], v[80:87], v14
  v_exp_f32 v91, v91
  v_exp_f32 v92, v92
  v_exp_f32 v93, v93
  v_exp_f32 v94, v94
  v_exp_f32 v95, v95
  v_exp_f32 v96, v96
  v_exp_f32 v97, v97
  v_smfmac_f32_32x32x32_bf16 v[112:127], v[188:191], v[88:95], v14
  v_exp_f32 v98, v98
  v_exp_f32 v99, v99
  v_exp_f32 v100, v100
  v_mfma_f32_32x32x16_bf16 v[80:95], v[176:179], v[32:35], 0
  v_exp_f32 v101, v101
  v_exp_f32 v102, v102
  v_exp_f32 v103, v103
  v_mfma_f32_32x32x16_bf16 v[80:95], v[180:183], v[36:39], v[80:95]
  buffer_load_dwordx4 v[48:51], v15, s[36:39], s70 offen offset:0 sc1
  buffer_load_dwordx4 v[52:55], v15, s[36:39], s70 offen offset:1024 sc1
  v_exp_f32 v104, v104
  v_exp_f32 v105, v105
  v_exp_f32 v106, v106
  v_smfmac_f32_32x32x32_bf16 v[128:143], v[184:187], v[96:103], v14
  v_exp_f32 v107, v107
  v_exp_f32 v108, v108
  v_exp_f32 v109, v109
  v_exp_f32 v110, v110
  v_exp_f32 v111, v111
  v_exp_f32 v80, v80
  v_exp_f32 v81, v81
  v_smfmac_f32_32x32x32_bf16 v[128:143], v[188:191], v[104:111], v14
  v_exp_f32 v82, v82
  v_exp_f32 v83, v83
  v_exp_f32 v84, v84
  v_mfma_f32_32x32x16_bf16 v[96:111], v[176:179], v[40:43], 0
  v_exp_f32 v85, v85
  v_exp_f32 v86, v86
  v_exp_f32 v87, v87
  v_mfma_f32_32x32x16_bf16 v[96:111], v[180:183], v[44:47], v[96:111]
  buffer_load_dwordx4 v[56:59], v15, s[36:39], s70 offen offset:2048 sc1
  buffer_load_dwordx4 v[60:63], v15, s[36:39], s70 offen offset:3072 sc1
  v_exp_f32 v88, v88
  v_exp_f32 v89, v89
  v_exp_f32 v90, v90
  v_smfmac_f32_32x32x32_bf16 v[144:159], v[184:187], v[80:87], v14
  v_exp_f32 v91, v91
  v_exp_f32 v92, v92
  v_exp_f32 v93, v93
  v_exp_f32 v94, v94
  v_exp_f32 v95, v95
  v_exp_f32 v96, v96
  v_exp_f32 v97, v97
  v_smfmac_f32_32x32x32_bf16 v[144:159], v[188:191], v[88:95], v14
  v_exp_f32 v98, v98
  v_exp_f32 v99, v99
  v_exp_f32 v100, v100
  s_waitcnt vmcnt(14)
  v_mfma_f32_32x32x16_bf16 v[80:95], v[192:195], v[16:19], 0
  v_exp_f32 v101, v101
  v_exp_f32 v102, v102
  v_exp_f32 v103, v103
  v_mfma_f32_32x32x16_bf16 v[80:95], v[196:199], v[20:23], v[80:95]
  buffer_load_dwordx4 v[64:67], v15, s[36:39], s71 offen offset:0 sc1
  buffer_load_dwordx4 v[68:71], v15, s[36:39], s71 offen offset:1024 sc1
  v_exp_f32 v104, v104
  v_exp_f32 v105, v105
  v_exp_f32 v106, v106
  v_smfmac_f32_32x32x32_bf16 v[160:175], v[184:187], v[96:103], v14
  v_exp_f32 v107, v107
  v_exp_f32 v108, v108
  v_exp_f32 v109, v109
  v_exp_f32 v110, v110
  v_exp_f32 v111, v111
  v_exp_f32 v80, v80
  v_exp_f32 v81, v81
  v_smfmac_f32_32x32x32_bf16 v[160:175], v[188:191], v[104:111], v14
  v_exp_f32 v82, v82
  v_exp_f32 v83, v83
  v_exp_f32 v84, v84
  v_mfma_f32_32x32x16_bf16 v[96:111], v[192:195], v[24:27], 0
  v_exp_f32 v85, v85
  v_exp_f32 v86, v86
  v_exp_f32 v87, v87
  v_mfma_f32_32x32x16_bf16 v[96:111], v[196:199], v[28:31], v[96:111]
  buffer_load_dwordx4 v[72:75], v15, s[36:39], s71 offen offset:2048 sc1
  buffer_load_dwordx4 v[76:79], v15, s[36:39], s71 offen offset:3072 sc1
  v_exp_f32 v88, v88
  v_exp_f32 v89, v89
  v_exp_f32 v90, v90
  s_waitcnt vmcnt(16)
  v_smfmac_f32_32x32x32_bf16 v[112:127], v[200:203], v[80:87], v14
  v_exp_f32 v91, v91
  v_exp_f32 v92, v92
  v_exp_f32 v93, v93
  v_exp_f32 v94, v94
  v_exp_f32 v95, v95
  v_lshlrev_b32 v10, 7, v1
  v_min_u32 v11, 528, v15
  s_mov_b32 s59, 69632
  buffer_load_dword v12, v15, s[36:39], s59 offen sc1
  buffer_load_dword v13, v11, s[36:39], s59 offen offset:1024 sc1
  v_exp_f32 v96, v96
  v_exp_f32 v97, v97
  v_smfmac_f32_32x32x32_bf16 v[112:127], v[204:207], v[88:95], v14
  v_exp_f32 v98, v98
  v_exp_f32 v99, v99
  v_exp_f32 v100, v100
  v_mfma_f32_32x32x16_bf16 v[80:95], v[192:195], v[32:35], 0
  v_exp_f32 v101, v101
  v_exp_f32 v102, v102
  v_exp_f32 v103, v103
  v_mfma_f32_32x32x16_bf16 v[80:95], v[196:199], v[36:39], v[80:95]
  v_exp_f32 v104, v104
  v_exp_f32 v105, v105
  v_exp_f32 v106, v106
  v_smfmac_f32_32x32x32_bf16 v[128:143], v[200:203], v[96:103], v14
  v_exp_f32 v107, v107
  v_exp_f32 v108, v108
  v_exp_f32 v109, v109
  v_exp_f32 v110, v110
  v_exp_f32 v111, v111
  v_exp_f32 v80, v80
  v_exp_f32 v81, v81
  v_smfmac_f32_32x32x32_bf16 v[128:143], v[204:207], v[104:111], v14
  v_exp_f32 v82, v82
  v_exp_f32 v83, v83
  v_exp_f32 v84, v84
  v_mfma_f32_32x32x16_bf16 v[96:111], v[192:195], v[40:43], 0
  v_exp_f32 v85, v85
  v_exp_f32 v86, v86
  v_exp_f32 v87, v87
  v_mfma_f32_32x32x16_bf16 v[96:111], v[196:199], v[44:47], v[96:111]
  v_exp_f32 v88, v88
  v_exp_f32 v89, v89
  v_exp_f32 v90, v90
  v_smfmac_f32_32x32x32_bf16 v[144:159], v[200:203], v[80:87], v14
  v_exp_f32 v91, v91
  v_exp_f32 v92, v92
  v_exp_f32 v93, v93
  v_exp_f32 v94, v94
  v_exp_f32 v95, v95
  v_exp_f32 v96, v96
  v_exp_f32 v97, v97
  v_smfmac_f32_32x32x32_bf16 v[144:159], v[204:207], v[88:95], v14
  v_exp_f32 v98, v98
  v_exp_f32 v99, v99
  v_exp_f32 v100, v100
  s_waitcnt vmcnt(16)
  v_mfma_f32_32x32x16_bf16 v[80:95], v[208:211], v[16:19], 0
  v_exp_f32 v101, v101
  v_exp_f32 v102, v102
  v_exp_f32 v103, v103
  v_mfma_f32_32x32x16_bf16 v[80:95], v[212:215], v[20:23], v[80:95]
  v_exp_f32 v104, v104
  v_exp_f32 v105, v105
  v_exp_f32 v106, v106
  v_smfmac_f32_32x32x32_bf16 v[160:175], v[200:203], v[96:103], v14
  v_exp_f32 v107, v107
  v_exp_f32 v108, v108
  v_exp_f32 v109, v109
  v_exp_f32 v110, v110
  v_exp_f32 v111, v111
  s_waitcnt vmcnt(0)
  v_xor_b32 v9, s48, v12
  v_bitop3_b32 v9, v9, v13, s48 bitop3:0xf6
  v_cmp_ne_u32 s[76:77], 0, v9
  s_nop 0
  s_and_b64 s[76:77], s[76:77], exec
  s_cbranch_scc1 L_wot_spin
L_wot_go:
  s_lshl_b32 s58, s50, 2
  s_add_u32 s58, s58, s54
  s_mul_i32 s58, s58, 6272
  s_add_u32 s58, s58, 1179648
  s_mov_b32 exec_hi, 0x1ffff
  buffer_load_dword v12, v10, s[36:39], s58 offen sc1
  s_mov_b32 exec_hi, -1
  v_exp_f32 v80, v80
  v_exp_f32 v81, v81
  v_smfmac_f32_32x32x32_bf16 v[160:175], v[204:207], v[104:111], v14
  v_exp_f32 v82, v82
  v_exp_f32 v83, v83
  v_exp_f32 v84, v84
  v_mfma_f32_32x32x16_bf16 v[96:111], v[208:211], v[24:27], 0
  v_exp_f32 v85, v85
  v_exp_f32 v86, v86
  v_exp_f32 v87, v87
  v_mfma_f32_32x32x16_bf16 v[96:111], v[212:215], v[28:31], v[96:111]
  v_exp_f32 v88, v88
  v_exp_f32 v89, v89
  v_exp_f32 v90, v90
  v_smfmac_f32_32x32x32_bf16 v[112:127], v[216:219], v[80:87], v14
  v_exp_f32 v91, v91
  v_exp_f32 v92, v92
  v_exp_f32 v93, v93
  v_exp_f32 v94, v94
  v_exp_f32 v95, v95
  v_exp_f32 v96, v96
  v_exp_f32 v97, v97
  v_smfmac_f32_32x32x32_bf16 v[112:127], v[220:223], v[88:95], v14
  v_exp_f32 v98, v98
  v_exp_f32 v99, v99
  v_exp_f32 v100, v100
  v_mfma_f32_32x32x16_bf16 v[80:95], v[208:211], v[32:35], 0
  v_exp_f32 v101, v101
  v_exp_f32 v102, v102
  v_exp_f32 v103, v103
  v_mfma_f32_32x32x16_bf16 v[80:95], v[212:215], v[36:39], v[80:95]
  v_exp_f32 v104, v104
  v_exp_f32 v105, v105
  v_exp_f32 v106, v106
  v_smfmac_f32_32x32x32_bf16 v[128:143], v[216:219], v[96:103], v14
  v_exp_f32 v107, v107
  v_exp_f32 v108, v108
  v_exp_f32 v109, v109
  v_exp_f32 v110, v110
  v_exp_f32 v111, v111
  v_exp_f32 v80, v80
  v_exp_f32 v81, v81
  v_smfmac_f32_32x32x32_bf16 v[128:143], v[220:223], v[104:111], v14
  v_exp_f32 v82, v82
  v_exp_f32 v83, v83
  v_exp_f32 v84, v84
  v_mfma_f32_32x32x16_bf16 v[96:111], v[208:211], v[40:43], 0
  v_exp_f32 v85, v85
  v_exp_f32 v86, v86
  s_add_u32 s58, s83, 114688
  buffer_load_dwordx4 v[240:243], v15, s[36:39], s58 offen offset:0 sc1
  v_exp_f32 v87, v87
  v_mfma_f32_32x32x16_bf16 v[96:111], v[212:215], v[44:47], v[96:111]
  v_exp_f32 v88, v88
  v_exp_f32 v89, v89
  v_exp_f32 v90, v90
  v_smfmac_f32_32x32x32_bf16 v[144:159], v[216:219], v[80:87], v14
  v_exp_f32 v91, v91
  v_exp_f32 v92, v92
  v_exp_f32 v93, v93
  v_exp_f32 v94, v94
  v_exp_f32 v95, v95
  buffer_load_dwordx4 v[244:247], v15, s[36:39], s58 offen offset:1024 sc1
  v_exp_f32 v96, v96
  v_exp_f32 v97, v97
  v_smfmac_f32_32x32x32_bf16 v[144:159], v[220:223], v[88:95], v14
  v_exp_f32 v98, v98
  v_exp_f32 v99, v99
  v_exp_f32 v100, v100
  v_mfma_f32_32x32x16_bf16 v[80:95], v[224:227], v[16:19], 0
  v_exp_f32 v101, v101
  v_exp_f32 v102, v102
  buffer_load_dwordx4 v[248:251], v15, s[36:39], s58 offen offset:2048 sc1
  v_exp_f32 v103, v103
  v_mfma_f32_32x32x16_bf16 v[80:95], v[228:231], v[20:23], v[80:95]
  v_exp_f32 v104, v104
  v_exp_f32 v105, v105
  v_exp_f32 v106, v106
  v_smfmac_f32_32x32x32_bf16 v[160:175], v[216:219], v[96:103], v14
  v_exp_f32 v107, v107
  v_exp_f32 v108, v108
  v_exp_f32 v109, v109
  v_exp_f32 v110, v110
  v_exp_f32 v111, v111
  buffer_load_dwordx4 v[252:255], v15, s[36:39], s58 offen offset:3072 sc1
  v_exp_f32 v80, v80
  v_exp_f32 v81, v81
  v_smfmac_f32_32x32x32_bf16 v[160:175], v[220:223], v[104:111], v14
  v_exp_f32 v82, v82
  v_exp_f32 v83, v83
  v_exp_f32 v84, v84
  v_mfma_f32_32x32x16_bf16 v[96:111], v[224:227], v[24:27], 0
  v_exp_f32 v85, v85
  v_exp_f32 v86, v86
  s_add_u32 s58, s83, 0
  buffer_load_dwordx4 v[176:179], v15, s[36:39], s58 offen offset:0 sc1
  v_exp_f32 v87, v87
  v_mfma_f32_32x32x16_bf16 v[96:111], v[228:231], v[28:31], v[96:111]
  v_exp_f32 v88, v88
  v_exp_f32 v89, v89
  v_exp_f32 v90, v90
  v_smfmac_f32_32x32x32_bf16 v[112:127], v[232:235], v[80:87], v14
  v_exp_f32 v91, v91
  v_exp_f32 v92, v92
  v_exp_f32 v93, v93
  v_exp_f32 v94, v94
  v_exp_f32 v95, v95
  buffer_load_dwordx4 v[180:183], v15, s[36:39], s58 offen offset:1024 sc1
  v_exp_f32 v96, v96
  v_exp_f32 v97, v97
  v_smfmac_f32_32x32x32_bf16 v[112:127], v[236:239], v[88:95], v14
  v_exp_f32 v98, v98
  v_exp_f32 v99, v99
  v_exp_f32 v100, v100
  v_mfma_f32_32x32x16_bf16 v[80:95], v[224:227], v[32:35], 0
  v_exp_f32 v101, v101
  v_exp_f32 v102, v102
  buffer_load_dwordx4 v[184:187], v15, s[36:39], s58 offen offset:2048 sc1
  v_exp_f32 v103, v103
  v_mfma_f32_32x32x16_bf16 v[80:95], v[228:231], v[36:39], v[80:95]
  v_exp_f32 v104, v104
  v_exp_f32 v105, v105
  v_exp_f32 v106, v106
  v_smfmac_f32_32x32x32_bf16 v[128:143], v[232:235], v[96:103], v14
  v_exp_f32 v107, v107
  v_exp_f32 v108, v108
  v_exp_f32 v109, v109
  v_exp_f32 v110, v110
  v_exp_f32 v111, v111
  buffer_load_dwordx4 v[188:191], v15, s[36:39], s58 offen offset:3072 sc1
  v_exp_f32 v80, v80
  v_exp_f32 v81, v81
  v_smfmac_f32_32x32x32_bf16 v[128:143], v[236:239], v[104:111], v14
  v_exp_f32 v82, v82
  v_exp_f32 v83, v83
  v_exp_f32 v84, v84
  v_mfma_f32_32x32x16_bf16 v[96:111], v[224:227], v[40:43], 0
  v_exp_f32 v85, v85
  v_exp_f32 v86, v86
  s_add_u32 s58, s83, 28672
  buffer_load_dwordx4 v[192:195], v15, s[36:39], s58 offen offset:0 sc1
  v_exp_f32 v87, v87
  v_mfma_f32_32x32x16_bf16 v[96:111], v[228:231], v[44:47], v[96:111]
  v_exp_f32 v88, v88
  v_exp_f32 v89, v89
  v_exp_f32 v90, v90
  v_smfmac_f32_32x32x32_bf16 v[144:159], v[232:235], v[80:87], v14
  v_exp_f32 v91, v91
  v_exp_f32 v92, v92
  v_exp_f32 v93, v93
  v_exp_f32 v94, v94
  v_exp_f32 v95, v95
  buffer_load_dwordx4 v[196:199], v15, s[36:39], s58 offen offset:1024 sc1
  v_exp_f32 v96, v96
  v_exp_f32 v97, v97
  v_smfmac_f32_32x32x32_bf16 v[144:159], v[236:239], v[88:95], v14
  v_exp_f32 v98, v98
  v_exp_f32 v99, v99
  v_exp_f32 v100, v100
  v_mfma_f32_32x32x16_bf16 v[80:95], v[48:51], v[16:19], 0
  v_exp_f32 v101, v101
  v_exp_f32 v102, v102
  buffer_load_dwordx4 v[200:203], v15, s[36:39], s58 offen offset:2048 sc1
  v_exp_f32 v103, v103
  v_mfma_f32_32x32x16_bf16 v[80:95], v[52:55], v[20:23], v[80:95]
  v_exp_f32 v104, v104
  v_exp_f32 v105, v105
  v_exp_f32 v106, v106
  v_smfmac_f32_32x32x32_bf16 v[160:175], v[232:235], v[96:103], v14
  v_exp_f32 v107, v107
  v_exp_f32 v108, v108
  v_exp_f32 v109, v109
  v_exp_f32 v110, v110
  v_exp_f32 v111, v111
  buffer_load_dwordx4 v[204:207], v15, s[36:39], s58 offen offset:3072 sc1
  v_exp_f32 v80, v80
  v_exp_f32 v81, v81
  v_smfmac_f32_32x32x32_bf16 v[160:175], v[236:239], v[104:111], v14
  v_exp_f32 v82, v82
  v_exp_f32 v83, v83
  v_exp_f32 v84, v84
  v_mfma_f32_32x32x16_bf16 v[96:111], v[48:51], v[24:27], 0
  v_exp_f32 v85, v85
  v_exp_f32 v86, v86
  s_add_u32 s58, s83, 57344
  buffer_load_dwordx4 v[208:211], v15, s[36:39], s58 offen offset:0 sc1
  v_exp_f32 v87, v87
  v_mfma_f32_32x32x16_bf16 v[96:111], v[52:55], v[28:31], v[96:111]
  v_exp_f32 v88, v88
  v_exp_f32 v89, v89
  v_exp_f32 v90, v90
  v_smfmac_f32_32x32x32_bf16 v[112:127], v[56:59], v[80:87], v14
  v_exp_f32 v91, v91
  v_exp_f32 v92, v92
  v_exp_f32 v93, v93
  v_exp_f32 v94, v94
  v_exp_f32 v95, v95
  v_exp_f32 v96, v96
  v_exp_f32 v97, v97
  v_smfmac_f32_32x32x32_bf16 v[112:127], v[60:63], v[88:95], v14
  v_exp_f32 v98, v98
  v_exp_f32 v99, v99
  v_exp_f32 v100, v100
  v_mfma_f32_32x32x16_bf16 v[80:95], v[48:51], v[32:35], 0
  v_exp_f32 v101, v101
  v_exp_f32 v102, v102
  buffer_load_dwordx4 v[212:215], v15, s[36:39], s58 offen offset:1024 sc1
  v_exp_f32 v103, v103
  v_mfma_f32_32x32x16_bf16 v[80:95], v[52:55], v[36:39], v[80:95]
  v_exp_f32 v104, v104
  v_exp_f32 v105, v105
  v_exp_f32 v106, v106
  v_smfmac_f32_32x32x32_bf16 v[128:143], v[56:59], v[96:103], v14
  v_exp_f32 v107, v107
  v_exp_f32 v108, v108
  v_exp_f32 v109, v109
  v_exp_f32 v110, v110
  v_exp_f32 v111, v111
  v_exp_f32 v80, v80
  v_exp_f32 v81, v81
  v_smfmac_f32_32x32x32_bf16 v[128:143], v[60:63], v[104:111], v14
  v_exp_f32 v82, v82
  v_exp_f32 v83, v83
  v_exp_f32 v84, v84
  v_mfma_f32_32x32x16_bf16 v[96:111], v[48:51], v[40:43], 0
  v_exp_f32 v85, v85
  v_exp_f32 v86, v86
  buffer_load_dwordx4 v[216:219], v15, s[36:39], s58 offen offset:2048 sc1
  v_exp_f32 v87, v87
  v_mfma_f32_32x32x16_bf16 v[96:111], v[52:55], v[44:47], v[96:111]
  v_exp_f32 v88, v88
  v_exp_f32 v89, v89
  v_exp_f32 v90, v90
  v_smfmac_f32_32x32x32_bf16 v[144:159], v[56:59], v[80:87], v14
  v_exp_f32 v91, v91
  v_exp_f32 v92, v92
  v_exp_f32 v93, v93
  v_exp_f32 v94, v94
  v_exp_f32 v95, v95
  v_exp_f32 v96, v96
  v_exp_f32 v97, v97
  v_smfmac_f32_32x32x32_bf16 v[144:159], v[60:63], v[88:95], v14
  v_exp_f32 v98, v98
  v_exp_f32 v99, v99
  v_exp_f32 v100, v100
  v_mfma_f32_32x32x16_bf16 v[80:95], v[64:67], v[16:19], 0
  v_exp_f32 v101, v101
  v_exp_f32 v102, v102
  buffer_load_dwordx4 v[220:223], v15, s[36:39], s58 offen offset:3072 sc1
  v_exp_f32 v103, v103
  v_mfma_f32_32x32x16_bf16 v[80:95], v[68:71], v[20:23], v[80:95]
  v_exp_f32 v104, v104
  v_exp_f32 v105, v105
  v_exp_f32 v106, v106
  v_smfmac_f32_32x32x32_bf16 v[160:175], v[56:59], v[96:103], v14
  v_exp_f32 v107, v107
  v_exp_f32 v108, v108
  v_exp_f32 v109, v109
  v_exp_f32 v110, v110
  v_exp_f32 v111, v111
  v_exp_f32 v80, v80
  v_exp_f32 v81, v81
  v_smfmac_f32_32x32x32_bf16 v[160:175], v[60:63], v[104:111], v14
  v_exp_f32 v82, v82
  v_exp_f32 v83, v83
  v_exp_f32 v84, v84
  v_mfma_f32_32x32x16_bf16 v[96:111], v[64:67], v[24:27], 0
  v_exp_f32 v85, v85
  v_exp_f32 v86, v86
  s_add_u32 s58, s83, 86016
  buffer_load_dwordx4 v[224:227], v15, s[36:39], s58 offen offset:0 sc1
  v_exp_f32 v87, v87
  v_mfma_f32_32x32x16_bf16 v[96:111], v[68:71], v[28:31], v[96:111]
  v_exp_f32 v88, v88
  v_exp_f32 v89, v89
  v_exp_f32 v90, v90
  v_smfmac_f32_32x32x32_bf16 v[112:127], v[72:75], v[80:87], v14
  v_exp_f32 v91, v91
  v_exp_f32 v92, v92
  v_exp_f32 v93, v93
  v_exp_f32 v94, v94
  v_exp_f32 v95, v95
  v_exp_f32 v96, v96
  v_exp_f32 v97, v97
  v_smfmac_f32_32x32x32_bf16 v[112:127], v[76:79], v[88:95], v14
  v_exp_f32 v98, v98
  v_exp_f32 v99, v99
  v_exp_f32 v100, v100
  v_mfma_f32_32x32x16_bf16 v[80:95], v[64:67], v[32:35], 0
  v_exp_f32 v101, v101
  v_exp_f32 v102, v102
  buffer_load_dwordx4 v[228:231], v15, s[36:39], s58 offen offset:1024 sc1
  v_exp_f32 v103, v103
  v_mfma_f32_32x32x16_bf16 v[80:95], v[68:71], v[36:39], v[80:95]
  v_exp_f32 v104, v104
  v_exp_f32 v105, v105
  v_exp_f32 v106, v106
  v_smfmac_f32_32x32x32_bf16 v[128:143], v[72:75], v[96:103], v14
  v_exp_f32 v107, v107
  v_exp_f32 v108, v108
  v_exp_f32 v109, v109
  v_exp_f32 v110, v110
  v_exp_f32 v111, v111
  v_exp_f32 v80, v80
  v_exp_f32 v81, v81
  v_smfmac_f32_32x32x32_bf16 v[128:143], v[76:79], v[104:111], v14
  v_exp_f32 v82, v82
  v_exp_f32 v83, v83
  v_exp_f32 v84, v84
  v_mfma_f32_32x32x16_bf16 v[96:111], v[64:67], v[40:43], 0
  v_exp_f32 v85, v85
  v_exp_f32 v86, v86
  buffer_load_dwordx4 v[232:235], v15, s[36:39], s58 offen offset:2048 sc1
  v_exp_f32 v87, v87
  v_mfma_f32_32x32x16_bf16 v[96:111], v[68:71], v[44:47], v[96:111]
  v_exp_f32 v88, v88
  v_exp_f32 v89, v89
  v_exp_f32 v90, v90
  v_smfmac_f32_32x32x32_bf16 v[144:159], v[72:75], v[80:87], v14
  v_exp_f32 v91, v91
  v_exp_f32 v92, v92
  v_exp_f32 v93, v93
  v_exp_f32 v94, v94
  v_exp_f32 v95, v95
  v_exp_f32 v96, v96
  v_exp_f32 v97, v97
  v_smfmac_f32_32x32x32_bf16 v[144:159], v[76:79], v[88:95], v14
  v_exp_f32 v98, v98
  v_exp_f32 v99, v99
  v_exp_f32 v100, v100
  v_exp_f32 v101, v101
  v_exp_f32 v102, v102
  buffer_load_dwordx4 v[236:239], v15, s[36:39], s58 offen offset:3072 sc1
  v_exp_f32 v103, v103
  v_exp_f32 v104, v104
  v_exp_f32 v105, v105
  v_exp_f32 v106, v106
  v_smfmac_f32_32x32x32_bf16 v[160:175], v[72:75], v[96:103], v14
  v_exp_f32 v107, v107
  v_exp_f32 v108, v108
  v_exp_f32 v109, v109
  v_exp_f32 v110, v110
  v_exp_f32 v111, v111
  s_nop 1
  v_smfmac_f32_32x32x32_bf16 v[160:175], v[76:79], v[104:111], v14
  s_branch L_reda
L_atta0:
  v_mov_b32 v136, 0
  v_mov_b32 v137, 0
  v_mov_b32 v138, 0
  v_mov_b32 v139, 0
  v_mov_b32 v140, 0
  v_mov_b32 v141, 0
  v_mov_b32 v142, 0
  v_mov_b32 v143, 0
  v_mov_b32 v144, 0
  v_mov_b32 v145, 0
  v_mov_b32 v146, 0
  v_mov_b32 v147, 0
  v_mov_b32 v148, 0
  v_mov_b32 v149, 0
  v_mov_b32 v150, 0
  v_mov_b32 v151, 0
  v_mov_b32 v152, 0
  v_mov_b32 v153, 0
  v_mov_b32 v154, 0
  v_mov_b32 v155, 0
  v_mov_b32 v156, 0
  v_mov_b32 v157, 0
  v_mov_b32 v158, 0
  v_mov_b32 v159, 0
  v_mov_b32 v160, 0
  v_mov_b32 v161, 0
  v_mov_b32 v162, 0
  v_mov_b32 v163, 0
  v_mov_b32 v164, 0
  v_mov_b32 v165, 0
  v_mov_b32 v166, 0
  v_mov_b32 v167, 0
  v_mov_b32 v168, 0
  v_mov_b32 v169, 0
  v_mov_b32 v170, 0
  v_mov_b32 v171, 0
  v_mov_b32 v172, 0
  v_mov_b32 v173, 0
  v_mov_b32 v174, 0
  v_mov_b32 v175, 0
  s_waitcnt vmcnt(0)
  v_cmp_ne_u32 s[76:77], s48, v2
  s_nop 0
  s_and_b32 s58, s76, 0x101
  s_cbranch_scc0 L_kv1a_go
  s_mov_b64 exec, 0xffff
  s_mov_b32 s75, 0
L_kv1a_poll:
  buffer_load_dword v2, v3, s[36:39], 0 offen sc1
  s_add_u32 s75, s75, 1
  s_waitcnt vmcnt(0)
  v_cmp_ne_u32 s[76:77], s48, v2
  s_nop 0
  s_and_b32 s58, s76, 0x101
  s_cbranch_scc0 L_kv1a_ok
  s_cmp_ge_u32 s75, 262144
  s_cbranch_scc1 L_kv1a_ok
  s_branch L_kv1a_poll
L_kv1a_ok:
  s_mov_b64 exec, -1
L_kv1a_go:
  buffer_load_dwordx4 v[48:51], v15, s[36:39], s64 offen offset:0 sc1
  buffer_load_dwordx4 v[52:55], v15, s[36:39], s64 offen offset:1024 sc1
  buffer_load_dwordx4 v[56:59], v15, s[36:39], s64 offen offset:2048 sc1
  buffer_load_dwordx4 v[60:63], v15, s[36:39], s64 offen offset:3072 sc1
  s_barrier
  ds_read_b128 v[16:19], v8
  ds_read_b128 v[20:23], v8 offset:1024
  ds_read_b128 v[24:27], v9
  ds_read_b128 v[28:31], v9 offset:1024
  ds_read_b128 v[32:35], v10
  ds_read_b128 v[36:39], v10 offset:1024
  ds_read_b128 v[40:43], v11
  ds_read_b128 v[44:47], v11 offset:1024
  s_waitcnt vmcnt(2) lgkmcnt(6)
  v_mfma_f32_32x32x16_bf16 v[80:95], v[48:51], v[16:19], 0
  v_mfma_f32_32x32x16_bf16 v[80:95], v[52:55], v[20:23], v[80:95]
  s_mov_b64 exec, 0xffff
  buffer_load_dword v2, v3, s[36:39], 0 offen sc1
  s_mov_b64 exec, -1
  s_nop 7
  s_waitcnt lgkmcnt(0)
  v_exp_f32 v80, v80
  v_exp_f32 v81, v81
  v_exp_f32 v82, v82
  v_exp_f32 v83, v83
  v_exp_f32 v84, v84
  v_mfma_f32_32x32x16_bf16 v[96:111], v[48:51], v[24:27], 0
  v_exp_f32 v85, v85
  v_exp_f32 v86, v86
  v_exp_f32 v87, v87
  v_mfma_f32_32x32x16_bf16 v[96:111], v[52:55], v[28:31], v[96:111]
  v_exp_f32 v88, v88
  v_exp_f32 v89, v89
  v_exp_f32 v90, v90
  s_waitcnt vmcnt(1)
  v_smfmac_f32_32x32x32_bf16 v[112:127], v[56:59], v[80:87], v14
  v_exp_f32 v91, v91
  v_exp_f32 v92, v92
  v_exp_f32 v93, v93
  v_exp_f32 v94, v94
  v_exp_f32 v95, v95
  s_waitcnt vmcnt(0)
  v_cmp_ne_u32 s[76:77], s48, v2
  s_nop 0
  s_and_b32 s58, s76, 0xffff
  s_cbranch_scc0 L_kv2a_go
  s_mov_b64 exec, 0xffff
  s_mov_b32 s75, 0
L_kv2a_poll:
  buffer_load_dword v2, v3, s[36:39], 0 offen sc1
  s_add_u32 s75, s75, 1
  s_waitcnt vmcnt(0)
  v_cmp_ne_u32 s[76:77], s48, v2
  s_nop 0
  s_and_b32 s58, s76, 0xffff
  s_cbranch_scc0 L_kv2a_ok
  s_cmp_ge_u32 s75, 262144
  s_cbranch_scc1 L_kv2a_ok
  s_branch L_kv2a_poll
L_kv2a_ok:
  s_mov_b64 exec, -1
L_kv2a_go:
  buffer_load_dwordx4 v[64:67], v15, s[36:39], s65 offen offset:0 sc1
  buffer_load_dwordx4 v[68:71], v15, s[36:39], s65 offen offset:1024 sc1
  buffer_load_dwordx4 v[72:75], v15, s[36:39], s65 offen offset:2048 sc1
  buffer_load_dwordx4 v[76:79], v15, s[36:39], s65 offen offset:3072 sc1
  v_exp_f32 v96, v96
  v_exp_f32 v97, v97
  v_smfmac_f32_32x32x32_bf16 v[112:127], v[60:63], v[88:95], v14
  v_exp_f32 v98, v98
  v_exp_f32 v99, v99
  v_exp_f32 v100, v100
  v_mfma_f32_32x32x16_bf16 v[80:95], v[48:51], v[32:35], 0
  v_exp_f32 v101, v101
  v_exp_f32 v102, v102
  v_exp_f32 v103, v103
  v_mfma_f32_32x32x16_bf16 v[80:95], v[52:55], v[36:39], v[80:95]
  v_exp_f32 v104, v104
  v_exp_f32 v105, v105
  v_exp_f32 v106, v106
  v_smfmac_f32_32x32x32_bf16 v[128:143], v[56:59], v[96:103], v14
  v_exp_f32 v107, v107
  v_exp_f32 v108, v108
  v_exp_f32 v109, v109
  v_exp_f32 v110, v110
  v_exp_f32 v111, v111
  v_exp_f32 v80, v80
  v_exp_f32 v81, v81
  v_smfmac_f32_32x32x32_bf16 v[128:143], v[60:63], v[104:111], v14
  v_exp_f32 v82, v82
  v_exp_f32 v83, v83
  v_exp_f32 v84, v84
  v_mfma_f32_32x32x16_bf16 v[96:111], v[48:51], v[40:43], 0
  v_exp_f32 v85, v85
  v_exp_f32 v86, v86
  v_exp_f32 v87, v87
  v_mfma_f32_32x32x16_bf16 v[96:111], v[52:55], v[44:47], v[96:111]
  buffer_load_dwordx4 v[48:51], v15, s[36:39], s66 offen offset:0 sc1
  buffer_load_dwordx4 v[52:55], v15, s[36:39], s66 offen offset:1024 sc1
  v_exp_f32 v88, v88
  v_exp_f32 v89, v89
  v_exp_f32 v90, v90
  v_smfmac_f32_32x32x32_bf16 v[144:159], v[56:59], v[80:87], v14
  v_exp_f32 v91, v91
  v_exp_f32 v92, v92
  v_exp_f32 v93, v93
  v_exp_f32 v94, v94
  v_exp_f32 v95, v95
  v_exp_f32 v96, v96
  v_exp_f32 v97, v97
  v_smfmac_f32_32x32x32_bf16 v[144:159], v[60:63], v[88:95], v14
  v_exp_f32 v98, v98
  v_exp_f32 v99, v99
  v_exp_f32 v100, v100
  s_waitcnt vmcnt(4)
  v_mfma_f32_32x32x16_bf16 v[80:95], v[64:67], v[16:19], 0
  v_exp_f32 v101, v101
  v_exp_f32 v102, v102
  v_exp_f32 v103, v103
  v_mfma_f32_32x32x16_bf16 v[80:95], v[68:71], v[20:23], v[80:95]
  v_exp_f32 v104, v104
  v_exp_f32 v105, v105
  v_exp_f32 v106, v106
  v_smfmac_f32_32x32x32_bf16 v[160:175], v[56:59], v[96:103], v14
  v_exp_f32 v107, v107
  v_exp_f32 v108, v108
  v_exp_f32 v109, v109
  v_exp_f32 v110, v110
  v_exp_f32 v111, v111
  v_exp_f32 v80, v80
  v_exp_f32 v81, v81
  v_smfmac_f32_32x32x32_bf16 v[160:175], v[60:63], v[104:111], v14
  buffer_load_dwordx4 v[56:59], v15, s[36:39], s66 offen offset:2048 sc1
  buffer_load_dwordx4 v[60:63], v15, s[36:39], s66 offen offset:3072 sc1
  v_exp_f32 v82, v82
  v_exp_f32 v83, v83
  v_exp_f32 v84, v84
  v_mfma_f32_32x32x16_bf16 v[96:111], v[64:67], v[24:27], 0
  v_exp_f32 v85, v85
  v_exp_f32 v86, v86
  v_exp_f32 v87, v87
  v_mfma_f32_32x32x16_bf16 v[96:111], v[68:71], v[28:31], v[96:111]
  v_exp_f32 v88, v88
  v_exp_f32 v89, v89
  v_exp_f32 v90, v90
  s_waitcnt vmcnt(4)
  v_smfmac_f32_32x32x32_bf16 v[112:127], v[72:75], v[80:87], v14
  v_exp_f32 v91, v91
  v_exp_f32 v92, v92
  v_exp_f32 v93, v93
  v_exp_f32 v94, v94
  v_exp_f32 v95, v95
  v_exp_f32 v96, v96
  v_exp_f32 v97, v97
  v_smfmac_f32_32x32x32_bf16 v[112:127], v[76:79], v[88:95], v14
  v_exp_f32 v98, v98
  v_exp_f32 v99, v99
  v_exp_f32 v100, v100
  v_mfma_f32_32x32x16_bf16 v[80:95], v[64:67], v[32:35], 0
  v_exp_f32 v101, v101
  v_exp_f32 v102, v102
  v_exp_f32 v103, v103
  v_mfma_f32_32x32x16_bf16 v[80:95], v[68:71], v[36:39], v[80:95]
  v_exp_f32 v104, v104
  v_exp_f32 v105, v105
  v_exp_f32 v106, v106
  v_smfmac_f32_32x32x32_bf16 v[128:143], v[72:75], v[96:103], v14
  v_exp_f32 v107, v107
  v_exp_f32 v108, v108
  v_exp_f32 v109, v109
  v_exp_f32 v110, v110
  v_exp_f32 v111, v111
  v_exp_f32 v80, v80
  v_exp_f32 v81, v81
  v_smfmac_f32_32x32x32_bf16 v[128:143], v[76:79], v[104:111], v14
  v_exp_f32 v82, v82
  v_exp_f32 v83, v83
  v_exp_f32 v84, v84
  v_mfma_f32_32x32x16_bf16 v[96:111], v[64:67], v[40:43], 0
  v_exp_f32 v85, v85
  v_exp_f32 v86, v86
  v_exp_f32 v87, v87
  v_mfma_f32_32x32x16_bf16 v[96:111], v[68:71], v[44:47], v[96:111]
  buffer_load_dwordx4 v[64:67], v15, s[36:39], s67 offen offset:0 sc1
  buffer_load_dwordx4 v[68:71], v15, s[36:39], s67 offen offset:1024 sc1
  v_exp_f32 v88, v88
  v_exp_f32 v89, v89
  v_exp_f32 v90, v90
  v_smfmac_f32_32x32x32_bf16 v[144:159], v[72:75], v[80:87], v14
  v_exp_f32 v91, v91
  v_exp_f32 v92, v92
  v_exp_f32 v93, v93
  v_exp_f32 v94, v94
  v_exp_f32 v95, v95
  v_exp_f32 v96, v96
  v_exp_f32 v97, v97
  v_smfmac_f32_32x32x32_bf16 v[144:159], v[76:79], v[88:95], v14
  v_exp_f32 v98, v98
  v_exp_f32 v99, v99
  v_exp_f32 v100, v100
  s_waitcnt vmcnt(4)
  v_mfma_f32_32x32x16_bf16 v[80:95], v[48:51], v[16:19], 0
  v_exp_f32 v101, v101
  v_exp_f32 v102, v102
  v_exp_f32 v103, v103
  v_mfma_f32_32x32x16_bf16 v[80:95], v[52:55], v[20:23], v[80:95]
  v_exp_f32 v104, v104
  v_exp_f32 v105, v105
  v_exp_f32 v106, v106
  v_smfmac_f32_32x32x32_bf16 v[160:175], v[72:75], v[96:103], v14
  v_exp_f32 v107, v107
  v_exp_f32 v108, v108
  v_exp_f32 v109, v109
  v_exp_f32 v110, v110
  v_exp_f32 v111, v111
  v_exp_f32 v80, v80
  v_exp_f32 v81, v81
  v_smfmac_f32_32x32x32_bf16 v[160:175], v[76:79], v[104:111], v14
  buffer_load_dwordx4 v[72:75], v15, s[36:39], s67 offen offset:2048 sc1
  buffer_load_dwordx4 v[76:79], v15, s[36:39], s67 offen offset:3072 sc1
  v_exp_f32 v82, v82
  v_exp_f32 v83, v83
  v_exp_f32 v84, v84
  v_mfma_f32_32x32x16_bf16 v[96:111], v[48:51], v[24:27], 0
  v_exp_f32 v85, v85
  v_exp_f32 v86, v86
  v_exp_f32 v87, v87
  v_mfma_f32_32x32x16_bf16 v[96:111], v[52:55], v[28:31], v[96:111]
  v_exp_f32 v88, v88
  v_exp_f32 v89, v89
  v_exp_f32 v90, v90
  s_waitcnt vmcnt(4)
  v_smfmac_f32_32x32x32_bf16 v[112:127], v[56:59], v[80:87], v14
  v_exp_f32 v91, v91
  v_exp_f32 v92, v92
  v_exp_f32 v93, v93
  v_exp_f32 v94, v94
  v_exp_f32 v95, v95
  v_exp_f32 v96, v96
  v_exp_f32 v97, v97
  v_smfmac_f32_32x32x32_bf16 v[112:127], v[60:63], v[88:95], v14
  v_exp_f32 v98, v98
  v_exp_f32 v99, v99
  v_exp_f32 v100, v100
  v_mfma_f32_32x32x16_bf16 v[80:95], v[48:51], v[32:35], 0
  v_exp_f32 v101, v101
  v_exp_f32 v102, v102
  v_exp_f32 v103, v103
  v_mfma_f32_32x32x16_bf16 v[80:95], v[52:55], v[36:39], v[80:95]
  v_exp_f32 v104, v104
  v_exp_f32 v105, v105
  v_exp_f32 v106, v106
  v_smfmac_f32_32x32x32_bf16 v[128:143], v[56:59], v[96:103], v14
  v_exp_f32 v107, v107
  v_exp_f32 v108, v108
  v_exp_f32 v109, v109
  v_exp_f32 v110, v110
  v_exp_f32 v111, v111
  v_exp_f32 v80, v80
  v_exp_f32 v81, v81
  v_smfmac_f32_32x32x32_bf16 v[128:143], v[60:63], v[104:111], v14
  v_exp_f32 v82, v82
  v_exp_f32 v83, v83
  v_exp_f32 v84, v84
  v_mfma_f32_32x32x16_bf16 v[96:111], v[48:51], v[40:43], 0
  v_exp_f32 v85, v85
  v_exp_f32 v86, v86
  v_exp_f32 v87, v87
  v_mfma_f32_32x32x16_bf16 v[96:111], v[52:55], v[44:47], v[96:111]
  buffer_load_dwordx4 v[48:51], v15, s[36:39], s68 offen offset:0 sc1
  buffer_load_dwordx4 v[52:55], v15, s[36:39], s68 offen offset:1024 sc1
  v_exp_f32 v88, v88
  v_exp_f32 v89, v89
  v_exp_f32 v90, v90
  v_smfmac_f32_32x32x32_bf16 v[144:159], v[56:59], v[80:87], v14
  v_exp_f32 v91, v91
  v_exp_f32 v92, v92
  v_exp_f32 v93, v93
  v_exp_f32 v94, v94
  v_exp_f32 v95, v95
  v_exp_f32 v96, v96
  v_exp_f32 v97, v97
  v_smfmac_f32_32x32x32_bf16 v[144:159], v[60:63], v[88:95], v14
  v_exp_f32 v98, v98
  v_exp_f32 v99, v99
  v_exp_f32 v100, v100
  s_waitcnt vmcnt(4)
  v_mfma_f32_32x32x16_bf16 v[80:95], v[64:67], v[16:19], 0
  v_exp_f32 v101, v101
  v_exp_f32 v102, v102
  v_exp_f32 v103, v103
  v_mfma_f32_32x32x16_bf16 v[80:95], v[68:71], v[20:23], v[80:95]
  v_exp_f32 v104, v104
  v_exp_f32 v105, v105
  v_exp_f32 v106, v106
  v_smfmac_f32_32x32x32_bf16 v[160:175], v[56:59], v[96:103], v14
  v_exp_f32 v107, v107
  v_exp_f32 v108, v108
  v_exp_f32 v109, v109
  v_exp_f32 v110, v110
  v_exp_f32 v111, v111
  v_exp_f32 v80, v80
  v_exp_f32 v81, v81
  v_smfmac_f32_32x32x32_bf16 v[160:175], v[60:63], v[104:111], v14
  buffer_load_dwordx4 v[56:59], v15, s[36:39], s68 offen offset:2048 sc1
  buffer_load_dwordx4 v[60:63], v15, s[36:39], s68 offen offset:3072 sc1
  v_exp_f32 v82, v82
  v_exp_f32 v83, v83
  v_exp_f32 v84, v84
  v_mfma_f32_32x32x16_bf16 v[96:111], v[64:67], v[24:27], 0
  v_exp_f32 v85, v85
  v_exp_f32 v86, v86
  v_exp_f32 v87, v87
  v_mfma_f32_32x32x16_bf16 v[96:111], v[68:71], v[28:31], v[96:111]
  v_exp_f32 v88, v88
  v_exp_f32 v89, v89
  v_exp_f32 v90, v90
  s_waitcnt vmcnt(4)
  v_smfmac_f32_32x32x32_bf16 v[112:127], v[72:75], v[80:87], v14
  v_exp_f32 v91, v91
  v_exp_f32 v92, v92
  v_exp_f32 v93, v93
  v_exp_f32 v94, v94
  v_exp_f32 v95, v95
  v_exp_f32 v96, v96
  v_exp_f32 v97, v97
  v_smfmac_f32_32x32x32_bf16 v[112:127], v[76:79], v[88:95], v14
  v_exp_f32 v98, v98
  v_exp_f32 v99, v99
  v_exp_f32 v100, v100
  v_mfma_f32_32x32x16_bf16 v[80:95], v[64:67], v[32:35], 0
  v_exp_f32 v101, v101
  v_exp_f32 v102, v102
  v_exp_f32 v103, v103
  v_mfma_f32_32x32x16_bf16 v[80:95], v[68:71], v[36:39], v[80:95]
  v_exp_f32 v104, v104
  v_exp_f32 v105, v105
  v_exp_f32 v106, v106
  v_smfmac_f32_32x32x32_bf16 v[128:143], v[72:75], v[96:103], v14
  v_exp_f32 v107, v107
  v_exp_f32 v108, v108
  v_exp_f32 v109, v109
  v_exp_f32 v110, v110
  v_exp_f32 v111, v111
  v_exp_f32 v80, v80
  v_exp_f32 v81, v81
  v_smfmac_f32_32x32x32_bf16 v[128:143], v[76:79], v[104:111], v14
  v_exp_f32 v82, v82
  v_exp_f32 v83, v83
  v_exp_f32 v84, v84
  v_mfma_f32_32x32x16_bf16 v[96:111], v[64:67], v[40:43], 0
  v_exp_f32 v85, v85
  v_exp_f32 v86, v86
  v_exp_f32 v87, v87
  v_mfma_f32_32x32x16_bf16 v[96:111], v[68:71], v[44:47], v[96:111]
  buffer_load_dwordx4 v[64:67], v15, s[36:39], s69 offen offset:0 sc1
  buffer_load_dwordx4 v[68:71], v15, s[36:39], s69 offen offset:1024 sc1
  v_exp_f32 v88, v88
  v_exp_f32 v89, v89
  v_exp_f32 v90, v90
  v_smfmac_f32_32x32x32_bf16 v[144:159], v[72:75], v[80:87], v14
  v_exp_f32 v91, v91
  v_exp_f32 v92, v92
  v_exp_f32 v93, v93
  v_exp_f32 v94, v94
  v_exp_f32 v95, v95
  v_exp_f32 v96, v96
  v_exp_f32 v97, v97
  v_smfmac_f32_32x32x32_bf16 v[144:159], v[76:79], v[88:95], v14
  v_exp_f32 v98, v98
  v_exp_f32 v99, v99
  v_exp_f32 v100, v100
  s_waitcnt vmcnt(4)
  v_mfma_f32_32x32x16_bf16 v[80:95], v[48:51], v[16:19], 0
  v_exp_f32 v101, v101
  v_exp_f32 v102, v102
  v_exp_f32 v103, v103
  v_mfma_f32_32x32x16_bf16 v[80:95], v[52:55], v[20:23], v[80:95]
  v_exp_f32 v104, v104
  v_exp_f32 v105, v105
  v_exp_f32 v106, v106
  v_smfmac_f32_32x32x32_bf16 v[160:175], v[72:75], v[96:103], v14
  v_exp_f32 v107, v107
  v_exp_f32 v108, v108
  v_exp_f32 v109, v109
  v_exp_f32 v110, v110
  v_exp_f32 v111, v111
  v_exp_f32 v80, v80
  v_exp_f32 v81, v81
  v_smfmac_f32_32x32x32_bf16 v[160:175], v[76:79], v[104:111], v14
  buffer_load_dwordx4 v[72:75], v15, s[36:39], s69 offen offset:2048 sc1
  buffer_load_dwordx4 v[76:79], v15, s[36:39], s69 offen offset:3072 sc1
  v_exp_f32 v82, v82
  v_exp_f32 v83, v83
  v_exp_f32 v84, v84
  v_mfma_f32_32x32x16_bf16 v[96:111], v[48:51], v[24:27], 0
  v_exp_f32 v85, v85
  v_exp_f32 v86, v86
  v_exp_f32 v87, v87
  v_mfma_f32_32x32x16_bf16 v[96:111], v[52:55], v[28:31], v[96:111]
  v_exp_f32 v88, v88
  v_exp_f32 v89, v89
  v_exp_f32 v90, v90
  s_waitcnt vmcnt(4)
  v_smfmac_f32_32x32x32_bf16 v[112:127], v[56:59], v[80:87], v14
  v_exp_f32 v91, v91
  v_exp_f32 v92, v92
  v_exp_f32 v93, v93
  v_exp_f32 v94, v94
  v_exp_f32 v95, v95
  v_exp_f32 v96, v96
  v_exp_f32 v97, v97
  v_smfmac_f32_32x32x32_bf16 v[112:127], v[60:63], v[88:95], v14
  v_exp_f32 v98, v98
  v_exp_f32 v99, v99
  v_exp_f32 v100, v100
  v_mfma_f32_32x32x16_bf16 v[80:95], v[48:51], v[32:35], 0
  v_exp_f32 v101, v101
  v_exp_f32 v102, v102
  v_exp_f32 v103, v103
  v_mfma_f32_32x32x16_bf16 v[80:95], v[52:55], v[36:39], v[80:95]
  v_exp_f32 v104, v104
  v_exp_f32 v105, v105
  v_exp_f32 v106, v106
  v_smfmac_f32_32x32x32_bf16 v[128:143], v[56:59], v[96:103], v14
  v_exp_f32 v107, v107
  v_exp_f32 v108, v108
  v_exp_f32 v109, v109
  v_exp_f32 v110, v110
  v_exp_f32 v111, v111
  v_exp_f32 v80, v80
  v_exp_f32 v81, v81
  v_smfmac_f32_32x32x32_bf16 v[128:143], v[60:63], v[104:111], v14
  v_exp_f32 v82, v82
  v_exp_f32 v83, v83
  v_exp_f32 v84, v84
  v_mfma_f32_32x32x16_bf16 v[96:111], v[48:51], v[40:43], 0
  v_exp_f32 v85, v85
  v_exp_f32 v86, v86
  v_exp_f32 v87, v87
  v_mfma_f32_32x32x16_bf16 v[96:111], v[52:55], v[44:47], v[96:111]
  buffer_load_dwordx4 v[48:51], v15, s[36:39], s70 offen offset:0 sc1
  buffer_load_dwordx4 v[52:55], v15, s[36:39], s70 offen offset:1024 sc1
  v_exp_f32 v88, v88
  v_exp_f32 v89, v89
  v_exp_f32 v90, v90
  v_smfmac_f32_32x32x32_bf16 v[144:159], v[56:59], v[80:87], v14
  v_exp_f32 v91, v91
  v_exp_f32 v92, v92
  v_exp_f32 v93, v93
  v_exp_f32 v94, v94
  v_exp_f32 v95, v95
  v_exp_f32 v96, v96
  v_exp_f32 v97, v97
  v_smfmac_f32_32x32x32_bf16 v[144:159], v[60:63], v[88:95], v14
  v_exp_f32 v98, v98
  v_exp_f32 v99, v99
  v_exp_f32 v100, v100
  s_waitcnt vmcnt(4)
  v_mfma_f32_32x32x16_bf16 v[80:95], v[64:67], v[16:19], 0
  v_exp_f32 v101, v101
  v_exp_f32 v102, v102
  v_exp_f32 v103, v103
  v_mfma_f32_32x32x16_bf16 v[80:95], v[68:71], v[20:23], v[80:95]
  v_exp_f32 v104, v104
  v_exp_f32 v105, v105
  v_exp_f32 v106, v106
  v_smfmac_f32_32x32x32_bf16 v[160:175], v[56:59], v[96:103], v14
  v_exp_f32 v107, v107
  v_exp_f32 v108, v108
  v_exp_f32 v109, v109
  v_exp_f32 v110, v110
  v_exp_f32 v111, v111
  v_exp_f32 v80, v80
  v_exp_f32 v81, v81
  v_smfmac_f32_32x32x32_bf16 v[160:175], v[60:63], v[104:111], v14
  buffer_load_dwordx4 v[56:59], v15, s[36:39], s70 offen offset:2048 sc1
  buffer_load_dwordx4 v[60:63], v15, s[36:39], s70 offen offset:3072 sc1
  v_exp_f32 v82, v82
  v_exp_f32 v83, v83
  v_exp_f32 v84, v84
  v_mfma_f32_32x32x16_bf16 v[96:111], v[64:67], v[24:27], 0
  v_exp_f32 v85, v85
  v_exp_f32 v86, v86
  v_exp_f32 v87, v87
  v_mfma_f32_32x32x16_bf16 v[96:111], v[68:71], v[28:31], v[96:111]
  v_exp_f32 v88, v88
  v_exp_f32 v89, v89
  v_exp_f32 v90, v90
  s_waitcnt vmcnt(4)
  v_smfmac_f32_32x32x32_bf16 v[112:127], v[72:75], v[80:87], v14
  v_exp_f32 v91, v91
  v_exp_f32 v92, v92
  v_exp_f32 v93, v93
  v_exp_f32 v94, v94
  v_exp_f32 v95, v95
  v_exp_f32 v96, v96
  v_exp_f32 v97, v97
  v_smfmac_f32_32x32x32_bf16 v[112:127], v[76:79], v[88:95], v14
  v_exp_f32 v98, v98
  v_exp_f32 v99, v99
  v_exp_f32 v100, v100
  v_mfma_f32_32x32x16_bf16 v[80:95], v[64:67], v[32:35], 0
  v_exp_f32 v101, v101
  v_exp_f32 v102, v102
  v_exp_f32 v103, v103
  v_mfma_f32_32x32x16_bf16 v[80:95], v[68:71], v[36:39], v[80:95]
  v_exp_f32 v104, v104
  v_exp_f32 v105, v105
  v_exp_f32 v106, v106
  v_smfmac_f32_32x32x32_bf16 v[128:143], v[72:75], v[96:103], v14
  v_exp_f32 v107, v107
  v_exp_f32 v108, v108
  v_exp_f32 v109, v109
  v_exp_f32 v110, v110
  v_exp_f32 v111, v111
  v_exp_f32 v80, v80
  v_exp_f32 v81, v81
  v_smfmac_f32_32x32x32_bf16 v[128:143], v[76:79], v[104:111], v14
  v_exp_f32 v82, v82
  v_exp_f32 v83, v83
  v_exp_f32 v84, v84
  v_mfma_f32_32x32x16_bf16 v[96:111], v[64:67], v[40:43], 0
  v_exp_f32 v85, v85
  v_exp_f32 v86, v86
  v_exp_f32 v87, v87
  v_mfma_f32_32x32x16_bf16 v[96:111], v[68:71], v[44:47], v[96:111]
  buffer_load_dwordx4 v[64:67], v15, s[36:39], s71 offen offset:0 sc1
  buffer_load_dwordx4 v[68:71], v15, s[36:39], s71 offen offset:1024 sc1
  v_exp_f32 v88, v88
  v_exp_f32 v89, v89
  v_exp_f32 v90, v90
  v_smfmac_f32_32x32x32_bf16 v[144:159], v[72:75], v[80:87], v14
  v_exp_f32 v91, v91
  v_exp_f32 v92, v92
  v_exp_f32 v93, v93
  v_exp_f32 v94, v94
  v_exp_f32 v95, v95
  v_exp_f32 v96, v96
  v_exp_f32 v97, v97
  v_smfmac_f32_32x32x32_bf16 v[144:159], v[76:79], v[88:95], v14
  v_exp_f32 v98, v98
  v_exp_f32 v99, v99
  v_exp_f32 v100, v100
  s_waitcnt vmcnt(4)
  v_mfma_f32_32x32x16_bf16 v[80:95], v[48:51], v[16:19], 0
  v_exp_f32 v101, v101
  v_exp_f32 v102, v102
  v_exp_f32 v103, v103
  v_mfma_f32_32x32x16_bf16 v[80:95], v[52:55], v[20:23], v[80:95]
  v_exp_f32 v104, v104
  v_exp_f32 v105, v105
  v_exp_f32 v106, v106
  v_smfmac_f32_32x32x32_bf16 v[160:175], v[72:75], v[96:103], v14
  v_exp_f32 v107, v107
  v_exp_f32 v108, v108
  v_exp_f32 v109, v109
  v_exp_f32 v110, v110
  v_exp_f32 v111, v111
  v_exp_f32 v80, v80
  v_exp_f32 v81, v81
  v_smfmac_f32_32x32x32_bf16 v[160:175], v[76:79], v[104:111], v14
  buffer_load_dwordx4 v[72:75], v15, s[36:39], s71 offen offset:2048 sc1
  buffer_load_dwordx4 v[76:79], v15, s[36:39], s71 offen offset:3072 sc1
  v_exp_f32 v82, v82
  v_exp_f32 v83, v83
  v_exp_f32 v84, v84
  v_mfma_f32_32x32x16_bf16 v[96:111], v[48:51], v[24:27], 0
  v_exp_f32 v85, v85
  v_exp_f32 v86, v86
  v_exp_f32 v87, v87
  v_mfma_f32_32x32x16_bf16 v[96:111], v[52:55], v[28:31], v[96:111]
  v_exp_f32 v88, v88
  v_exp_f32 v89, v89
  v_exp_f32 v90, v90
  s_waitcnt vmcnt(4)
  v_smfmac_f32_32x32x32_bf16 v[112:127], v[56:59], v[80:87], v14
  v_exp_f32 v91, v91
  v_exp_f32 v92, v92
  v_exp_f32 v93, v93
  v_exp_f32 v94, v94
  v_exp_f32 v95, v95
  v_exp_f32 v96, v96
  v_exp_f32 v97, v97
  v_smfmac_f32_32x32x32_bf16 v[112:127], v[60:63], v[88:95], v14
  v_exp_f32 v98, v98
  v_exp_f32 v99, v99
  v_exp_f32 v100, v100
  v_mfma_f32_32x32x16_bf16 v[80:95], v[48:51], v[32:35], 0
  v_exp_f32 v101, v101
  v_exp_f32 v102, v102
  v_exp_f32 v103, v103
  v_mfma_f32_32x32x16_bf16 v[80:95], v[52:55], v[36:39], v[80:95]
  v_exp_f32 v104, v104
  v_exp_f32 v105, v105
  v_exp_f32 v106, v106
  v_smfmac_f32_32x32x32_bf16 v[128:143], v[56:59], v[96:103], v14
  v_exp_f32 v107, v107
  v_exp_f32 v108, v108
  v_exp_f32 v109, v109
  v_exp_f32 v110, v110
  v_exp_f32 v111, v111
  v_exp_f32 v80, v80
  v_exp_f32 v81, v81
  v_smfmac_f32_32x32x32_bf16 v[128:143], v[60:63], v[104:111], v14
  v_exp_f32 v82, v82
  v_exp_f32 v83, v83
  v_exp_f32 v84, v84
  v_mfma_f32_32x32x16_bf16 v[96:111], v[48:51], v[40:43], 0
  v_exp_f32 v85, v85
  v_exp_f32 v86, v86
  v_exp_f32 v87, v87
  v_mfma_f32_32x32x16_bf16 v[96:111], v[52:55], v[44:47], v[96:111]
  v_exp_f32 v88, v88
  v_exp_f32 v89, v89
  v_exp_f32 v90, v90
  v_smfmac_f32_32x32x32_bf16 v[144:159], v[56:59], v[80:87], v14
  v_exp_f32 v91, v91
  v_exp_f32 v92, v92
  v_exp_f32 v93, v93
  v_exp_f32 v94, v94
  v_exp_f32 v95, v95
  v_exp_f32 v96, v96
  v_exp_f32 v97, v97
  v_smfmac_f32_32x32x32_bf16 v[144:159], v[60:63], v[88:95], v14
  v_exp_f32 v98, v98
  v_exp_f32 v99, v99
  v_exp_f32 v100, v100
  s_waitcnt vmcnt(2)
  v_mfma_f32_32x32x16_bf16 v[80:95], v[64:67], v[16:19], 0
  v_exp_f32 v101, v101
  v_exp_f32 v102, v102
  v_exp_f32 v103, v103
  v_mfma_f32_32x32x16_bf16 v[80:95], v[68:71], v[20:23], v[80:95]
  v_exp_f32 v104, v104
  v_exp_f32 v105, v105
  v_exp_f32 v106, v106
  v_smfmac_f32_32x32x32_bf16 v[160:175], v[56:59], v[96:103], v14
  v_exp_f32 v107, v107
  v_exp_f32 v108, v108
  v_exp_f32 v109, v109
  v_exp_f32 v110, v110
  v_exp_f32 v111, v111
  v_exp_f32 v80, v80
  v_exp_f32 v81, v81
  v_smfmac_f32_32x32x32_bf16 v[160:175], v[60:63], v[104:111], v14
  v_exp_f32 v82, v82
  v_exp_f32 v83, v83
  v_exp_f32 v84, v84
  v_mfma_f32_32x32x16_bf16 v[96:111], v[64:67], v[24:27], 0
  v_exp_f32 v85, v85
  v_exp_f32 v86, v86
  v_exp_f32 v87, v87
  v_mfma_f32_32x32x16_bf16 v[96:111], v[68:71], v[28:31], v[96:111]
  v_exp_f32 v88, v88
  v_exp_f32 v89, v89
  v_exp_f32 v90, v90
  s_waitcnt vmcnt(0)
  v_smfmac_f32_32x32x32_bf16 v[112:127], v[72:75], v[80:87], v14
  v_exp_f32 v91, v91
  v_exp_f32 v92, v92
  v_exp_f32 v93, v93
  v_exp_f32 v94, v94
  v_exp_f32 v95, v95
  v_exp_f32 v96, v96
  v_exp_f32 v97, v97
  v_smfmac_f32_32x32x32_bf16 v[112:127], v[76:79], v[88:95], v14
  v_exp_f32 v98, v98
  v_exp_f32 v99, v99
  v_exp_f32 v100, v100
  v_mfma_f32_32x32x16_bf16 v[80:95], v[64:67], v[32:35], 0
  v_exp_f32 v101, v101
  v_exp_f32 v102, v102
  v_exp_f32 v103, v103
  v_mfma_f32_32x32x16_bf16 v[80:95], v[68:71], v[36:39], v[80:95]
  v_exp_f32 v104, v104
  v_exp_f32 v105, v105
  v_exp_f32 v106, v106
  v_smfmac_f32_32x32x32_bf16 v[128:143], v[72:75], v[96:103], v14
  v_exp_f32 v107, v107
  v_exp_f32 v108, v108
  v_exp_f32 v109, v109
  v_exp_f32 v110, v110
  v_exp_f32 v111, v111
  v_exp_f32 v80, v80
  v_exp_f32 v81, v81
  v_smfmac_f32_32x32x32_bf16 v[128:143], v[76:79], v[104:111], v14
  v_exp_f32 v82, v82
  v_exp_f32 v83, v83
  v_exp_f32 v84, v84
  v_mfma_f32_32x32x16_bf16 v[96:111], v[64:67], v[40:43], 0
  v_exp_f32 v85, v85
  v_exp_f32 v86, v86
  v_exp_f32 v87, v87
  v_mfma_f32_32x32x16_bf16 v[96:111], v[68:71], v[44:47], v[96:111]
  v_exp_f32 v88, v88
  v_exp_f32 v89, v89
  v_exp_f32 v90, v90
  v_smfmac_f32_32x32x32_bf16 v[144:159], v[72:75], v[80:87], v14
  v_exp_f32 v91, v91
  v_exp_f32 v92, v92
  v_exp_f32 v93, v93
  v_exp_f32 v94, v94
  v_exp_f32 v95, v95
  v_exp_f32 v96, v96
  v_exp_f32 v97, v97
  v_smfmac_f32_32x32x32_bf16 v[144:159], v[76:79], v[88:95], v14
  v_exp_f32 v98, v98
  v_exp_f32 v99, v99
  v_exp_f32 v100, v100
  v_exp_f32 v101, v101
  v_exp_f32 v102, v102
  v_exp_f32 v103, v103
  v_exp_f32 v104, v104
  v_exp_f32 v105, v105
  v_exp_f32 v106, v106
  v_smfmac_f32_32x32x32_bf16 v[160:175], v[72:75], v[96:103], v14
  v_exp_f32 v107, v107
  v_exp_f32 v108, v108
  v_exp_f32 v109, v109
  v_exp_f32 v110, v110
  v_exp_f32 v111, v111
  s_nop 1
  v_smfmac_f32_32x32x32_bf16 v[160:175], v[76:79], v[104:111], v14
L_reda:
  ds_write_b128 v4, v[112:115] offset:0
  ds_write_b128 v4, v[116:119] offset:1024
  ds_write_b128 v4, v[120:123] offset:2048
  ds_write_b128 v4, v[124:127] offset:3072
  ds_write_b128 v5, v[128:131] offset:4096
  ds_write_b128 v5, v[132:135] offset:5120
  ds_write_b128 v5, v[136:139] offset:6144
  ds_write_b128 v5, v[140:143] offset:7168
  ds_write_b128 v6, v[144:147] offset:8192
  ds_write_b128 v6, v[148:151] offset:9216
  ds_write_b128 v6, v[152:155] offset:10240
  ds_write_b128 v6, v[156:159] offset:11264
  s_lshl_b32 s58, s50, 2
  s_add_u32 s58, s58, s54
  s_mul_i32 s58, s58, 40960
  s_mul_i32 s59, s51, 1280
  s_add_u32 s58, s58, s59
  s_add_u32 s58, s58, 1638400
  v_and_b32 v2, 15, v1
  v_lshlrev_b32 v2, 7, v2
  v_lshrrev_b32 v3, 4, v1
  v_mul_u32_u24 v3, 20480, v3
  v_add_u32 v2, v2, v3
  s_mov_b64 exec, 0x03ff03ff
  buffer_load_dword v12, v2, s[36:39], s58 offen sc1
  s_lshl_b32 s58, s57, 3
  s_lshl_b32 s59, s53, 2
  s_add_u32 s58, s58, s59
  s_add_u32 s58, s58, s54
  s_lshl_b32 s58, s58, 9
  s_add_u32 s58, s58, 131072
  s_mov_b64 exec, 15
  s_mov_b64 exec, -1
  s_cmp_lg_u32 s9, 0
  s_cbranch_scc1 L_red_noearly
  s_add_u32 s58, s83, 143360
  buffer_load_dwordx4 v[16:19], v15, s[36:39], s58 offen offset:0 sc1
  buffer_load_dwordx4 v[20:23], v15, s[36:39], s58 offen offset:1024 sc1
  buffer_load_dwordx4 v[24:27], v15, s[36:39], s58 offen offset:2048 sc1
  buffer_load_dwordx4 v[28:31], v15, s[36:39], s58 offen offset:3072 sc1
  s_add_u32 s58, s83, 172032
  buffer_load_dwordx4 v[32:35], v15, s[36:39], s58 offen offset:0 sc1
  buffer_load_dwordx4 v[36:39], v15, s[36:39], s58 offen offset:1024 sc1
  buffer_load_dwordx4 v[40:43], v15, s[36:39], s58 offen offset:2048 sc1
  buffer_load_dwordx4 v[44:47], v15, s[36:39], s58 offen offset:3072 sc1
L_red_noearly:
  s_waitcnt lgkmcnt(0)
  s_barrier
  s_setprio 2
  s_cmp_lg_u32 s9, 0
  s_cbranch_scc1 L_red_other
  ds_read_b128 v[112:115], v7 offset:0
  ds_read_b128 v[116:119], v7 offset:1024
  ds_read_b128 v[120:123], v7 offset:2048
  ds_read_b128 v[124:127], v7 offset:3072
  ds_read_b128 v[128:131], v7 offset:4096
  ds_read_b128 v[132:135], v7 offset:5120
  ds_read_b128 v[136:139], v7 offset:6144
  ds_read_b128 v[140:143], v7 offset:7168
  ds_read_b128 v[144:147], v7 offset:8192
  ds_read_b128 v[148:151], v7 offset:9216
  ds_read_b128 v[152:155], v7 offset:10240
  ds_read_b128 v[156:159], v7 offset:11264
  s_add_u32 s58, s83, 200704
  buffer_load_dwordx4 v[48:51], v15, s[36:39], s58 offen offset:0 sc1
  s_waitcnt lgkmcnt(11)
  v_add_f32 v160, v160, v112
  v_add_f32 v161, v161, v113
  buffer_load_dwordx4 v[52:55], v15, s[36:39], s58 offen offset:1024 sc1
  v_add_f32 v162, v162, v114
  v_add_f32 v163, v163, v115
  buffer_load_dwordx4 v[56:59], v15, s[36:39], s58 offen offset:2048 sc1
  s_waitcnt lgkmcnt(10)
  v_add_f32 v164, v164, v116
  v_add_f32 v165, v165, v117
  buffer_load_dwordx4 v[60:63], v15, s[36:39], s58 offen offset:3072 sc1
  v_add_f32 v166, v166, v118
  v_add_f32 v167, v167, v119
  s_add_u32 s58, s83, 229376
  buffer_load_dwordx4 v[64:67], v15, s[36:39], s58 offen offset:0 sc1
  s_waitcnt lgkmcnt(9)
  v_add_f32 v168, v168, v120
  v_add_f32 v169, v169, v121
  buffer_load_dwordx4 v[68:71], v15, s[36:39], s58 offen offset:1024 sc1
  v_add_f32 v170, v170, v122
  v_add_f32 v171, v171, v123
  buffer_load_dwordx4 v[72:75], v15, s[36:39], s58 offen offset:2048 sc1
  s_waitcnt lgkmcnt(8)
  v_add_f32 v172, v172, v124
  v_add_f32 v173, v173, v125
  buffer_load_dwordx4 v[76:79], v15, s[36:39], s58 offen offset:3072 sc1
  v_add_f32 v174, v174, v126
  v_add_f32 v175, v175, v127
  s_add_u32 s58, s83, 258048
  buffer_load_dwordx4 v[80:83], v15, s[36:39], s58 offen offset:0 sc1
  s_waitcnt lgkmcnt(7)
  v_add_f32 v160, v160, v128
  v_add_f32 v161, v161, v129
  buffer_load_dwordx4 v[84:87], v15, s[36:39], s58 offen offset:1024 sc1
  v_add_f32 v162, v162, v130
  v_add_f32 v163, v163, v131
  buffer_load_dwordx4 v[88:91], v15, s[36:39], s58 offen offset:2048 sc1
  s_waitcnt lgkmcnt(6)
  v_add_f32 v164, v164, v132
  v_add_f32 v165, v165, v133
  buffer_load_dwordx4 v[92:95], v15, s[36:39], s58 offen offset:3072 sc1
  v_add_f32 v166, v166, v134
  v_add_f32 v167, v167, v135
  s_add_u32 s58, s83, 286720
  buffer_load_dwordx4 v[96:99], v15, s[36:39], s58 offen offset:0 sc1
  s_waitcnt lgkmcnt(5)
  v_add_f32 v168, v168, v136
  v_add_f32 v169, v169, v137
  buffer_load_dwordx4 v[100:103], v15, s[36:39], s58 offen offset:1024 sc1
  v_add_f32 v170, v170, v138
  v_add_f32 v171, v171, v139
  buffer_load_dwordx4 v[104:107], v15, s[36:39], s58 offen offset:2048 sc1
  s_waitcnt lgkmcnt(4)
  v_add_f32 v172, v172, v140
  v_add_f32 v173, v173, v141
  buffer_load_dwordx4 v[108:111], v15, s[36:39], s58 offen offset:3072 sc1
  v_add_f32 v174, v174, v142
  v_add_f32 v175, v175, v143
  s_waitcnt lgkmcnt(3)
  v_add_f32 v160, v160, v144
  v_add_f32 v161, v161, v145
  v_add_f32 v162, v162, v146
  v_add_f32 v163, v163, v147
  s_waitcnt lgkmcnt(2)
  v_add_f32 v164, v164, v148
  v_add_f32 v165, v165, v149
  v_add_f32 v166, v166, v150
  v_add_f32 v167, v167, v151
  s_waitcnt lgkmcnt(1)
  v_add_f32 v168, v168, v152
  v_add_f32 v169, v169, v153
  v_add_f32 v170, v170, v154
  v_add_f32 v171, v171, v155
  s_waitcnt lgkmcnt(0)
  v_add_f32 v172, v172, v156
  v_add_f32 v173, v173, v157
  v_add_f32 v174, v174, v158
  v_add_f32 v175, v175, v159
  s_setprio 0
  s_lshl_b32 s60, s54, 14
  s_add_u32 m0, s60, 0
  s_add_u32 s58, s83, 315392
  buffer_load_dwordx4 v15, s[36:39], s58 offen offset:0 sc1 lds
  buffer_load_dwordx4 v15, s[36:39], s58 offen offset:1024 sc1 lds
  buffer_load_dwordx4 v15, s[36:39], s58 offen offset:2048 sc1 lds
  buffer_load_dwordx4 v15, s[36:39], s58 offen offset:3072 sc1 lds
  s_add_u32 m0, s60, 4096
  s_add_u32 s58, s83, 344064
  buffer_load_dwordx4 v15, s[36:39], s58 offen offset:0 sc1 lds
  buffer_load_dwordx4 v15, s[36:39], s58 offen offset:1024 sc1 lds
  buffer_load_dwordx4 v15, s[36:39], s58 offen offset:2048 sc1 lds
  buffer_load_dwordx4 v15, s[36:39], s58 offen offset:3072 sc1 lds
  s_add_u32 m0, s60, 8192
  s_add_u32 s58, s83, 372736
  buffer_load_dwordx4 v15, s[36:39], s58 offen offset:0 sc1 lds
  buffer_load_dwordx4 v15, s[36:39], s58 offen offset:1024 sc1 lds
  buffer_load_dwordx4 v15, s[36:39], s58 offen offset:2048 sc1 lds
  buffer_load_dwordx4 v15, s[36:39], s58 offen offset:3072 sc1 lds
  s_mov_b32 s40, s12
  s_mov_b32 s41, s13
  s_mov_b32 s42, 896
  s_mov_b32 s43, 0x20000
  s_lshl_b32 s58, s2, 2
  s_add_u32 s58, s58, s54
  s_mul_i32 s58, s58, 3584
  s_add_u32 m0, s60, 12288
  s_nop 0
  buffer_load_dwordx4 v15, s[28:31], s58 offen offset:0 lds
  s_add_u32 m0, s60, 12304
  s_nop 0
  buffer_load_dwordx4 v15, s[28:31], s58 offen offset:896 lds
  s_add_u32 m0, s60, 12320
  s_nop 0
  buffer_load_dwordx4 v15, s[28:31], s58 offen offset:1792 lds
  s_add_u32 m0, s60, 12336
  s_nop 0
  buffer_load_dwordx4 v15, s[28:31], s58 offen offset:2688 lds
  s_mov_b32 m0, 131072
  s_nop 0
  buffer_load_dwordx4 v15, s[40:43], 0 offen lds
  v_add_u32 v7, 0x10000, v7
  s_setprio 2
  s_barrier
  ds_read_b128 v[112:115], v7 offset:0
  ds_read_b128 v[116:119], v7 offset:1024
  ds_read_b128 v[120:123], v7 offset:2048
  ds_read_b128 v[124:127], v7 offset:3072
  ds_read_b128 v[128:131], v7 offset:4096
  ds_read_b128 v[132:135], v7 offset:5120
  ds_read_b128 v[136:139], v7 offset:6144
  ds_read_b128 v[140:143], v7 offset:7168
  ds_read_b128 v[144:147], v7 offset:8192
  ds_read_b128 v[148:151], v7 offset:9216
  ds_read_b128 v[152:155], v7 offset:10240
  ds_read_b128 v[156:159], v7 offset:11264
  s_mul_i32 s59, s54, 3072
  s_lshl_b32 s61, s59, 1
  s_waitcnt lgkmcnt(11)
  v_add_f32 v160, v160, v112
  v_add_f32 v161, v161, v113
  v_add_f32 v162, v162, v114
  v_add_f32 v163, v163, v115
  s_waitcnt lgkmcnt(10)
  v_add_f32 v164, v164, v116
  v_add_f32 v165, v165, v117
  v_add_f32 v166, v166, v118
  v_add_f32 v167, v167, v119
  s_waitcnt lgkmcnt(9)
  v_add_f32 v168, v168, v120
  v_add_f32 v169, v169, v121
  v_add_f32 v170, v170, v122
  v_add_f32 v171, v171, v123
  s_waitcnt lgkmcnt(8)
  v_add_f32 v172, v172, v124
  v_add_f32 v173, v173, v125
  v_add_f32 v174, v174, v126
  v_add_f32 v175, v175, v127
  s_waitcnt lgkmcnt(7)
  v_add_f32 v160, v160, v128
  v_add_f32 v161, v161, v129
  v_add_f32 v162, v162, v130
  v_add_f32 v163, v163, v131
  s_waitcnt lgkmcnt(6)
  v_add_f32 v164, v164, v132
  v_add_f32 v165, v165, v133
  v_add_f32 v166, v166, v134
  v_add_f32 v167, v167, v135
  s_waitcnt lgkmcnt(5)
  v_add_f32 v168, v168, v136
  v_add_f32 v169, v169, v137
  v_add_f32 v170, v170, v138
  v_add_f32 v171, v171, v139
  s_waitcnt lgkmcnt(4)
  v_add_f32 v172, v172, v140
  v_add_f32 v173, v173, v141
  v_add_f32 v174, v174, v142
  v_add_f32 v175, v175, v143
  s_waitcnt lgkmcnt(3)
  v_add_f32 v160, v160, v144
  v_add_f32 v161, v161, v145
  v_add_f32 v162, v162, v146
  v_add_f32 v163, v163, v147
  s_waitcnt lgkmcnt(2)
  v_add_f32 v164, v164, v148
  v_add_f32 v165, v165, v149
  v_add_f32 v166, v166, v150
  v_add_f32 v167, v167, v151
  s_waitcnt lgkmcnt(1)
  v_add_f32 v168, v168, v152
  v_add_f32 v169, v169, v153
  v_add_f32 v170, v170, v154
  v_add_f32 v171, v171, v155
  s_waitcnt lgkmcnt(0)
  v_add_f32 v172, v172, v156
  v_add_f32 v173, v173, v157
  v_add_f32 v174, v174, v158
  v_add_f32 v175, v175, v159
  s_branch L_red_join
L_red_other:
  s_cmp_lg_u32 s9, 2
  s_cbranch_scc1 L_idle_nm
  s_mov_b32 s40, s14
  s_mov_b32 s41, s15
  s_mov_b32 s42, 0x188000
  s_mov_b32 s43, 0x20000
  s_mov_b32 s44, s16
  s_mov_b32 s45, s17
  s_mov_b32 s46, 0x188000
  s_mov_b32 s47, 0x20000
  s_mul_i32 s58, s50, 147
  s_lshr_b32 s58, s58, 10
  s_mul_i32 s58, s58, 7
  s_sub_u32 s58, s50, s58
  s_cmp_gt_u32 s52, s58
  s_subb_u32 s58, s52, 0
  s_mul_i32 s59, s50, 6
  s_add_u32 s58, s58, s59
  s_lshl_b32 s58, s58, 2
  s_add_u32 s58, s58, s54
  s_mul_i32 s58, s58, 4224
  v_lshlrev_b32 v10, 7, v1
  s_mov_b32 exec_hi, 1
  buffer_load_dword v12, v10, s[40:43], s58 offen
  buffer_load_dword v12, v10, s[44:47], s58 offen
  s_mov_b32 exec_hi, -1
L_idle_nm:
  s_cmp_lg_u32 s9, 1
  s_cbranch_scc1 L_idle_done0
L_idle_done0:
  ds_read_b128 v[112:115], v7 offset:0
  ds_read_b128 v[116:119], v7 offset:1024
  ds_read_b128 v[120:123], v7 offset:2048
  ds_read_b128 v[124:127], v7 offset:3072
  ds_read_b128 v[128:131], v7 offset:4096
  ds_read_b128 v[132:135], v7 offset:5120
  ds_read_b128 v[136:139], v7 offset:6144
  ds_read_b128 v[140:143], v7 offset:7168
  ds_read_b128 v[144:147], v7 offset:8192
  ds_read_b128 v[148:151], v7 offset:9216
  ds_read_b128 v[152:155], v7 offset:10240
  ds_read_b128 v[156:159], v7 offset:11264
  s_waitcnt lgkmcnt(11)
  v_add_f32 v160, v160, v112
  v_add_f32 v161, v161, v113
  v_add_f32 v162, v162, v114
  v_add_f32 v163, v163, v115
  s_waitcnt lgkmcnt(10)
  v_add_f32 v164, v164, v116
  v_add_f32 v165, v165, v117
  v_add_f32 v166, v166, v118
  v_add_f32 v167, v167, v119
  s_waitcnt lgkmcnt(9)
  v_add_f32 v168, v168, v120
  v_add_f32 v169, v169, v121
  v_add_f32 v170, v170, v122
  v_add_f32 v171, v171, v123
  s_waitcnt lgkmcnt(8)
  v_add_f32 v172, v172, v124
  v_add_f32 v173, v173, v125
  v_add_f32 v174, v174, v126
  v_add_f32 v175, v175, v127
  s_waitcnt lgkmcnt(7)
  v_add_f32 v160, v160, v128
  v_add_f32 v161, v161, v129
  v_add_f32 v162, v162, v130
  v_add_f32 v163, v163, v131
  s_waitcnt lgkmcnt(6)
  v_add_f32 v164, v164, v132
  v_add_f32 v165, v165, v133
  v_add_f32 v166, v166, v134
  v_add_f32 v167, v167, v135
  s_waitcnt lgkmcnt(5)
  v_add_f32 v168, v168, v136
  v_add_f32 v169, v169, v137
  v_add_f32 v170, v170, v138
  v_add_f32 v171, v171, v139
  s_waitcnt lgkmcnt(4)
  v_add_f32 v172, v172, v140
  v_add_f32 v173, v173, v141
  v_add_f32 v174, v174, v142
  v_add_f32 v175, v175, v143
  s_waitcnt lgkmcnt(3)
  v_add_f32 v160, v160, v144
  v_add_f32 v161, v161, v145
  v_add_f32 v162, v162, v146
  v_add_f32 v163, v163, v147
  s_waitcnt lgkmcnt(2)
  v_add_f32 v164, v164, v148
  v_add_f32 v165, v165, v149
  v_add_f32 v166, v166, v150
  v_add_f32 v167, v167, v151
  s_waitcnt lgkmcnt(1)
  v_add_f32 v168, v168, v152
  v_add_f32 v169, v169, v153
  v_add_f32 v170, v170, v154
  v_add_f32 v171, v171, v155
  s_waitcnt lgkmcnt(0)
  v_add_f32 v172, v172, v156
  v_add_f32 v173, v173, v157
  v_add_f32 v174, v174, v158
  v_add_f32 v175, v175, v159
  s_setprio 0
  s_cmp_lg_u32 s9, 1
  s_cbranch_scc1 L_idle_done1
  s_mov_b32 s40, s18
  s_mov_b32 s41, s19
  s_mov_b32 s42, 0x188000
  s_mov_b32 s43, 0x20000
  s_mov_b32 exec_hi, 0x00ffffff
  s_lshl_b32 s59, s91, 2
  s_add_u32 s59, s59, s54
  s_mul_i32 s58, s59, 14336
  s_lshl_b32 s60, s54, 14
  s_add_u32 m0, s60, 0
  s_nop 0
  buffer_load_dwordx4 v15, s[40:43], s58 offen lds
  s_add_u32 s58, s58, 896
  s_add_u32 m0, s60, 912
  s_nop 0
  buffer_load_dwordx4 v15, s[40:43], s58 offen lds
  s_add_u32 s58, s58, 896
  s_add_u32 m0, s60, 1824
  s_nop 0
  buffer_load_dwordx4 v15, s[40:43], s58 offen lds
  s_add_u32 s58, s58, 896
  s_add_u32 m0, s60, 2736
  s_nop 0
  buffer_load_dwordx4 v15, s[40:43], s58 offen lds
  s_add_u32 s58, s58, 896
  s_add_u32 m0, s60, 3648
  s_nop 0
  buffer_load_dwordx4 v15, s[40:43], s58 offen lds
  s_add_u32 s58, s58, 896
  s_add_u32 m0, s60, 4560
  s_nop 0
  buffer_load_dwordx4 v15, s[40:43], s58 offen lds
  s_add_u32 s58, s58, 896
  s_add_u32 m0, s60, 5472
  s_nop 0
  buffer_load_dwordx4 v15, s[40:43], s58 offen lds
  s_add_u32 s58, s58, 896
  s_add_u32 m0, s60, 6384
  s_nop 0
  buffer_load_dwordx4 v15, s[40:43], s58 offen lds
  s_add_u32 s58, s58, 896
  s_add_u32 m0, s60, 7296
  s_nop 0
  buffer_load_dwordx4 v15, s[40:43], s58 offen lds
  s_add_u32 s58, s58, 896
  s_add_u32 m0, s60, 8208
  s_nop 0
  buffer_load_dwordx4 v15, s[40:43], s58 offen lds
  s_add_u32 s58, s58, 896
  s_add_u32 m0, s60, 9120
  s_nop 0
  buffer_load_dwordx4 v15, s[40:43], s58 offen lds
  s_add_u32 s58, s58, 896
  s_add_u32 m0, s60, 10032
  s_nop 0
  buffer_load_dwordx4 v15, s[40:43], s58 offen lds
  s_add_u32 s58, s58, 896
  s_add_u32 m0, s60, 10944
  s_nop 0
  buffer_load_dwordx4 v15, s[40:43], s58 offen lds
  s_add_u32 s58, s58, 896
  s_add_u32 m0, s60, 11856
  s_nop 0
  buffer_load_dwordx4 v15, s[40:43], s58 offen lds
  s_add_u32 s58, s58, 896
  s_add_u32 m0, s60, 12768
  s_nop 0
  buffer_load_dwordx4 v15, s[40:43], s58 offen lds
  s_add_u32 s58, s58, 896
  s_add_u32 m0, s60, 13680
  s_nop 0
  buffer_load_dwordx4 v15, s[40:43], s58 offen lds
  s_mov_b64 exec, -1
  s_mov_b32 s40, s14
  s_mov_b32 s41, s15
  s_mov_b32 s42, 0x188000
  s_mov_b32 s43, 0x20000
  s_mov_b32 s44, s16
  s_mov_b32 s45, s17
  s_mov_b32 s46, 0x188000
  s_mov_b32 s47, 0x20000
  s_lshl_b32 s59, s91, 2
  s_add_u32 s59, s59, s54
  s_mul_i32 s58, s59, 7168
  s_add_u32 s58, s58, 0
  v_lshlrev_b32 v10, 7, v1
  s_mov_b32 exec_lo, -1
  s_mov_b32 exec_hi, 0x00ffffff
  buffer_load_dword v12, v10, s[40:43], s58 offen
  buffer_load_dword v12, v10, s[44:47], s58 offen
  s_mov_b64 exec, -1
L_idle_done1:
  v_add_u32 v7, 0x10000, v7
  s_setprio 2
  s_barrier
  ds_read_b128 v[112:115], v7 offset:0
  ds_read_b128 v[116:119], v7 offset:1024
  ds_read_b128 v[120:123], v7 offset:2048
  ds_read_b128 v[124:127], v7 offset:3072
  ds_read_b128 v[128:131], v7 offset:4096
  ds_read_b128 v[132:135], v7 offset:5120
  ds_read_b128 v[136:139], v7 offset:6144
  ds_read_b128 v[140:143], v7 offset:7168
  ds_read_b128 v[144:147], v7 offset:8192
  ds_read_b128 v[148:151], v7 offset:9216
  ds_read_b128 v[152:155], v7 offset:10240
  ds_read_b128 v[156:159], v7 offset:11264
  s_waitcnt lgkmcnt(11)
  v_add_f32 v160, v160, v112
  v_add_f32 v161, v161, v113
  v_add_f32 v162, v162, v114
  v_add_f32 v163, v163, v115
  s_waitcnt lgkmcnt(10)
  v_add_f32 v164, v164, v116
  v_add_f32 v165, v165, v117
  v_add_f32 v166, v166, v118
  v_add_f32 v167, v167, v119
  s_waitcnt lgkmcnt(9)
  v_add_f32 v168, v168, v120
  v_add_f32 v169, v169, v121
  v_add_f32 v170, v170, v122
  v_add_f32 v171, v171, v123
  s_waitcnt lgkmcnt(8)
  v_add_f32 v172, v172, v124
  v_add_f32 v173, v173, v125
  v_add_f32 v174, v174, v126
  v_add_f32 v175, v175, v127
  s_waitcnt lgkmcnt(7)
  v_add_f32 v160, v160, v128
  v_add_f32 v161, v161, v129
  v_add_f32 v162, v162, v130
  v_add_f32 v163, v163, v131
  s_waitcnt lgkmcnt(6)
  v_add_f32 v164, v164, v132
  v_add_f32 v165, v165, v133
  v_add_f32 v166, v166, v134
  v_add_f32 v167, v167, v135
  s_waitcnt lgkmcnt(5)
  v_add_f32 v168, v168, v136
  v_add_f32 v169, v169, v137
  v_add_f32 v170, v170, v138
  v_add_f32 v171, v171, v139
  s_waitcnt lgkmcnt(4)
  v_add_f32 v172, v172, v140
  v_add_f32 v173, v173, v141
  v_add_f32 v174, v174, v142
  v_add_f32 v175, v175, v143
  s_waitcnt lgkmcnt(3)
  v_add_f32 v160, v160, v144
  v_add_f32 v161, v161, v145
  v_add_f32 v162, v162, v146
  v_add_f32 v163, v163, v147
  s_waitcnt lgkmcnt(2)
  v_add_f32 v164, v164, v148
  v_add_f32 v165, v165, v149
  v_add_f32 v166, v166, v150
  v_add_f32 v167, v167, v151
  s_waitcnt lgkmcnt(1)
  v_add_f32 v168, v168, v152
  v_add_f32 v169, v169, v153
  v_add_f32 v170, v170, v154
  v_add_f32 v171, v171, v155
  s_waitcnt lgkmcnt(0)
  v_add_f32 v172, v172, v156
  v_add_f32 v173, v173, v157
  v_add_f32 v174, v174, v158
  v_add_f32 v175, v175, v159
L_red_join:
  ds_write_b128 v7, v[160:163] offset:12288
  ds_write_b128 v7, v[164:167] offset:13312
  ds_write_b128 v7, v[168:171] offset:14336
  ds_write_b128 v7, v[172:175] offset:15360
  s_setprio 0
  s_waitcnt vmcnt(0) lgkmcnt(0)
  s_barrier
  s_cmp_eq_u32 s9, 0
  s_cbranch_scc1 L_p3_a
  s_branch L_other
L_attb0:
  ds_read_b128 v[16:19], v8
  ds_read_b128 v[20:23], v8 offset:1024
  ds_read_b128 v[24:27], v9
  ds_read_b128 v[28:31], v9 offset:1024
  ds_read_b128 v[32:35], v10
  ds_read_b128 v[36:39], v10 offset:1024
  ds_read_b128 v[40:43], v11
  ds_read_b128 v[44:47], v11 offset:1024
  s_waitcnt vmcnt(0)
  v_mov_b32 v2, v96
  v_mov_b32 v3, v85
  s_waitcnt vmcnt(0)
  v_cmp_ne_u32 s[76:77], s48, v2
  s_nop 0
  s_and_b32 s58, s76, 0xffff
  s_cbranch_scc0 L_kv1b_go
  s_mov_b64 exec, 0xffff
  s_mov_b32 s75, 0
L_kv1b_poll:
  buffer_load_dword v2, v3, s[36:39], 0 offen sc1
  s_add_u32 s75, s75, 1
  s_waitcnt vmcnt(0)
  v_cmp_ne_u32 s[76:77], s48, v2
  s_nop 0
  s_and_b32 s58, s76, 0xffff
  s_cbranch_scc0 L_kv1b_ok
  s_cmp_ge_u32 s75, 262144
  s_cbranch_scc1 L_kv1b_ok
  s_branch L_kv1b_poll
L_kv1b_ok:
  s_mov_b64 exec, -1
L_kv1b_go:
  buffer_load_dwordx4 v[48:51], v15, s[36:39], s64 offen offset:0 sc1
  buffer_load_dwordx4 v[52:55], v15, s[36:39], s64 offen offset:1024 sc1
  buffer_load_dwordx4 v[56:59], v15, s[36:39], s64 offen offset:2048 sc1
  buffer_load_dwordx4 v[60:63], v15, s[36:39], s64 offen offset:3072 sc1
  buffer_load_dwordx4 v[176:179], v15, s[36:39], s65 offen offset:0 sc1
  buffer_load_dwordx4 v[180:183], v15, s[36:39], s65 offen offset:1024 sc1
  buffer_load_dwordx4 v[184:187], v15, s[36:39], s65 offen offset:2048 sc1
  buffer_load_dwordx4 v[188:191], v15, s[36:39], s65 offen offset:3072 sc1
  s_waitcnt vmcnt(6) lgkmcnt(6)
  v_mfma_f32_32x32x16_bf16 v[80:95], v[48:51], v[16:19], 0
  v_mfma_f32_32x32x16_bf16 v[80:95], v[52:55], v[20:23], v[80:95]
  s_nop 10
  s_waitcnt lgkmcnt(0)
  v_exp_f32 v80, v80
  v_exp_f32 v81, v81
  buffer_load_dwordx4 v[192:195], v15, s[36:39], s66 offen offset:0 sc1
  buffer_load_dwordx4 v[196:199], v15, s[36:39], s66 offen offset:1024 sc1
  v_exp_f32 v82, v82
  v_exp_f32 v83, v83
  v_exp_f32 v84, v84
  v_mfma_f32_32x32x16_bf16 v[96:111], v[48:51], v[24:27], 0
  v_exp_f32 v85, v85
  v_exp_f32 v86, v86
  buffer_load_dwordx4 v[200:203], v15, s[36:39], s66 offen offset:2048 sc1
  buffer_load_dwordx4 v[204:207], v15, s[36:39], s66 offen offset:3072 sc1
  v_exp_f32 v87, v87
  v_mfma_f32_32x32x16_bf16 v[96:111], v[52:55], v[28:31], v[96:111]
  v_exp_f32 v88, v88
  v_exp_f32 v89, v89
  v_exp_f32 v90, v90
  s_waitcnt vmcnt(8)
  v_smfmac_f32_32x32x32_bf16 v[112:127], v[56:59], v[80:87], v14
  v_exp_f32 v91, v91
  v_exp_f32 v92, v92
  v_exp_f32 v93, v93
  v_exp_f32 v94, v94
  v_exp_f32 v95, v95
  v_exp_f32 v96, v96
  v_exp_f32 v97, v97
  v_smfmac_f32_32x32x32_bf16 v[112:127], v[60:63], v[88:95], v14
  buffer_load_dwordx4 v[208:211], v15, s[36:39], s67 offen offset:0 sc1
  buffer_load_dwordx4 v[212:215], v15, s[36:39], s67 offen offset:1024 sc1
  v_exp_f32 v98, v98
  v_exp_f32 v99, v99
  v_exp_f32 v100, v100
  v_mfma_f32_32x32x16_bf16 v[80:95], v[48:51], v[32:35], 0
  v_exp_f32 v101, v101
  v_exp_f32 v102, v102
  buffer_load_dwordx4 v[216:219], v15, s[36:39], s67 offen offset:2048 sc1
  buffer_load_dwordx4 v[220:223], v15, s[36:39], s67 offen offset:3072 sc1
  v_exp_f32 v103, v103
  v_mfma_f32_32x32x16_bf16 v[80:95], v[52:55], v[36:39], v[80:95]
  v_exp_f32 v104, v104
  v_exp_f32 v105, v105
  v_exp_f32 v106, v106
  v_smfmac_f32_32x32x32_bf16 v[128:143], v[56:59], v[96:103], v14
  v_exp_f32 v107, v107
  v_exp_f32 v108, v108
  v_exp_f32 v109, v109
  v_exp_f32 v110, v110
  v_exp_f32 v111, v111
  v_exp_f32 v80, v80
  v_exp_f32 v81, v81
  v_smfmac_f32_32x32x32_bf16 v[128:143], v[60:63], v[104:111], v14
  buffer_load_dwordx4 v[224:227], v15, s[36:39], s68 offen offset:0 sc1
  buffer_load_dwordx4 v[228:231], v15, s[36:39], s68 offen offset:1024 sc1
  v_exp_f32 v82, v82
  v_exp_f32 v83, v83
  v_exp_f32 v84, v84
  v_mfma_f32_32x32x16_bf16 v[96:111], v[48:51], v[40:43], 0
  v_exp_f32 v85, v85
  v_exp_f32 v86, v86
  buffer_load_dwordx4 v[232:235], v15, s[36:39], s68 offen offset:2048 sc1
  buffer_load_dwordx4 v[236:239], v15, s[36:39], s68 offen offset:3072 sc1
  v_exp_f32 v87, v87
  v_mfma_f32_32x32x16_bf16 v[96:111], v[52:55], v[44:47], v[96:111]
  v_exp_f32 v88, v88
  v_exp_f32 v89, v89
  v_exp_f32 v90, v90
  v_smfmac_f32_32x32x32_bf16 v[144:159], v[56:59], v[80:87], v14
  v_exp_f32 v91, v91
  v_exp_f32 v92, v92
  v_exp_f32 v93, v93
  v_exp_f32 v94, v94
  v_exp_f32 v95, v95
  v_exp_f32 v96, v96
  v_exp_f32 v97, v97
  v_smfmac_f32_32x32x32_bf16 v[144:159], v[60:63], v[88:95], v14
  buffer_load_dwordx4 v[240:243], v15, s[36:39], s69 offen offset:0 sc1
  buffer_load_dwordx4 v[244:247], v15, s[36:39], s69 offen offset:1024 sc1
  v_exp_f32 v98, v98
  v_exp_f32 v99, v99
  v_exp_f32 v100, v100
  s_waitcnt vmcnt(16)
  v_mfma_f32_32x32x16_bf16 v[80:95], v[176:179], v[16:19], 0
  v_exp_f32 v101, v101
  v_exp_f32 v102, v102
  buffer_load_dwordx4 v[248:251], v15, s[36:39], s69 offen offset:2048 sc1
  buffer_load_dwordx4 v[252:255], v15, s[36:39], s69 offen offset:3072 sc1
  v_exp_f32 v103, v103
  v_mfma_f32_32x32x16_bf16 v[80:95], v[180:183], v[20:23], v[80:95]
  v_exp_f32 v104, v104
  v_exp_f32 v105, v105
  v_exp_f32 v106, v106
  v_smfmac_f32_32x32x32_bf16 v[160:175], v[56:59], v[96:103], v14
  v_exp_f32 v107, v107
  v_exp_f32 v108, v108
  v_exp_f32 v109, v109
  v_exp_f32 v110, v110
  v_exp_f32 v111, v111
  v_exp_f32 v80, v80
  v_exp_f32 v81, v81
  v_smfmac_f32_32x32x32_bf16 v[160:175], v[60:63], v[104:111], v14
  buffer_load_dwordx4 v[64:67], v15, s[36:39], s70 offen offset:0 sc1
  buffer_load_dwordx4 v[68:71], v15, s[36:39], s70 offen offset:1024 sc1
  v_exp_f32 v82, v82
  v_exp_f32 v83, v83
  v_exp_f32 v84, v84
  v_mfma_f32_32x32x16_bf16 v[96:111], v[176:179], v[24:27], 0
  v_exp_f32 v85, v85
  v_exp_f32 v86, v86
  buffer_load_dwordx4 v[72:75], v15, s[36:39], s70 offen offset:2048 sc1
  buffer_load_dwordx4 v[76:79], v15, s[36:39], s70 offen offset:3072 sc1
  v_exp_f32 v87, v87
  v_mfma_f32_32x32x16_bf16 v[96:111], v[180:183], v[28:31], v[96:111]
  v_exp_f32 v88, v88
  v_exp_f32 v89, v89
  v_exp_f32 v90, v90
  s_waitcnt vmcnt(20)
  v_smfmac_f32_32x32x32_bf16 v[112:127], v[184:187], v[80:87], v14
  v_exp_f32 v91, v91
  v_exp_f32 v92, v92
  v_exp_f32 v93, v93
  v_exp_f32 v94, v94
  v_exp_f32 v95, v95
  v_exp_f32 v96, v96
  v_exp_f32 v97, v97
  v_smfmac_f32_32x32x32_bf16 v[112:127], v[188:191], v[88:95], v14
  buffer_load_dwordx4 v[48:51], v15, s[36:39], s71 offen offset:0 sc1
  buffer_load_dwordx4 v[52:55], v15, s[36:39], s71 offen offset:1024 sc1
  v_exp_f32 v98, v98
  v_exp_f32 v99, v99
  v_exp_f32 v100, v100
  v_mfma_f32_32x32x16_bf16 v[80:95], v[176:179], v[32:35], 0
  v_exp_f32 v101, v101
  v_exp_f32 v102, v102
  buffer_load_dwordx4 v[56:59], v15, s[36:39], s71 offen offset:2048 sc1
  buffer_load_dwordx4 v[60:63], v15, s[36:39], s71 offen offset:3072 sc1
  v_exp_f32 v103, v103
  v_mfma_f32_32x32x16_bf16 v[80:95], v[180:183], v[36:39], v[80:95]
  v_exp_f32 v104, v104
  v_exp_f32 v105, v105
  v_exp_f32 v106, v106
  v_smfmac_f32_32x32x32_bf16 v[128:143], v[184:187], v[96:103], v14
  v_exp_f32 v107, v107
  v_exp_f32 v108, v108
  v_exp_f32 v109, v109
  v_exp_f32 v110, v110
  v_exp_f32 v111, v111
  v_exp_f32 v80, v80
  v_exp_f32 v81, v81
  v_smfmac_f32_32x32x32_bf16 v[128:143], v[188:191], v[104:111], v14
  v_exp_f32 v82, v82
  v_exp_f32 v83, v83
  v_exp_f32 v84, v84
  v_mfma_f32_32x32x16_bf16 v[96:111], v[176:179], v[40:43], 0
  v_exp_f32 v85, v85
  v_exp_f32 v86, v86
  v_exp_f32 v87, v87
  v_mfma_f32_32x32x16_bf16 v[96:111], v[180:183], v[44:47], v[96:111]
  v_exp_f32 v88, v88
  v_exp_f32 v89, v89
  v_exp_f32 v90, v90
  v_smfmac_f32_32x32x32_bf16 v[144:159], v[184:187], v[80:87], v14
  v_exp_f32 v91, v91
  v_exp_f32 v92, v92
  v_exp_f32 v93, v93
  v_exp_f32 v94, v94
  v_exp_f32 v95, v95
  v_exp_f32 v96, v96
  v_exp_f32 v97, v97
  v_smfmac_f32_32x32x32_bf16 v[144:159], v[188:191], v[88:95], v14
  v_exp_f32 v98, v98
  v_exp_f32 v99, v99
  v_exp_f32 v100, v100
  s_waitcnt vmcnt(22)
  v_mfma_f32_32x32x16_bf16 v[80:95], v[192:195], v[16:19], 0
  v_exp_f32 v101, v101
  v_exp_f32 v102, v102
  v_exp_f32 v103, v103
  v_mfma_f32_32x32x16_bf16 v[80:95], v[196:199], v[20:23], v[80:95]
  v_exp_f32 v104, v104
  v_exp_f32 v105, v105
  v_exp_f32 v106, v106
  v_smfmac_f32_32x32x32_bf16 v[160:175], v[184:187], v[96:103], v14
  v_exp_f32 v107, v107
  v_exp_f32 v108, v108
  v_exp_f32 v109, v109
  v_exp_f32 v110, v110
  v_exp_f32 v111, v111
  s_barrier
  s_setprio 1
  v_exp_f32 v80, v80
  v_exp_f32 v81, v81
  v_smfmac_f32_32x32x32_bf16 v[160:175], v[188:191], v[104:111], v14
  v_exp_f32 v82, v82
  v_exp_f32 v83, v83
  v_exp_f32 v84, v84
  s_waitcnt vmcnt(18)
  v_mfma_f32_32x32x16_bf16 v[96:111], v[208:211], v[16:19], 0
  v_exp_f32 v85, v85
  v_exp_f32 v86, v86
  v_exp_f32 v87, v87
  v_mfma_f32_32x32x16_bf16 v[96:111], v[212:215], v[20:23], v[96:111]
  v_exp_f32 v88, v88
  v_exp_f32 v89, v89
  v_exp_f32 v90, v90
  v_smfmac_f32_32x32x32_bf16 v[112:127], v[200:203], v[80:87], v14
  v_exp_f32 v91, v91
  v_exp_f32 v92, v92
  v_exp_f32 v93, v93
  v_exp_f32 v94, v94
  v_exp_f32 v95, v95
  v_exp_f32 v96, v96
  v_exp_f32 v97, v97
  v_smfmac_f32_32x32x32_bf16 v[112:127], v[204:207], v[88:95], v14
  v_exp_f32 v98, v98
  v_exp_f32 v99, v99
  v_exp_f32 v100, v100
  s_waitcnt vmcnt(14)
  v_mfma_f32_32x32x16_bf16 v[80:95], v[224:227], v[16:19], 0
  v_exp_f32 v101, v101
  v_exp_f32 v102, v102
  v_exp_f32 v103, v103
  v_mfma_f32_32x32x16_bf16 v[80:95], v[228:231], v[20:23], v[80:95]
  v_exp_f32 v104, v104
  v_exp_f32 v105, v105
  v_exp_f32 v106, v106
  v_smfmac_f32_32x32x32_bf16 v[112:127], v[216:219], v[96:103], v14
  v_exp_f32 v107, v107
  v_exp_f32 v108, v108
  v_exp_f32 v109, v109
  v_exp_f32 v110, v110
  v_exp_f32 v111, v111
  v_exp_f32 v80, v80
  v_exp_f32 v81, v81
  v_smfmac_f32_32x32x32_bf16 v[112:127], v[220:223], v[104:111], v14
  v_exp_f32 v82, v82
  v_exp_f32 v83, v83
  v_exp_f32 v84, v84
  s_waitcnt vmcnt(10)
  v_mfma_f32_32x32x16_bf16 v[96:111], v[240:243], v[16:19], 0
  v_exp_f32 v85, v85
  v_exp_f32 v86, v86
  v_exp_f32 v87, v87
  v_mfma_f32_32x32x16_bf16 v[96:111], v[244:247], v[20:23], v[96:111]
  v_exp_f32 v88, v88
  v_exp_f32 v89, v89
  v_exp_f32 v90, v90
  v_smfmac_f32_32x32x32_bf16 v[112:127], v[232:235], v[80:87], v14
  v_exp_f32 v91, v91
  v_exp_f32 v92, v92
  v_exp_f32 v93, v93
  v_exp_f32 v94, v94
  v_exp_f32 v95, v95
  v_exp_f32 v96, v96
  v_exp_f32 v97, v97
  v_smfmac_f32_32x32x32_bf16 v[112:127], v[236:239], v[88:95], v14
  v_exp_f32 v98, v98
  v_exp_f32 v99, v99
  v_exp_f32 v100, v100
  s_waitcnt vmcnt(6)
  v_mfma_f32_32x32x16_bf16 v[80:95], v[64:67], v[16:19], 0
  v_exp_f32 v101, v101
  v_exp_f32 v102, v102
  v_exp_f32 v103, v103
  v_mfma_f32_32x32x16_bf16 v[80:95], v[68:71], v[20:23], v[80:95]
  v_exp_f32 v104, v104
  v_exp_f32 v105, v105
  v_exp_f32 v106, v106
  v_smfmac_f32_32x32x32_bf16 v[112:127], v[248:251], v[96:103], v14
  v_exp_f32 v107, v107
  v_exp_f32 v108, v108
  v_exp_f32 v109, v109
  v_exp_f32 v110, v110
  v_exp_f32 v111, v111
  v_exp_f32 v80, v80
  v_exp_f32 v81, v81
  v_smfmac_f32_32x32x32_bf16 v[112:127], v[252:255], v[104:111], v14
  v_exp_f32 v82, v82
  v_exp_f32 v83, v83
  v_exp_f32 v84, v84
  s_waitcnt vmcnt(2)
  v_mfma_f32_32x32x16_bf16 v[96:111], v[48:51], v[16:19], 0
  v_exp_f32 v85, v85
  v_exp_f32 v86, v86
  v_exp_f32 v87, v87
  v_mfma_f32_32x32x16_bf16 v[96:111], v[52:55], v[20:23], v[96:111]
  v_exp_f32 v88, v88
  v_exp_f32 v89, v89
  v_exp_f32 v90, v90
  v_smfmac_f32_32x32x32_bf16 v[112:127], v[72:75], v[80:87], v14
  v_exp_f32 v91, v91
  v_exp_f32 v92, v92
  v_exp_f32 v93, v93
  v_exp_f32 v94, v94
  v_exp_f32 v95, v95
  v_exp_f32 v96, v96
  v_exp_f32 v97, v97
  v_smfmac_f32_32x32x32_bf16 v[112:127], v[76:79], v[88:95], v14
  v_exp_f32 v98, v98
  v_exp_f32 v99, v99
  v_exp_f32 v100, v100
  v_mfma_f32_32x32x16_bf16 v[80:95], v[192:195], v[24:27], 0
  v_exp_f32 v101, v101
  v_exp_f32 v102, v102
  v_exp_f32 v103, v103
  v_mfma_f32_32x32x16_bf16 v[80:95], v[196:199], v[28:31], v[80:95]
  v_exp_f32 v104, v104
  v_exp_f32 v105, v105
  v_exp_f32 v106, v106
  s_waitcnt vmcnt(0)
  v_smfmac_f32_32x32x32_bf16 v[112:127], v[56:59], v[96:103], v14
  v_exp_f32 v107, v107
  v_exp_f32 v108, v108
  v_exp_f32 v109, v109
  v_exp_f32 v110, v110
  v_exp_f32 v111, v111
  v_exp_f32 v80, v80
  v_exp_f32 v81, v81
  v_smfmac_f32_32x32x32_bf16 v[112:127], v[60:63], v[104:111], v14
  v_exp_f32 v82, v82
  v_exp_f32 v83, v83
  v_exp_f32 v84, v84
  v_mfma_f32_32x32x16_bf16 v[96:111], v[208:211], v[24:27], 0
  v_exp_f32 v85, v85
  v_exp_f32 v86, v86
  v_exp_f32 v87, v87
  v_mfma_f32_32x32x16_bf16 v[96:111], v[212:215], v[28:31], v[96:111]
  v_exp_f32 v88, v88
  v_exp_f32 v89, v89
  v_exp_f32 v90, v90
  v_smfmac_f32_32x32x32_bf16 v[128:143], v[200:203], v[80:87], v14
  v_exp_f32 v91, v91
  ds_write_b128 v4, v[112:115] offset:0
  v_exp_f32 v92, v92
  v_exp_f32 v93, v93
  v_exp_f32 v94, v94
  v_exp_f32 v95, v95
  v_exp_f32 v96, v96
  v_exp_f32 v97, v97
  v_smfmac_f32_32x32x32_bf16 v[128:143], v[204:207], v[88:95], v14
  v_exp_f32 v98, v98
  v_exp_f32 v99, v99
  v_exp_f32 v100, v100
  v_mfma_f32_32x32x16_bf16 v[80:95], v[224:227], v[24:27], 0
  v_exp_f32 v101, v101
  v_exp_f32 v102, v102
  ds_write_b128 v4, v[116:119] offset:1024
  v_exp_f32 v103, v103
  v_mfma_f32_32x32x16_bf16 v[80:95], v[228:231], v[28:31], v[80:95]
  v_exp_f32 v104, v104
  v_exp_f32 v105, v105
  v_exp_f32 v106, v106
  v_smfmac_f32_32x32x32_bf16 v[128:143], v[216:219], v[96:103], v14
  v_exp_f32 v107, v107
  ds_write_b128 v4, v[120:123] offset:2048
  v_exp_f32 v108, v108
  v_exp_f32 v109, v109
  v_exp_f32 v110, v110
  v_exp_f32 v111, v111
  v_exp_f32 v80, v80
  v_exp_f32 v81, v81
  v_smfmac_f32_32x32x32_bf16 v[128:143], v[220:223], v[104:111], v14
  v_exp_f32 v82, v82
  v_exp_f32 v83, v83
  v_exp_f32 v84, v84
  v_mfma_f32_32x32x16_bf16 v[96:111], v[240:243], v[24:27], 0
  v_exp_f32 v85, v85
  v_exp_f32 v86, v86
  ds_write_b128 v4, v[124:127] offset:3072
  v_exp_f32 v87, v87
  v_mfma_f32_32x32x16_bf16 v[96:111], v[244:247], v[28:31], v[96:111]
  v_exp_f32 v88, v88
  v_exp_f32 v89, v89
  v_exp_f32 v90, v90
  v_smfmac_f32_32x32x32_bf16 v[128:143], v[232:235], v[80:87], v14
  v_exp_f32 v91, v91
  v_exp_f32 v92, v92
  v_exp_f32 v93, v93
  v_exp_f32 v94, v94
  v_exp_f32 v95, v95
  v_exp_f32 v96, v96
  v_exp_f32 v97, v97
  v_smfmac_f32_32x32x32_bf16 v[128:143], v[236:239], v[88:95], v14
  v_exp_f32 v98, v98
  v_exp_f32 v99, v99
  v_exp_f32 v100, v100
  v_mfma_f32_32x32x16_bf16 v[80:95], v[64:67], v[24:27], 0
  v_exp_f32 v101, v101
  v_exp_f32 v102, v102
  v_exp_f32 v103, v103
  v_mfma_f32_32x32x16_bf16 v[80:95], v[68:71], v[28:31], v[80:95]
  v_exp_f32 v104, v104
  v_exp_f32 v105, v105
  v_exp_f32 v106, v106
  v_smfmac_f32_32x32x32_bf16 v[128:143], v[248:251], v[96:103], v14
  v_exp_f32 v107, v107
  v_exp_f32 v108, v108
  v_exp_f32 v109, v109
  v_exp_f32 v110, v110
  v_exp_f32 v111, v111
  v_exp_f32 v80, v80
  v_exp_f32 v81, v81
  v_smfmac_f32_32x32x32_bf16 v[128:143], v[252:255], v[104:111], v14
  v_exp_f32 v82, v82
  v_exp_f32 v83, v83
  v_exp_f32 v84, v84
  v_mfma_f32_32x32x16_bf16 v[96:111], v[48:51], v[24:27], 0
  v_exp_f32 v85, v85
  v_exp_f32 v86, v86
  v_exp_f32 v87, v87
  v_mfma_f32_32x32x16_bf16 v[96:111], v[52:55], v[28:31], v[96:111]
  v_exp_f32 v88, v88
  v_exp_f32 v89, v89
  v_exp_f32 v90, v90
  v_smfmac_f32_32x32x32_bf16 v[128:143], v[72:75], v[80:87], v14
  v_exp_f32 v91, v91
  v_exp_f32 v92, v92
  v_exp_f32 v93, v93
  v_exp_f32 v94, v94
  v_exp_f32 v95, v95
  v_exp_f32 v96, v96
  v_exp_f32 v97, v97
  v_smfmac_f32_32x32x32_bf16 v[128:143], v[76:79], v[88:95], v14
  v_exp_f32 v98, v98
  v_exp_f32 v99, v99
  v_exp_f32 v100, v100
  v_mfma_f32_32x32x16_bf16 v[80:95], v[192:195], v[32:35], 0
  v_exp_f32 v101, v101
  v_exp_f32 v102, v102
  v_exp_f32 v103, v103
  v_mfma_f32_32x32x16_bf16 v[80:95], v[196:199], v[36:39], v[80:95]
  v_exp_f32 v104, v104
  v_exp_f32 v105, v105
  v_exp_f32 v106, v106
  v_smfmac_f32_32x32x32_bf16 v[128:143], v[56:59], v[96:103], v14
  v_exp_f32 v107, v107
  v_exp_f32 v108, v108
  v_exp_f32 v109, v109
  v_exp_f32 v110, v110
  v_exp_f32 v111, v111
  v_exp_f32 v80, v80
  v_exp_f32 v81, v81
  v_smfmac_f32_32x32x32_bf16 v[128:143], v[60:63], v[104:111], v14
  v_exp_f32 v82, v82
  v_exp_f32 v83, v83
  v_exp_f32 v84, v84
  v_mfma_f32_32x32x16_bf16 v[96:111], v[208:211], v[32:35], 0
  v_exp_f32 v85, v85
  v_exp_f32 v86, v86
  v_exp_f32 v87, v87
  v_mfma_f32_32x32x16_bf16 v[96:111], v[212:215], v[36:39], v[96:111]
  v_exp_f32 v88, v88
  v_exp_f32 v89, v89
  v_exp_f32 v90, v90
  v_smfmac_f32_32x32x32_bf16 v[144:159], v[200:203], v[80:87], v14
  v_exp_f32 v91, v91
  ds_write_b128 v5, v[128:131] offset:4096
  v_exp_f32 v92, v92
  v_exp_f32 v93, v93
  v_exp_f32 v94, v94
  v_exp_f32 v95, v95
  v_exp_f32 v96, v96
  v_exp_f32 v97, v97
  v_smfmac_f32_32x32x32_bf16 v[144:159], v[204:207], v[88:95], v14
  v_exp_f32 v98, v98
  v_exp_f32 v99, v99
  v_exp_f32 v100, v100
  v_mfma_f32_32x32x16_bf16 v[80:95], v[224:227], v[32:35], 0
  v_exp_f32 v101, v101
  v_exp_f32 v102, v102
  ds_write_b128 v5, v[132:135] offset:5120
  v_exp_f32 v103, v103
  v_mfma_f32_32x32x16_bf16 v[80:95], v[228:231], v[36:39], v[80:95]
  v_exp_f32 v104, v104
  v_exp_f32 v105, v105
  v_exp_f32 v106, v106
  v_smfmac_f32_32x32x32_bf16 v[144:159], v[216:219], v[96:103], v14
  v_exp_f32 v107, v107
  ds_write_b128 v5, v[136:139] offset:6144
  v_exp_f32 v108, v108
  v_exp_f32 v109, v109
  v_exp_f32 v110, v110
  v_exp_f32 v111, v111
  v_exp_f32 v80, v80
  v_exp_f32 v81, v81
  v_smfmac_f32_32x32x32_bf16 v[144:159], v[220:223], v[104:111], v14
  v_exp_f32 v82, v82
  v_exp_f32 v83, v83
  v_exp_f32 v84, v84
  v_mfma_f32_32x32x16_bf16 v[96:111], v[240:243], v[32:35], 0
  v_exp_f32 v85, v85
  v_exp_f32 v86, v86
  ds_write_b128 v5, v[140:143] offset:7168
  v_exp_f32 v87, v87
  v_mfma_f32_32x32x16_bf16 v[96:111], v[244:247], v[36:39], v[96:111]
  v_exp_f32 v88, v88
  v_exp_f32 v89, v89
  v_exp_f32 v90, v90
  v_smfmac_f32_32x32x32_bf16 v[144:159], v[232:235], v[80:87], v14
  v_exp_f32 v91, v91
  v_exp_f32 v92, v92
  v_exp_f32 v93, v93
  v_exp_f32 v94, v94
  v_exp_f32 v95, v95
  v_exp_f32 v96, v96
  v_exp_f32 v97, v97
  v_smfmac_f32_32x32x32_bf16 v[144:159], v[236:239], v[88:95], v14
  v_exp_f32 v98, v98
  v_exp_f32 v99, v99
  v_exp_f32 v100, v100
  v_mfma_f32_32x32x16_bf16 v[80:95], v[64:67], v[32:35], 0
  v_exp_f32 v101, v101
  v_exp_f32 v102, v102
  v_exp_f32 v103, v103
  v_mfma_f32_32x32x16_bf16 v[80:95], v[68:71], v[36:39], v[80:95]
  v_exp_f32 v104, v104
  v_exp_f32 v105, v105
  v_exp_f32 v106, v106
  v_smfmac_f32_32x32x32_bf16 v[144:159], v[248:251], v[96:103], v14
  v_exp_f32 v107, v107
  v_exp_f32 v108, v108
  v_exp_f32 v109, v109
  v_exp_f32 v110, v110
  v_exp_f32 v111, v111
  v_exp_f32 v80, v80
  v_exp_f32 v81, v81
  v_smfmac_f32_32x32x32_bf16 v[144:159], v[252:255], v[104:111], v14
  v_exp_f32 v82, v82
  v_exp_f32 v83, v83
  v_exp_f32 v84, v84
  v_mfma_f32_32x32x16_bf16 v[96:111], v[48:51], v[32:35], 0
  v_exp_f32 v85, v85
  v_exp_f32 v86, v86
  v_exp_f32 v87, v87
  v_mfma_f32_32x32x16_bf16 v[96:111], v[52:55], v[36:39], v[96:111]
  v_exp_f32 v88, v88
  v_exp_f32 v89, v89
  v_exp_f32 v90, v90
  v_smfmac_f32_32x32x32_bf16 v[144:159], v[72:75], v[80:87], v14
  v_exp_f32 v91, v91
  v_exp_f32 v92, v92
  v_exp_f32 v93, v93
  v_exp_f32 v94, v94
  v_exp_f32 v95, v95
  v_exp_f32 v96, v96
  v_exp_f32 v97, v97
  v_smfmac_f32_32x32x32_bf16 v[144:159], v[76:79], v[88:95], v14
  v_exp_f32 v98, v98
  v_exp_f32 v99, v99
  v_exp_f32 v100, v100
  v_mfma_f32_32x32x16_bf16 v[80:95], v[192:195], v[40:43], 0
  v_exp_f32 v101, v101
  v_exp_f32 v102, v102
  v_exp_f32 v103, v103
  v_mfma_f32_32x32x16_bf16 v[80:95], v[196:199], v[44:47], v[80:95]
  v_exp_f32 v104, v104
  v_exp_f32 v105, v105
  v_exp_f32 v106, v106
  v_smfmac_f32_32x32x32_bf16 v[144:159], v[56:59], v[96:103], v14
  v_exp_f32 v107, v107
  v_exp_f32 v108, v108
  v_exp_f32 v109, v109
  v_exp_f32 v110, v110
  v_exp_f32 v111, v111
  v_exp_f32 v80, v80
  v_exp_f32 v81, v81
  v_smfmac_f32_32x32x32_bf16 v[144:159], v[60:63], v[104:111], v14
  v_exp_f32 v82, v82
  v_exp_f32 v83, v83
  v_exp_f32 v84, v84
  v_mfma_f32_32x32x16_bf16 v[96:111], v[208:211], v[40:43], 0
  v_exp_f32 v85, v85
  v_exp_f32 v86, v86
  v_exp_f32 v87, v87
  v_mfma_f32_32x32x16_bf16 v[96:111], v[212:215], v[44:47], v[96:111]
  v_exp_f32 v88, v88
  v_exp_f32 v89, v89
  v_exp_f32 v90, v90
  v_smfmac_f32_32x32x32_bf16 v[160:175], v[200:203], v[80:87], v14
  v_exp_f32 v91, v91
  ds_write_b128 v6, v[144:147] offset:8192
  v_exp_f32 v92, v92
  ds_write_b128 v6, v[148:151] offset:9216
  v_exp_f32 v93, v93
  ds_write_b128 v6, v[152:155] offset:10240
  v_exp_f32 v94, v94
  ds_write_b128 v6, v[156:159] offset:11264
  v_exp_f32 v95, v95
  v_exp_f32 v96, v96
  v_exp_f32 v97, v97
  v_smfmac_f32_32x32x32_bf16 v[160:175], v[204:207], v[88:95], v14
  v_exp_f32 v98, v98
  v_exp_f32 v99, v99
  v_exp_f32 v100, v100
  v_mfma_f32_32x32x16_bf16 v[80:95], v[224:227], v[40:43], 0
  v_exp_f32 v101, v101
  v_exp_f32 v102, v102
  s_waitcnt lgkmcnt(0)
  s_barrier
  v_exp_f32 v103, v103
  v_mfma_f32_32x32x16_bf16 v[80:95], v[228:231], v[44:47], v[80:95]
  v_exp_f32 v104, v104
  v_exp_f32 v105, v105
  v_exp_f32 v106, v106
  v_smfmac_f32_32x32x32_bf16 v[160:175], v[216:219], v[96:103], v14
  v_exp_f32 v107, v107
  v_exp_f32 v108, v108
  v_exp_f32 v109, v109
  v_exp_f32 v110, v110
  v_exp_f32 v111, v111
  v_exp_f32 v80, v80
  v_exp_f32 v81, v81
  v_smfmac_f32_32x32x32_bf16 v[160:175], v[220:223], v[104:111], v14
  v_exp_f32 v82, v82
  v_exp_f32 v83, v83
  v_exp_f32 v84, v84
  v_mfma_f32_32x32x16_bf16 v[96:111], v[240:243], v[40:43], 0
  v_exp_f32 v85, v85
  v_exp_f32 v86, v86
  v_exp_f32 v87, v87
  v_mfma_f32_32x32x16_bf16 v[96:111], v[244:247], v[44:47], v[96:111]
  v_exp_f32 v88, v88
  v_exp_f32 v89, v89
  v_exp_f32 v90, v90
  v_smfmac_f32_32x32x32_bf16 v[160:175], v[232:235], v[80:87], v14
  v_exp_f32 v91, v91
  v_exp_f32 v92, v92
  v_exp_f32 v93, v93
  v_exp_f32 v94, v94
  v_exp_f32 v95, v95
  v_exp_f32 v96, v96
  v_exp_f32 v97, v97
  v_smfmac_f32_32x32x32_bf16 v[160:175], v[236:239], v[88:95], v14
  v_exp_f32 v98, v98
  v_exp_f32 v99, v99
  v_exp_f32 v100, v100
  v_mfma_f32_32x32x16_bf16 v[80:95], v[64:67], v[40:43], 0
  v_exp_f32 v101, v101
  v_exp_f32 v102, v102
  v_exp_f32 v103, v103
  v_mfma_f32_32x32x16_bf16 v[80:95], v[68:71], v[44:47], v[80:95]
  v_exp_f32 v104, v104
  v_exp_f32 v105, v105
  v_exp_f32 v106, v106
  v_smfmac_f32_32x32x32_bf16 v[160:175], v[248:251], v[96:103], v14
  v_exp_f32 v107, v107
  v_exp_f32 v108, v108
  v_exp_f32 v109, v109
  v_exp_f32 v110, v110
  v_exp_f32 v111, v111
  v_exp_f32 v80, v80
  v_exp_f32 v81, v81
  v_smfmac_f32_32x32x32_bf16 v[160:175], v[252:255], v[104:111], v14
  v_exp_f32 v82, v82
  v_exp_f32 v83, v83
  v_exp_f32 v84, v84
  v_mfma_f32_32x32x16_bf16 v[96:111], v[48:51], v[40:43], 0
  v_exp_f32 v85, v85
  v_exp_f32 v86, v86
  v_exp_f32 v87, v87
  v_mfma_f32_32x32x16_bf16 v[96:111], v[52:55], v[44:47], v[96:111]
  v_exp_f32 v88, v88
  v_exp_f32 v89, v89
  v_exp_f32 v90, v90
  v_smfmac_f32_32x32x32_bf16 v[160:175], v[72:75], v[80:87], v14
  v_exp_f32 v91, v91
  v_exp_f32 v92, v92
  v_exp_f32 v93, v93
  v_exp_f32 v94, v94
  v_exp_f32 v95, v95
  v_exp_f32 v96, v96
  v_exp_f32 v97, v97
  v_smfmac_f32_32x32x32_bf16 v[160:175], v[76:79], v[88:95], v14
  v_exp_f32 v98, v98
  v_exp_f32 v99, v99
  v_exp_f32 v100, v100
  v_exp_f32 v101, v101
  s_barrier
  ds_read_b128 v[252:255], v7 offset:15360
  v_exp_f32 v102, v102
  ds_read_b128 v[240:243], v7 offset:12288
  v_exp_f32 v103, v103
  ds_read_b128 v[244:247], v7 offset:13312
  v_exp_f32 v104, v104
  ds_read_b128 v[248:251], v7 offset:14336
  v_exp_f32 v105, v105
  v_exp_f32 v106, v106
  v_smfmac_f32_32x32x32_bf16 v[160:175], v[56:59], v[96:103], v14
  v_exp_f32 v107, v107
  v_exp_f32 v108, v108
  v_exp_f32 v109, v109
  v_exp_f32 v110, v110
  v_exp_f32 v111, v111
  s_nop 1
  v_smfmac_f32_32x32x32_bf16 v[160:175], v[60:63], v[104:111], v14
  v_mov_b32 v115, s48
  v_mov_b32 v119, s48
  v_mov_b32 v123, s48
  s_not_b32 s78, s81
  s_not_b32 s79, s81
  s_nop 5
  s_waitcnt lgkmcnt(0)
  v_pk_add_f32 v[172:173], v[172:173], v[252:253]
  v_pk_add_f32 v[174:175], v[174:175], v[254:255]
  v_mov_b32 v9, v172
  v_mov_b32 v10, v172
  v_pk_add_f32 v[160:161], v[160:161], v[240:241]
  v_pk_add_f32 v[162:163], v[162:163], v[242:243]
  v_permlane32_swap_b32 v9, v10
  v_rcp_f32 v9, v10
  v_cmp_nlt_f32 vcc, 0x2b800000, v10
  v_pk_add_f32 v[164:165], v[164:165], v[244:245]
  s_mov_b64 s[76:77], vcc
  v_cmp_ngt_f32 vcc, 0x53800000, v10
  v_pk_add_f32 v[166:167], v[166:167], v[246:247]
  v_pk_add_f32 v[168:169], v[168:169], v[248:249]
  v_pk_add_f32 v[170:171], v[170:171], v[250:251]
  s_or_b64 s[76:77], s[76:77], vcc
  s_cbranch_scc1 L_slow
L_norm2:
  v_mov_b32 v10, v9
  v_mov_b32 v11, v9
  v_pk_mul_f32 v[160:161], v[160:161], v[10:11]
  v_pk_mul_f32 v[162:163], v[162:163], v[10:11]
  v_pk_mul_f32 v[164:165], v[164:165], v[10:11]
  v_cvt_pk_bf16_f32 v112, v160, v161
  v_cvt_pk_bf16_f32 v113, v162, v163
  v_cvt_pk_bf16_f32 v114, v164, v165
  s_mov_b64 exec, s[78:79]
  buffer_store_dwordx4 v[112:115], v13, s[36:39], s82 offen offset:0 sc1
  s_mov_b64 exec, -1
  v_pk_mul_f32 v[166:167], v[166:167], v[10:11]
  v_pk_mul_f32 v[168:169], v[168:169], v[10:11]
  v_pk_mul_f32 v[170:171], v[170:171], v[10:11]
  v_cvt_pk_bf16_f32 v116, v166, v167
  v_cvt_pk_bf16_f32 v117, v168, v169
  v_cvt_pk_bf16_f32 v118, v170, v171
  s_mov_b64 exec, s[78:79]
  buffer_store_dwordx4 v[116:119], v13, s[36:39], s82 offen offset:512 sc1
  s_mov_b64 exec, -1
  v_pk_mul_f32 v[172:173], v[172:173], v[10:11]
  v_pk_mul_f32 v[174:175], v[174:175], v[10:11]
  v_cvt_pk_bf16_f32 v120, v172, v173
  v_cvt_pk_bf16_f32 v121, v174, v175
  s_mov_b32 exec_lo, s78
  s_mov_b32 exec_hi, 0
  buffer_store_dwordx4 v[120:123], v13, s[36:39], s82 offen offset:1024 sc1
  s_cmp_eq_u32 s81, 0
  s_cbranch_scc1 L_noloc_13
  s_mov_b32 exec_lo, s81
  buffer_store_dwordx4 v[120:123], v13, s[36:39], s82 offen offset:1024
  s_mov_b32 exec_hi, s81
  buffer_store_dwordx4 v[112:115], v13, s[36:39], s82 offen offset:0
  buffer_store_dwordx4 v[116:119], v13, s[36:39], s82 offen offset:512
L_noloc_13:
  s_mov_b64 exec, -1
  s_setprio 0
  s_cmp_eq_u32 s9, 0
  s_cbranch_scc1 L_p3_b
  s_branch L_other
L_attb:
  ds_read_b128 v[16:19], v8
  ds_read_b128 v[20:23], v8 offset:1024
  ds_read_b128 v[24:27], v9
  ds_read_b128 v[28:31], v9 offset:1024
  ds_read_b128 v[32:35], v10
  ds_read_b128 v[36:39], v10 offset:1024
  ds_read_b128 v[40:43], v11
  ds_read_b128 v[44:47], v11 offset:1024
  s_waitcnt vmcnt(0)
  v_mov_b32 v2, v96
  v_mov_b32 v3, v85
  s_waitcnt vmcnt(0)
  v_cmp_ne_u32 s[76:77], s48, v2
  s_nop 0
  s_and_b32 s58, s76, 0xffff
  s_cbranch_scc0 L_kv1bp_go
  s_mov_b64 exec, 0xffff
  s_mov_b32 s75, 0
L_kv1bp_poll:
  buffer_load_dword v2, v3, s[36:39], 0 offen sc1
  s_add_u32 s75, s75, 1
  s_waitcnt vmcnt(0)
  v_cmp_ne_u32 s[76:77], s48, v2
  s_nop 0
  s_and_b32 s58, s76, 0xffff
  s_cbranch_scc0 L_kv1bp_ok
  s_cmp_ge_u32 s75, 262144
  s_cbranch_scc1 L_kv1bp_ok
  s_branch L_kv1bp_poll
L_kv1bp_ok:
  s_mov_b64 exec, -1
L_kv1bp_go:
  buffer_load_dwordx4 v[48:51], v15, s[36:39], s64 offen offset:0 sc1
  buffer_load_dwordx4 v[52:55], v15, s[36:39], s64 offen offset:1024 sc1
  buffer_load_dwordx4 v[56:59], v15, s[36:39], s64 offen offset:2048 sc1
  buffer_load_dwordx4 v[60:63], v15, s[36:39], s64 offen offset:3072 sc1
  buffer_load_dwordx4 v[176:179], v15, s[36:39], s65 offen offset:0 sc1
  buffer_load_dwordx4 v[180:183], v15, s[36:39], s65 offen offset:1024 sc1
  buffer_load_dwordx4 v[184:187], v15, s[36:39], s65 offen offset:2048 sc1
  buffer_load_dwordx4 v[188:191], v15, s[36:39], s65 offen offset:3072 sc1
  s_waitcnt vmcnt(6) lgkmcnt(6)
  v_mfma_f32_32x32x16_bf16 v[80:95], v[48:51], v[16:19], 0
  v_mfma_f32_32x32x16_bf16 v[80:95], v[52:55], v[20:23], v[80:95]
  s_nop 10
  s_waitcnt lgkmcnt(0)
  v_exp_f32 v80, v80
  v_exp_f32 v81, v81
  buffer_load_dwordx4 v[192:195], v15, s[36:39], s66 offen offset:0 sc1
  buffer_load_dwordx4 v[196:199], v15, s[36:39], s66 offen offset:1024 sc1
  v_exp_f32 v82, v82
  v_exp_f32 v83, v83
  v_exp_f32 v84, v84
  v_mfma_f32_32x32x16_bf16 v[96:111], v[48:51], v[24:27], 0
  v_exp_f32 v85, v85
  v_exp_f32 v86, v86
  buffer_load_dwordx4 v[200:203], v15, s[36:39], s66 offen offset:2048 sc1
  buffer_load_dwordx4 v[204:207], v15, s[36:39], s66 offen offset:3072 sc1
  v_exp_f32 v87, v87
  v_mfma_f32_32x32x16_bf16 v[96:111], v[52:55], v[28:31], v[96:111]
  v_exp_f32 v88, v88
  v_exp_f32 v89, v89
  v_exp_f32 v90, v90
  s_waitcnt vmcnt(8)
  v_smfmac_f32_32x32x32_bf16 v[112:127], v[56:59], v[80:87], v14
  v_exp_f32 v91, v91
  v_exp_f32 v92, v92
  v_exp_f32 v93, v93
  v_exp_f32 v94, v94
  v_exp_f32 v95, v95
  v_exp_f32 v96, v96
  v_exp_f32 v97, v97
  v_smfmac_f32_32x32x32_bf16 v[112:127], v[60:63], v[88:95], v14
  buffer_load_dwordx4 v[208:211], v15, s[36:39], s67 offen offset:0 sc1
  buffer_load_dwordx4 v[212:215], v15, s[36:39], s67 offen offset:1024 sc1
  v_exp_f32 v98, v98
  v_exp_f32 v99, v99
  v_exp_f32 v100, v100
  v_mfma_f32_32x32x16_bf16 v[80:95], v[48:51], v[32:35], 0
  v_exp_f32 v101, v101
  v_exp_f32 v102, v102
  buffer_load_dwordx4 v[216:219], v15, s[36:39], s67 offen offset:2048 sc1
  buffer_load_dwordx4 v[220:223], v15, s[36:39], s67 offen offset:3072 sc1
  v_exp_f32 v103, v103
  v_mfma_f32_32x32x16_bf16 v[80:95], v[52:55], v[36:39], v[80:95]
  v_exp_f32 v104, v104
  v_exp_f32 v105, v105
  v_exp_f32 v106, v106
  v_smfmac_f32_32x32x32_bf16 v[128:143], v[56:59], v[96:103], v14
  v_exp_f32 v107, v107
  v_exp_f32 v108, v108
  v_exp_f32 v109, v109
  v_exp_f32 v110, v110
  v_exp_f32 v111, v111
  v_exp_f32 v80, v80
  v_exp_f32 v81, v81
  v_smfmac_f32_32x32x32_bf16 v[128:143], v[60:63], v[104:111], v14
  buffer_load_dwordx4 v[224:227], v15, s[36:39], s68 offen offset:0 sc1
  buffer_load_dwordx4 v[228:231], v15, s[36:39], s68 offen offset:1024 sc1
  v_exp_f32 v82, v82
  v_exp_f32 v83, v83
  v_exp_f32 v84, v84
  v_mfma_f32_32x32x16_bf16 v[96:111], v[48:51], v[40:43], 0
  v_exp_f32 v85, v85
  v_exp_f32 v86, v86
  buffer_load_dwordx4 v[232:235], v15, s[36:39], s68 offen offset:2048 sc1
  buffer_load_dwordx4 v[236:239], v15, s[36:39], s68 offen offset:3072 sc1
  v_exp_f32 v87, v87
  v_mfma_f32_32x32x16_bf16 v[96:111], v[52:55], v[44:47], v[96:111]
  v_exp_f32 v88, v88
  v_exp_f32 v89, v89
  v_exp_f32 v90, v90
  v_smfmac_f32_32x32x32_bf16 v[144:159], v[56:59], v[80:87], v14
  v_exp_f32 v91, v91
  v_exp_f32 v92, v92
  v_exp_f32 v93, v93
  v_exp_f32 v94, v94
  v_exp_f32 v95, v95
  v_exp_f32 v96, v96
  v_exp_f32 v97, v97
  v_smfmac_f32_32x32x32_bf16 v[144:159], v[60:63], v[88:95], v14
  buffer_load_dwordx4 v[240:243], v15, s[36:39], s69 offen offset:0 sc1
  buffer_load_dwordx4 v[244:247], v15, s[36:39], s69 offen offset:1024 sc1
  v_exp_f32 v98, v98
  v_exp_f32 v99, v99
  v_exp_f32 v100, v100
  s_waitcnt vmcnt(16)
  v_mfma_f32_32x32x16_bf16 v[80:95], v[176:179], v[16:19], 0
  v_exp_f32 v101, v101
  v_exp_f32 v102, v102
  buffer_load_dwordx4 v[248:251], v15, s[36:39], s69 offen offset:2048 sc1
  buffer_load_dwordx4 v[252:255], v15, s[36:39], s69 offen offset:3072 sc1
  v_exp_f32 v103, v103
  v_mfma_f32_32x32x16_bf16 v[80:95], v[180:183], v[20:23], v[80:95]
  v_exp_f32 v104, v104
  v_exp_f32 v105, v105
  v_exp_f32 v106, v106
  v_smfmac_f32_32x32x32_bf16 v[160:175], v[56:59], v[96:103], v14
  v_exp_f32 v107, v107
  v_exp_f32 v108, v108
  v_exp_f32 v109, v109
  v_exp_f32 v110, v110
  v_exp_f32 v111, v111
  v_exp_f32 v80, v80
  v_exp_f32 v81, v81
  v_smfmac_f32_32x32x32_bf16 v[160:175], v[60:63], v[104:111], v14
  buffer_load_dwordx4 v[64:67], v15, s[36:39], s70 offen offset:0 sc1
  buffer_load_dwordx4 v[68:71], v15, s[36:39], s70 offen offset:1024 sc1
  v_exp_f32 v82, v82
  v_exp_f32 v83, v83
  v_exp_f32 v84, v84
  v_mfma_f32_32x32x16_bf16 v[96:111], v[176:179], v[24:27], 0
  v_exp_f32 v85, v85
  v_exp_f32 v86, v86
  buffer_load_dwordx4 v[72:75], v15, s[36:39], s70 offen offset:2048 sc1
  buffer_load_dwordx4 v[76:79], v15, s[36:39], s70 offen offset:3072 sc1
  v_exp_f32 v87, v87
  v_mfma_f32_32x32x16_bf16 v[96:111], v[180:183], v[28:31], v[96:111]
  v_exp_f32 v88, v88
  v_exp_f32 v89, v89
  v_exp_f32 v90, v90
  s_waitcnt vmcnt(20)
  v_smfmac_f32_32x32x32_bf16 v[112:127], v[184:187], v[80:87], v14
  v_exp_f32 v91, v91
  v_exp_f32 v92, v92
  v_exp_f32 v93, v93
  v_exp_f32 v94, v94
  v_exp_f32 v95, v95
  v_exp_f32 v96, v96
  v_exp_f32 v97, v97
  v_smfmac_f32_32x32x32_bf16 v[112:127], v[188:191], v[88:95], v14
  buffer_load_dwordx4 v[48:51], v15, s[36:39], s71 offen offset:0 sc1
  buffer_load_dwordx4 v[52:55], v15, s[36:39], s71 offen offset:1024 sc1
  v_exp_f32 v98, v98
  v_exp_f32 v99, v99
  v_exp_f32 v100, v100
  v_mfma_f32_32x32x16_bf16 v[80:95], v[176:179], v[32:35], 0
  v_exp_f32 v101, v101
  v_exp_f32 v102, v102
  buffer_load_dwordx4 v[56:59], v15, s[36:39], s71 offen offset:2048 sc1
  buffer_load_dwordx4 v[60:63], v15, s[36:39], s71 offen offset:3072 sc1
  v_exp_f32 v103, v103
  v_mfma_f32_32x32x16_bf16 v[80:95], v[180:183], v[36:39], v[80:95]
  v_exp_f32 v104, v104
  v_exp_f32 v105, v105
  v_exp_f32 v106, v106
  v_smfmac_f32_32x32x32_bf16 v[128:143], v[184:187], v[96:103], v14
  v_exp_f32 v107, v107
  v_exp_f32 v108, v108
  v_exp_f32 v109, v109
  v_exp_f32 v110, v110
  v_exp_f32 v111, v111
  v_exp_f32 v80, v80
  v_exp_f32 v81, v81
  v_smfmac_f32_32x32x32_bf16 v[128:143], v[188:191], v[104:111], v14
  v_exp_f32 v82, v82
  v_exp_f32 v83, v83
  v_exp_f32 v84, v84
  v_mfma_f32_32x32x16_bf16 v[96:111], v[176:179], v[40:43], 0
  v_exp_f32 v85, v85
  v_exp_f32 v86, v86
  v_exp_f32 v87, v87
  v_mfma_f32_32x32x16_bf16 v[96:111], v[180:183], v[44:47], v[96:111]
  v_exp_f32 v88, v88
  v_exp_f32 v89, v89
  v_exp_f32 v90, v90
  v_smfmac_f32_32x32x32_bf16 v[144:159], v[184:187], v[80:87], v14
  v_exp_f32 v91, v91
  v_exp_f32 v92, v92
  v_exp_f32 v93, v93
  v_exp_f32 v94, v94
  v_exp_f32 v95, v95
  v_exp_f32 v96, v96
  v_exp_f32 v97, v97
  v_smfmac_f32_32x32x32_bf16 v[144:159], v[188:191], v[88:95], v14
  v_exp_f32 v98, v98
  v_exp_f32 v99, v99
  v_exp_f32 v100, v100
  s_waitcnt vmcnt(22)
  v_mfma_f32_32x32x16_bf16 v[80:95], v[192:195], v[16:19], 0
  v_exp_f32 v101, v101
  v_exp_f32 v102, v102
  v_exp_f32 v103, v103
  v_mfma_f32_32x32x16_bf16 v[80:95], v[196:199], v[20:23], v[80:95]
  v_exp_f32 v104, v104
  v_exp_f32 v105, v105
  v_exp_f32 v106, v106
  v_smfmac_f32_32x32x32_bf16 v[160:175], v[184:187], v[96:103], v14
  v_exp_f32 v107, v107
  v_exp_f32 v108, v108
  v_exp_f32 v109, v109
  v_exp_f32 v110, v110
  v_exp_f32 v111, v111
  v_exp_f32 v80, v80
  v_exp_f32 v81, v81
  v_smfmac_f32_32x32x32_bf16 v[160:175], v[188:191], v[104:111], v14
  v_exp_f32 v82, v82
  v_exp_f32 v83, v83
  v_exp_f32 v84, v84
  s_waitcnt vmcnt(18)
  v_mfma_f32_32x32x16_bf16 v[96:111], v[208:211], v[16:19], 0
  v_exp_f32 v85, v85
  v_exp_f32 v86, v86
  v_exp_f32 v87, v87
  v_mfma_f32_32x32x16_bf16 v[96:111], v[212:215], v[20:23], v[96:111]
  v_exp_f32 v88, v88
  v_exp_f32 v89, v89
  v_exp_f32 v90, v90
  v_smfmac_f32_32x32x32_bf16 v[112:127], v[200:203], v[80:87], v14
  v_exp_f32 v91, v91
  v_exp_f32 v92, v92
  v_exp_f32 v93, v93
  v_exp_f32 v94, v94
  v_exp_f32 v95, v95
  v_exp_f32 v96, v96
  v_exp_f32 v97, v97
  v_smfmac_f32_32x32x32_bf16 v[112:127], v[204:207], v[88:95], v14
  v_exp_f32 v98, v98
  v_exp_f32 v99, v99
  v_exp_f32 v100, v100
  s_waitcnt vmcnt(14)
  v_mfma_f32_32x32x16_bf16 v[80:95], v[224:227], v[16:19], 0
  v_exp_f32 v101, v101
  v_exp_f32 v102, v102
  v_exp_f32 v103, v103
  v_mfma_f32_32x32x16_bf16 v[80:95], v[228:231], v[20:23], v[80:95]
  v_exp_f32 v104, v104
  v_exp_f32 v105, v105
  v_exp_f32 v106, v106
  v_smfmac_f32_32x32x32_bf16 v[112:127], v[216:219], v[96:103], v14
  v_exp_f32 v107, v107
  v_exp_f32 v108, v108
  v_exp_f32 v109, v109
  v_exp_f32 v110, v110
  v_exp_f32 v111, v111
  v_exp_f32 v80, v80
  v_exp_f32 v81, v81
  v_smfmac_f32_32x32x32_bf16 v[112:127], v[220:223], v[104:111], v14
  v_exp_f32 v82, v82
  v_exp_f32 v83, v83
  v_exp_f32 v84, v84
  s_waitcnt vmcnt(10)
  v_mfma_f32_32x32x16_bf16 v[96:111], v[240:243], v[16:19], 0
  v_exp_f32 v85, v85
  v_exp_f32 v86, v86
  v_exp_f32 v87, v87
  v_mfma_f32_32x32x16_bf16 v[96:111], v[244:247], v[20:23], v[96:111]
  v_exp_f32 v88, v88
  v_exp_f32 v89, v89
  v_exp_f32 v90, v90
  v_smfmac_f32_32x32x32_bf16 v[112:127], v[232:235], v[80:87], v14
  v_exp_f32 v91, v91
  v_exp_f32 v92, v92
  v_exp_f32 v93, v93
  v_exp_f32 v94, v94
  v_exp_f32 v95, v95
  v_exp_f32 v96, v96
  v_exp_f32 v97, v97
  v_smfmac_f32_32x32x32_bf16 v[112:127], v[236:239], v[88:95], v14
  v_exp_f32 v98, v98
  v_exp_f32 v99, v99
  v_exp_f32 v100, v100
  s_waitcnt vmcnt(6)
  v_mfma_f32_32x32x16_bf16 v[80:95], v[64:67], v[16:19], 0
  v_exp_f32 v101, v101
  v_exp_f32 v102, v102
  v_exp_f32 v103, v103
  v_mfma_f32_32x32x16_bf16 v[80:95], v[68:71], v[20:23], v[80:95]
  v_exp_f32 v104, v104
  v_exp_f32 v105, v105
  v_exp_f32 v106, v106
  v_smfmac_f32_32x32x32_bf16 v[112:127], v[248:251], v[96:103], v14
  v_exp_f32 v107, v107
  v_exp_f32 v108, v108
  v_exp_f32 v109, v109
  v_exp_f32 v110, v110
  v_exp_f32 v111, v111
  v_exp_f32 v80, v80
  v_exp_f32 v81, v81
  v_smfmac_f32_32x32x32_bf16 v[112:127], v[252:255], v[104:111], v14
  v_exp_f32 v82, v82
  v_exp_f32 v83, v83
  v_exp_f32 v84, v84
  s_waitcnt vmcnt(2)
  v_mfma_f32_32x32x16_bf16 v[96:111], v[48:51], v[16:19], 0
  v_exp_f32 v85, v85
  v_exp_f32 v86, v86
  v_exp_f32 v87, v87
  v_mfma_f32_32x32x16_bf16 v[96:111], v[52:55], v[20:23], v[96:111]
  v_exp_f32 v88, v88
  v_exp_f32 v89, v89
  v_exp_f32 v90, v90
  v_smfmac_f32_32x32x32_bf16 v[112:127], v[72:75], v[80:87], v14
  v_exp_f32 v91, v91
  v_exp_f32 v92, v92
  v_exp_f32 v93, v93
  v_exp_f32 v94, v94
  v_exp_f32 v95, v95
  s_barrier
  s_setprio 1
  v_exp_f32 v96, v96
  v_exp_f32 v97, v97
  v_smfmac_f32_32x32x32_bf16 v[112:127], v[76:79], v[88:95], v14
  v_exp_f32 v98, v98
  v_exp_f32 v99, v99
  v_exp_f32 v100, v100
  v_mfma_f32_32x32x16_bf16 v[80:95], v[192:195], v[24:27], 0
  v_exp_f32 v101, v101
  v_exp_f32 v102, v102
  v_exp_f32 v103, v103
  v_mfma_f32_32x32x16_bf16 v[80:95], v[196:199], v[28:31], v[80:95]
  v_exp_f32 v104, v104
  v_exp_f32 v105, v105
  v_exp_f32 v106, v106
  s_waitcnt vmcnt(0)
  v_smfmac_f32_32x32x32_bf16 v[112:127], v[56:59], v[96:103], v14
  v_exp_f32 v107, v107
  v_exp_f32 v108, v108
  v_exp_f32 v109, v109
  v_exp_f32 v110, v110
  v_exp_f32 v111, v111
  v_exp_f32 v80, v80
  v_exp_f32 v81, v81
  v_smfmac_f32_32x32x32_bf16 v[112:127], v[60:63], v[104:111], v14
  v_exp_f32 v82, v82
  v_exp_f32 v83, v83
  v_exp_f32 v84, v84
  v_mfma_f32_32x32x16_bf16 v[96:111], v[208:211], v[24:27], 0
  v_exp_f32 v85, v85
  v_exp_f32 v86, v86
  v_exp_f32 v87, v87
  v_mfma_f32_32x32x16_bf16 v[96:111], v[212:215], v[28:31], v[96:111]
  v_exp_f32 v88, v88
  v_exp_f32 v89, v89
  v_exp_f32 v90, v90
  v_smfmac_f32_32x32x32_bf16 v[128:143], v[200:203], v[80:87], v14
  v_exp_f32 v91, v91
  ds_write_b128 v4, v[112:115] offset:0
  v_exp_f32 v92, v92
  v_exp_f32 v93, v93
  v_exp_f32 v94, v94
  v_exp_f32 v95, v95
  v_exp_f32 v96, v96
  v_exp_f32 v97, v97
  v_smfmac_f32_32x32x32_bf16 v[128:143], v[204:207], v[88:95], v14
  v_exp_f32 v98, v98
  v_exp_f32 v99, v99
  v_exp_f32 v100, v100
  v_mfma_f32_32x32x16_bf16 v[80:95], v[224:227], v[24:27], 0
  v_exp_f32 v101, v101
  v_exp_f32 v102, v102
  ds_write_b128 v4, v[116:119] offset:1024
  v_exp_f32 v103, v103
  v_mfma_f32_32x32x16_bf16 v[80:95], v[228:231], v[28:31], v[80:95]
  v_exp_f32 v104, v104
  v_exp_f32 v105, v105
  v_exp_f32 v106, v106
  v_smfmac_f32_32x32x32_bf16 v[128:143], v[216:219], v[96:103], v14
  v_exp_f32 v107, v107
  ds_write_b128 v4, v[120:123] offset:2048
  v_exp_f32 v108, v108
  v_exp_f32 v109, v109
  v_exp_f32 v110, v110
  v_exp_f32 v111, v111
  v_exp_f32 v80, v80
  v_exp_f32 v81, v81
  v_smfmac_f32_32x32x32_bf16 v[128:143], v[220:223], v[104:111], v14
  v_exp_f32 v82, v82
  v_exp_f32 v83, v83
  v_exp_f32 v84, v84
  v_mfma_f32_32x32x16_bf16 v[96:111], v[240:243], v[24:27], 0
  v_exp_f32 v85, v85
  v_exp_f32 v86, v86
  ds_write_b128 v4, v[124:127] offset:3072
  v_exp_f32 v87, v87
  v_mfma_f32_32x32x16_bf16 v[96:111], v[244:247], v[28:31], v[96:111]
  v_exp_f32 v88, v88
  v_exp_f32 v89, v89
  v_exp_f32 v90, v90
  v_smfmac_f32_32x32x32_bf16 v[128:143], v[232:235], v[80:87], v14
  v_exp_f32 v91, v91
  v_exp_f32 v92, v92
  v_exp_f32 v93, v93
  v_exp_f32 v94, v94
  v_exp_f32 v95, v95
  v_exp_f32 v96, v96
  v_exp_f32 v97, v97
  v_smfmac_f32_32x32x32_bf16 v[128:143], v[236:239], v[88:95], v14
  v_exp_f32 v98, v98
  v_exp_f32 v99, v99
  v_exp_f32 v100, v100
  v_mfma_f32_32x32x16_bf16 v[80:95], v[64:67], v[24:27], 0
  v_exp_f32 v101, v101
  v_exp_f32 v102, v102
  v_exp_f32 v103, v103
  v_mfma_f32_32x32x16_bf16 v[80:95], v[68:71], v[28:31], v[80:95]
  v_exp_f32 v104, v104
  v_exp_f32 v105, v105
  v_exp_f32 v106, v106
  v_smfmac_f32_32x32x32_bf16 v[128:143], v[248:251], v[96:103], v14
  v_exp_f32 v107, v107
  v_exp_f32 v108, v108
  v_exp_f32 v109, v109
  v_exp_f32 v110, v110
  v_exp_f32 v111, v111
  v_exp_f32 v80, v80
  v_exp_f32 v81, v81
  v_smfmac_f32_32x32x32_bf16 v[128:143], v[252:255], v[104:111], v14
  v_exp_f32 v82, v82
  v_exp_f32 v83, v83
  v_exp_f32 v84, v84
  v_mfma_f32_32x32x16_bf16 v[96:111], v[48:51], v[24:27], 0
  v_exp_f32 v85, v85
  v_exp_f32 v86, v86
  v_exp_f32 v87, v87
  v_mfma_f32_32x32x16_bf16 v[96:111], v[52:55], v[28:31], v[96:111]
  v_exp_f32 v88, v88
  v_exp_f32 v89, v89
  v_exp_f32 v90, v90
  v_smfmac_f32_32x32x32_bf16 v[128:143], v[72:75], v[80:87], v14
  v_exp_f32 v91, v91
  v_exp_f32 v92, v92
  v_exp_f32 v93, v93
  v_exp_f32 v94, v94
  v_exp_f32 v95, v95
  v_exp_f32 v96, v96
  v_exp_f32 v97, v97
  v_smfmac_f32_32x32x32_bf16 v[128:143], v[76:79], v[88:95], v14
  v_exp_f32 v98, v98
  v_exp_f32 v99, v99
  v_exp_f32 v100, v100
  v_mfma_f32_32x32x16_bf16 v[80:95], v[192:195], v[32:35], 0
  v_exp_f32 v101, v101
  v_exp_f32 v102, v102
  v_exp_f32 v103, v103
  v_mfma_f32_32x32x16_bf16 v[80:95], v[196:199], v[36:39], v[80:95]
  v_exp_f32 v104, v104
  v_exp_f32 v105, v105
  v_exp_f32 v106, v106
  v_smfmac_f32_32x32x32_bf16 v[128:143], v[56:59], v[96:103], v14
  v_exp_f32 v107, v107
  v_exp_f32 v108, v108
  v_exp_f32 v109, v109
  v_exp_f32 v110, v110
  v_exp_f32 v111, v111
  v_exp_f32 v80, v80
  v_exp_f32 v81, v81
  v_smfmac_f32_32x32x32_bf16 v[128:143], v[60:63], v[104:111], v14
  v_exp_f32 v82, v82
  v_exp_f32 v83, v83
  v_exp_f32 v84, v84
  v_mfma_f32_32x32x16_bf16 v[96:111], v[208:211], v[32:35], 0
  v_exp_f32 v85, v85
  v_exp_f32 v86, v86
  v_exp_f32 v87, v87
  v_mfma_f32_32x32x16_bf16 v[96:111], v[212:215], v[36:39], v[96:111]
  v_exp_f32 v88, v88
  v_exp_f32 v89, v89
  v_exp_f32 v90, v90
  v_smfmac_f32_32x32x32_bf16 v[144:159], v[200:203], v[80:87], v14
  v_exp_f32 v91, v91
  ds_write_b128 v5, v[128:131] offset:4096
  v_exp_f32 v92, v92
  v_exp_f32 v93, v93
  v_exp_f32 v94, v94
  v_exp_f32 v95, v95
  v_exp_f32 v96, v96
  v_exp_f32 v97, v97
  v_smfmac_f32_32x32x32_bf16 v[144:159], v[204:207], v[88:95], v14
  v_exp_f32 v98, v98
  v_exp_f32 v99, v99
  v_exp_f32 v100, v100
  v_mfma_f32_32x32x16_bf16 v[80:95], v[224:227], v[32:35], 0
  v_exp_f32 v101, v101
  v_exp_f32 v102, v102
  ds_write_b128 v5, v[132:135] offset:5120
  v_exp_f32 v103, v103
  v_mfma_f32_32x32x16_bf16 v[80:95], v[228:231], v[36:39], v[80:95]
  v_exp_f32 v104, v104
  v_exp_f32 v105, v105
  v_exp_f32 v106, v106
  v_smfmac_f32_32x32x32_bf16 v[144:159], v[216:219], v[96:103], v14
  v_exp_f32 v107, v107
  ds_write_b128 v5, v[136:139] offset:6144
  v_exp_f32 v108, v108
  v_exp_f32 v109, v109
  v_exp_f32 v110, v110
  v_exp_f32 v111, v111
  v_exp_f32 v80, v80
  v_exp_f32 v81, v81
  v_smfmac_f32_32x32x32_bf16 v[144:159], v[220:223], v[104:111], v14
  v_exp_f32 v82, v82
  v_exp_f32 v83, v83
  v_exp_f32 v84, v84
  v_mfma_f32_32x32x16_bf16 v[96:111], v[240:243], v[32:35], 0
  v_exp_f32 v85, v85
  v_exp_f32 v86, v86
  ds_write_b128 v5, v[140:143] offset:7168
  v_exp_f32 v87, v87
  v_mfma_f32_32x32x16_bf16 v[96:111], v[244:247], v[36:39], v[96:111]
  v_exp_f32 v88, v88
  v_exp_f32 v89, v89
  v_exp_f32 v90, v90
  v_smfmac_f32_32x32x32_bf16 v[144:159], v[232:235], v[80:87], v14
  v_exp_f32 v91, v91
  v_exp_f32 v92, v92
  v_exp_f32 v93, v93
  v_exp_f32 v94, v94
  v_exp_f32 v95, v95
  v_exp_f32 v96, v96
  v_exp_f32 v97, v97
  v_smfmac_f32_32x32x32_bf16 v[144:159], v[236:239], v[88:95], v14
  v_exp_f32 v98, v98
  v_exp_f32 v99, v99
  v_exp_f32 v100, v100
  v_mfma_f32_32x32x16_bf16 v[80:95], v[64:67], v[32:35], 0
  v_exp_f32 v101, v101
  v_exp_f32 v102, v102
  v_exp_f32 v103, v103
  v_mfma_f32_32x32x16_bf16 v[80:95], v[68:71], v[36:39], v[80:95]
  v_exp_f32 v104, v104
  v_exp_f32 v105, v105
  v_exp_f32 v106, v106
  v_smfmac_f32_32x32x32_bf16 v[144:159], v[248:251], v[96:103], v14
  v_exp_f32 v107, v107
  v_exp_f32 v108, v108
  v_exp_f32 v109, v109
  v_exp_f32 v110, v110
  v_exp_f32 v111, v111
  v_exp_f32 v80, v80
  v_exp_f32 v81, v81
  v_smfmac_f32_32x32x32_bf16 v[144:159], v[252:255], v[104:111], v14
  v_exp_f32 v82, v82
  v_exp_f32 v83, v83
  v_exp_f32 v84, v84
  v_mfma_f32_32x32x16_bf16 v[96:111], v[48:51], v[32:35], 0
  v_exp_f32 v85, v85
  v_exp_f32 v86, v86
  v_exp_f32 v87, v87
  v_mfma_f32_32x32x16_bf16 v[96:111], v[52:55], v[36:39], v[96:111]
  v_exp_f32 v88, v88
  v_exp_f32 v89, v89
  v_exp_f32 v90, v90
  v_smfmac_f32_32x32x32_bf16 v[144:159], v[72:75], v[80:87], v14
  v_exp_f32 v91, v91
  v_exp_f32 v92, v92
  v_exp_f32 v93, v93
  v_exp_f32 v94, v94
  v_exp_f32 v95, v95
  v_exp_f32 v96, v96
  v_exp_f32 v97, v97
  v_smfmac_f32_32x32x32_bf16 v[144:159], v[76:79], v[88:95], v14
  v_exp_f32 v98, v98
  v_exp_f32 v99, v99
  v_exp_f32 v100, v100
  v_mfma_f32_32x32x16_bf16 v[80:95], v[192:195], v[40:43], 0
  v_exp_f32 v101, v101
  v_exp_f32 v102, v102
  v_exp_f32 v103, v103
  v_mfma_f32_32x32x16_bf16 v[80:95], v[196:199], v[44:47], v[80:95]
  v_exp_f32 v104, v104
  v_exp_f32 v105, v105
  v_exp_f32 v106, v106
  v_smfmac_f32_32x32x32_bf16 v[144:159], v[56:59], v[96:103], v14
  v_exp_f32 v107, v107
  v_exp_f32 v108, v108
  v_exp_f32 v109, v109
  v_exp_f32 v110, v110
  v_exp_f32 v111, v111
  v_exp_f32 v80, v80
  v_exp_f32 v81, v81
  v_smfmac_f32_32x32x32_bf16 v[144:159], v[60:63], v[104:111], v14
  v_exp_f32 v82, v82
  v_exp_f32 v83, v83
  v_exp_f32 v84, v84
  v_mfma_f32_32x32x16_bf16 v[96:111], v[208:211], v[40:43], 0
  v_exp_f32 v85, v85
  v_exp_f32 v86, v86
  v_exp_f32 v87, v87
  v_mfma_f32_32x32x16_bf16 v[96:111], v[212:215], v[44:47], v[96:111]
  v_exp_f32 v88, v88
  v_exp_f32 v89, v89
  v_exp_f32 v90, v90
  v_smfmac_f32_32x32x32_bf16 v[160:175], v[200:203], v[80:87], v14
  v_exp_f32 v91, v91
  ds_write_b128 v6, v[144:147] offset:8192
  v_exp_f32 v92, v92
  ds_write_b128 v6, v[148:151] offset:9216
  v_exp_f32 v93, v93
  ds_write_b128 v6, v[152:155] offset:10240
  v_exp_f32 v94, v94
  ds_write_b128 v6, v[156:159] offset:11264
  v_exp_f32 v95, v95
  v_exp_f32 v96, v96
  v_exp_f32 v97, v97
  v_smfmac_f32_32x32x32_bf16 v[160:175], v[204:207], v[88:95], v14
  v_exp_f32 v98, v98
  v_exp_f32 v99, v99
  v_exp_f32 v100, v100
  v_mfma_f32_32x32x16_bf16 v[80:95], v[224:227], v[40:43], 0
  v_exp_f32 v101, v101
  v_exp_f32 v102, v102
  s_waitcnt lgkmcnt(0)
  s_barrier
  v_exp_f32 v103, v103
  v_mfma_f32_32x32x16_bf16 v[80:95], v[228:231], v[44:47], v[80:95]
  v_exp_f32 v104, v104
  v_exp_f32 v105, v105
  v_exp_f32 v106, v106
  v_smfmac_f32_32x32x32_bf16 v[160:175], v[216:219], v[96:103], v14
  v_exp_f32 v107, v107
  v_exp_f32 v108, v108
  v_exp_f32 v109, v109
  v_exp_f32 v110, v110
  v_exp_f32 v111, v111
  v_exp_f32 v80, v80
  v_exp_f32 v81, v81
  v_smfmac_f32_32x32x32_bf16 v[160:175], v[220:223], v[104:111], v14
  v_exp_f32 v82, v82
  v_exp_f32 v83, v83
  v_exp_f32 v84, v84
  v_mfma_f32_32x32x16_bf16 v[96:111], v[240:243], v[40:43], 0
  v_exp_f32 v85, v85
  v_exp_f32 v86, v86
  v_exp_f32 v87, v87
  v_mfma_f32_32x32x16_bf16 v[96:111], v[244:247], v[44:47], v[96:111]
  v_exp_f32 v88, v88
  v_exp_f32 v89, v89
  v_exp_f32 v90, v90
  v_smfmac_f32_32x32x32_bf16 v[160:175], v[232:235], v[80:87], v14
  v_exp_f32 v91, v91
  v_exp_f32 v92, v92
  v_exp_f32 v93, v93
  v_exp_f32 v94, v94
  v_exp_f32 v95, v95
  v_exp_f32 v96, v96
  v_exp_f32 v97, v97
  v_smfmac_f32_32x32x32_bf16 v[160:175], v[236:239], v[88:95], v14
  v_exp_f32 v98, v98
  v_exp_f32 v99, v99
  v_exp_f32 v100, v100
  v_mfma_f32_32x32x16_bf16 v[80:95], v[64:67], v[40:43], 0
  v_exp_f32 v101, v101
  v_exp_f32 v102, v102
  v_exp_f32 v103, v103
  v_mfma_f32_32x32x16_bf16 v[80:95], v[68:71], v[44:47], v[80:95]
  v_exp_f32 v104, v104
  v_exp_f32 v105, v105
  v_exp_f32 v106, v106
  v_smfmac_f32_32x32x32_bf16 v[160:175], v[248:251], v[96:103], v14
  v_exp_f32 v107, v107
  v_exp_f32 v108, v108
  v_exp_f32 v109, v109
  v_exp_f32 v110, v110
  v_exp_f32 v111, v111
  v_exp_f32 v80, v80
  v_exp_f32 v81, v81
  v_smfmac_f32_32x32x32_bf16 v[160:175], v[252:255], v[104:111], v14
  v_exp_f32 v82, v82
  v_exp_f32 v83, v83
  v_exp_f32 v84, v84
  v_mfma_f32_32x32x16_bf16 v[96:111], v[48:51], v[40:43], 0
  v_exp_f32 v85, v85
  v_exp_f32 v86, v86
  v_exp_f32 v87, v87
  v_mfma_f32_32x32x16_bf16 v[96:111], v[52:55], v[44:47], v[96:111]
  v_exp_f32 v88, v88
  v_exp_f32 v89, v89
  v_exp_f32 v90, v90
  v_smfmac_f32_32x32x32_bf16 v[160:175], v[72:75], v[80:87], v14
  v_exp_f32 v91, v91
  v_exp_f32 v92, v92
  v_exp_f32 v93, v93
  v_exp_f32 v94, v94
  v_exp_f32 v95, v95
  v_exp_f32 v96, v96
  v_exp_f32 v97, v97
  v_smfmac_f32_32x32x32_bf16 v[160:175], v[76:79], v[88:95], v14
  v_exp_f32 v98, v98
  v_exp_f32 v99, v99
  v_exp_f32 v100, v100
  v_exp_f32 v101, v101
  s_barrier
  ds_read_b128 v[252:255], v7 offset:15360
  v_exp_f32 v102, v102
  ds_read_b128 v[240:243], v7 offset:12288
  v_exp_f32 v103, v103
  ds_read_b128 v[244:247], v7 offset:13312
  v_exp_f32 v104, v104
  ds_read_b128 v[248:251], v7 offset:14336
  v_exp_f32 v105, v105
  v_exp_f32 v106, v106
  v_smfmac_f32_32x32x32_bf16 v[160:175], v[56:59], v[96:103], v14
  v_exp_f32 v107, v107
  v_exp_f32 v108, v108
  v_exp_f32 v109, v109
  v_exp_f32 v110, v110
  v_exp_f32 v111, v111
  s_nop 1
  v_smfmac_f32_32x32x32_bf16 v[160:175], v[60:63], v[104:111], v14
  v_mov_b32 v115, s48
  v_mov_b32 v119, s48
  v_mov_b32 v123, s48
  s_not_b32 s78, s81
  s_not_b32 s79, s81
  s_nop 5
  s_waitcnt lgkmcnt(0)
  v_pk_add_f32 v[172:173], v[172:173], v[252:253]
  v_pk_add_f32 v[174:175], v[174:175], v[254:255]
  v_mov_b32 v9, v172
  v_mov_b32 v10, v172
  v_pk_add_f32 v[160:161], v[160:161], v[240:241]
  v_pk_add_f32 v[162:163], v[162:163], v[242:243]
  v_permlane32_swap_b32 v9, v10
  v_rcp_f32 v9, v10
  v_cmp_nlt_f32 vcc, 0x2b800000, v10
  v_pk_add_f32 v[164:165], v[164:165], v[244:245]
  s_mov_b64 s[76:77], vcc
  v_cmp_ngt_f32 vcc, 0x53800000, v10
  v_pk_add_f32 v[166:167], v[166:167], v[246:247]
  v_pk_add_f32 v[168:169], v[168:169], v[248:249]
  v_pk_add_f32 v[170:171], v[170:171], v[250:251]
  s_or_b64 s[76:77], s[76:77], vcc
  s_cbranch_scc1 L_slow
  v_mov_b32 v10, v9
  v_mov_b32 v11, v9
  v_pk_mul_f32 v[160:161], v[160:161], v[10:11]
  v_pk_mul_f32 v[162:163], v[162:163], v[10:11]
  v_pk_mul_f32 v[164:165], v[164:165], v[10:11]
  v_cvt_pk_bf16_f32 v112, v160, v161
  v_cvt_pk_bf16_f32 v113, v162, v163
  v_cvt_pk_bf16_f32 v114, v164, v165
  s_mov_b64 exec, s[78:79]
  buffer_store_dwordx4 v[112:115], v13, s[36:39], s82 offen offset:0 sc1
  s_mov_b64 exec, -1
  v_pk_mul_f32 v[166:167], v[166:167], v[10:11]
  v_pk_mul_f32 v[168:169], v[168:169], v[10:11]
  v_pk_mul_f32 v[170:171], v[170:171], v[10:11]
  v_cvt_pk_bf16_f32 v116, v166, v167
  v_cvt_pk_bf16_f32 v117, v168, v169
  v_cvt_pk_bf16_f32 v118, v170, v171
  s_mov_b64 exec, s[78:79]
  buffer_store_dwordx4 v[116:119], v13, s[36:39], s82 offen offset:512 sc1
  s_mov_b64 exec, -1
  v_pk_mul_f32 v[172:173], v[172:173], v[10:11]
  v_pk_mul_f32 v[174:175], v[174:175], v[10:11]
  v_cvt_pk_bf16_f32 v120, v172, v173
  v_cvt_pk_bf16_f32 v121, v174, v175
  s_mov_b32 exec_lo, s78
  s_mov_b32 exec_hi, 0
  buffer_store_dwordx4 v[120:123], v13, s[36:39], s82 offen offset:1024 sc1
  s_cmp_eq_u32 s81, 0
  s_cbranch_scc1 L_noloc_14
  s_mov_b32 exec_lo, s81
  buffer_store_dwordx4 v[120:123], v13, s[36:39], s82 offen offset:1024
  s_mov_b32 exec_hi, s81
  buffer_store_dwordx4 v[112:115], v13, s[36:39], s82 offen offset:0
  buffer_store_dwordx4 v[116:119], v13, s[36:39], s82 offen offset:512
L_noloc_14:
  s_mov_b64 exec, -1
  s_setprio 0
L_p3_b:
  s_barrier
  s_mov_b32 s62, 0
  v_lshrrev_b32 v4, 4, v1
  v_and_b32 v5, 15, v1
  v_lshlrev_b32 v5, 4, v5
  s_mov_b32 s44, s20
  s_mov_b32 s45, s21
  s_mov_b32 s46, 0x1c0000
  s_mov_b32 s47, 0x20000
  s_lshr_b32 s58, s3, 1
  s_lshl_b32 s58, s58, 6
  s_and_b32 s59, s3, 1
  s_mul_i32 s63, s59, 48
  s_add_u32 s63, s63, 8
  s_lshl_b32 s59, s59, 3
  s_add_u32 s58, s58, s59
  v_lshl_add_u32 v14, v4, 4, s58
  v_add_u32 v9, 131072, v14
  v_add_u32 v11, s63, v9
  v_bfe_u32 v2, v1, 2, 2
  v_and_b32 v3, 3, v1
  v_mul_u32_u24 v3, 912, v3
  v_lshl_add_u32 v3, v2, 14, v3
  v_add_u32 v8, v3, v14
  v_add_u32 v8, 12288, v8
  v_add_u32 v10, s63, v8
  v_mul_u32_u24 v7, 58, v5
  v_add_u32 v7, 65536, v7
  v_mul_u32_u24 v6, 12, v4
  s_mul_i32 s58, s62, 112
  v_add3_u32 v6, v6, v7, s58
  v_lshl_add_u32 v3, v4, 2, v5
  v_lshlrev_b32 v3, 3, v3
  v_add_u32 v3, 80896, v3
  s_lshl_b32 s58, s49, 2
  v_add_u32 v2, s58, v3
  v_lshl_add_u32 v5, v4, 4, v7
  s_lshl_b32 s58, s54, 14
  v_add_u32 v7, s58, v15
  ds_read_b64 v[128:129], v8 offset:0
  ds_read_b64 v[136:137], v9 offset:0
  ds_read_b64 v[130:131], v8 offset:64
  ds_read_b64 v[138:139], v9 offset:64
  ds_read_b64 v[132:133], v10 offset:0
  ds_read_b64 v[140:141], v11 offset:0
  s_waitcnt lgkmcnt(0)
  v_lshlrev_b32 v112, 16, v128
  v_and_b32 v113, 0xffff0000, v128
  v_lshlrev_b32 v160, 16, v136
  v_and_b32 v161, 0xffff0000, v136
  v_lshlrev_b32 v114, 16, v129
  v_and_b32 v115, 0xffff0000, v129
  v_lshlrev_b32 v162, 16, v137
  v_and_b32 v163, 0xffff0000, v137
  v_lshlrev_b32 v116, 16, v130
  v_and_b32 v117, 0xffff0000, v130
  v_lshlrev_b32 v164, 16, v138
  v_and_b32 v165, 0xffff0000, v138
  v_lshlrev_b32 v118, 16, v131
  v_and_b32 v119, 0xffff0000, v131
  v_lshlrev_b32 v166, 16, v139
  v_and_b32 v167, 0xffff0000, v139
  v_lshlrev_b32 v120, 16, v132
  v_and_b32 v121, 0xffff0000, v132
  v_lshlrev_b32 v168, 16, v140
  v_and_b32 v169, 0xffff0000, v140
  v_lshlrev_b32 v122, 16, v133
  v_and_b32 v123, 0xffff0000, v133
  v_lshlrev_b32 v170, 16, v141
  v_and_b32 v171, 0xffff0000, v141
  v_add_f32 v13, v160, v161
  v_add_f32 v13, v13, v162
  v_add_f32 v13, v13, v163
  v_add_f32 v13, v13, v164
  v_add_f32 v13, v13, v165
  v_add_f32 v13, v13, v166
  v_add_f32 v13, v13, v167
  v_add_f32 v13, v13, v168
  v_add_f32 v13, v13, v169
  v_add_f32 v13, v13, v170
  v_add_f32 v13, v13, v171
  s_add_u32 s58, s83, 0
  buffer_load_dwordx4 v[176:179], v15, s[36:39], s58 offen offset:0 sc1
  buffer_load_dwordx4 v[180:183], v15, s[36:39], s58 offen offset:2048 sc1
  buffer_load_dwordx4 v[184:187], v15, s[36:39], s58 offen offset:1024 sc1
  s_add_u32 s58, s83, 28672
  buffer_load_dwordx4 v[188:191], v15, s[36:39], s58 offen offset:0 sc1
  buffer_load_dwordx4 v[192:195], v15, s[36:39], s58 offen offset:2048 sc1
  buffer_load_dwordx4 v[196:199], v15, s[36:39], s58 offen offset:1024 sc1
  s_add_u32 s58, s83, 57344
  buffer_load_dwordx4 v[200:203], v15, s[36:39], s58 offen offset:0 sc1
  buffer_load_dwordx4 v[204:207], v15, s[36:39], s58 offen offset:2048 sc1
  buffer_load_dwordx4 v[208:211], v15, s[36:39], s58 offen offset:1024 sc1
  s_add_u32 s58, s83, 86016
  buffer_load_dwordx4 v[212:215], v15, s[36:39], s58 offen offset:0 sc1
  buffer_load_dwordx4 v[216:219], v15, s[36:39], s58 offen offset:2048 sc1
  buffer_load_dwordx4 v[220:223], v15, s[36:39], s58 offen offset:1024 sc1
  s_add_u32 s58, s83, 114688
  buffer_load_dwordx4 v[224:227], v15, s[36:39], s58 offen offset:0 sc1
  buffer_load_dwordx4 v[228:231], v15, s[36:39], s58 offen offset:2048 sc1
  buffer_load_dwordx4 v[232:235], v15, s[36:39], s58 offen offset:1024 sc1
  s_add_u32 s58, s83, 143360
  buffer_load_dwordx4 v[236:239], v15, s[36:39], s58 offen offset:0 sc1
  buffer_load_dwordx4 v[240:243], v15, s[36:39], s58 offen offset:2048 sc1
  buffer_load_dwordx4 v[244:247], v15, s[36:39], s58 offen offset:1024 sc1
  s_add_u32 s58, s83, 172032
  buffer_load_dwordx4 v[16:19], v15, s[36:39], s58 offen offset:0 sc1
  buffer_load_dwordx4 v[20:23], v15, s[36:39], s58 offen offset:2048 sc1
  buffer_load_dwordx4 v[24:27], v15, s[36:39], s58 offen offset:1024 sc1
  s_add_u32 s58, s83, 200704
  buffer_load_dwordx4 v[28:31], v15, s[36:39], s58 offen offset:0 sc1
  buffer_load_dwordx4 v[32:35], v15, s[36:39], s58 offen offset:2048 sc1
  buffer_load_dwordx4 v[36:39], v15, s[36:39], s58 offen offset:1024 sc1
  s_waitcnt lgkmcnt(0)
  s_barrier
  ds_read_b128 v[128:131], v5 offset:0
  ds_read_b128 v[132:135], v5 offset:64
  ds_read_b128 v[136:139], v5 offset:128
  s_add_u32 s58, s83, 229376
  buffer_load_dwordx4 v[40:43], v15, s[36:39], s58 offen offset:0 sc1
  buffer_load_dwordx4 v[44:47], v15, s[36:39], s58 offen offset:2048 sc1
  buffer_load_dwordx4 v[48:51], v15, s[36:39], s58 offen offset:1024 sc1
  s_add_u32 s58, s83, 258048
  buffer_load_dwordx4 v[52:55], v15, s[36:39], s58 offen offset:0 sc1
  buffer_load_dwordx4 v[56:59], v15, s[36:39], s58 offen offset:2048 sc1
  buffer_load_dwordx4 v[60:63], v15, s[36:39], s58 offen offset:1024 sc1
  s_add_u32 s58, s83, 286720
  buffer_load_dwordx4 v[64:67], v15, s[36:39], s58 offen offset:0 sc1
  buffer_load_dwordx4 v[68:71], v15, s[36:39], s58 offen offset:2048 sc1
  buffer_load_dwordx4 v[72:75], v15, s[36:39], s58 offen offset:1024 sc1
  s_add_u32 s58, s83, 315392
  buffer_load_dwordx4 v[76:79], v15, s[36:39], s58 offen offset:0 sc1
  buffer_load_dwordx4 v[80:83], v15, s[36:39], s58 offen offset:2048 sc1
  buffer_load_dwordx4 v[84:87], v15, s[36:39], s58 offen offset:1024 sc1
  s_add_u32 s58, s83, 344064
  buffer_load_dwordx4 v[88:91], v15, s[36:39], s58 offen offset:0 sc1
  buffer_load_dwordx4 v[92:95], v15, s[36:39], s58 offen offset:2048 sc1
  buffer_load_dwordx4 v[96:99], v15, s[36:39], s58 offen offset:1024 sc1
  s_add_u32 s58, s83, 372736
  buffer_load_dwordx4 v[100:103], v15, s[36:39], s58 offen offset:0 sc1
  buffer_load_dwordx4 v[104:107], v15, s[36:39], s58 offen offset:2048 sc1
  buffer_load_dwordx4 v[108:111], v15, s[36:39], s58 offen offset:1024 sc1
  ds_read_b128 v[140:143], v5 offset:192
  s_waitcnt lgkmcnt(3) vmcnt(39)
  v_mfma_f32_16x16x32_bf16 v[112:115], v[176:179], v[128:131], v[112:115]
  v_mfma_f32_16x16x32_bf16 v[116:119], v[180:183], v[128:131], v[116:119]
  v_mfma_f32_16x16x32_bf16 v[120:123], v[184:187], v[128:131], v[120:123]
  ds_read_b128 v[128:131], v5 offset:256
  s_waitcnt lgkmcnt(3) vmcnt(36)
  v_mfma_f32_16x16x32_bf16 v[112:115], v[188:191], v[132:135], v[112:115]
  v_mfma_f32_16x16x32_bf16 v[116:119], v[192:195], v[132:135], v[116:119]
  v_mfma_f32_16x16x32_bf16 v[120:123], v[196:199], v[132:135], v[120:123]
  ds_read_b128 v[132:135], v5 offset:320
  s_waitcnt lgkmcnt(3) vmcnt(33)
  v_mfma_f32_16x16x32_bf16 v[112:115], v[200:203], v[136:139], v[112:115]
  v_mfma_f32_16x16x32_bf16 v[116:119], v[204:207], v[136:139], v[116:119]
  v_mfma_f32_16x16x32_bf16 v[120:123], v[208:211], v[136:139], v[120:123]
  ds_read_b128 v[136:139], v5 offset:384
  s_waitcnt lgkmcnt(3) vmcnt(30)
  v_mfma_f32_16x16x32_bf16 v[112:115], v[212:215], v[140:143], v[112:115]
  v_mfma_f32_16x16x32_bf16 v[116:119], v[216:219], v[140:143], v[116:119]
  v_mfma_f32_16x16x32_bf16 v[120:123], v[220:223], v[140:143], v[120:123]
  ds_read_b128 v[140:143], v5 offset:448
  s_waitcnt lgkmcnt(3) vmcnt(27)
  v_mfma_f32_16x16x32_bf16 v[112:115], v[224:227], v[128:131], v[112:115]
  v_mfma_f32_16x16x32_bf16 v[116:119], v[228:231], v[128:131], v[116:119]
  v_mfma_f32_16x16x32_bf16 v[120:123], v[232:235], v[128:131], v[120:123]
  ds_read_b128 v[128:131], v5 offset:512
  s_waitcnt lgkmcnt(3) vmcnt(24)
  v_mfma_f32_16x16x32_bf16 v[112:115], v[236:239], v[132:135], v[112:115]
  v_mfma_f32_16x16x32_bf16 v[116:119], v[240:243], v[132:135], v[116:119]
  v_mfma_f32_16x16x32_bf16 v[120:123], v[244:247], v[132:135], v[120:123]
  ds_read_b128 v[132:135], v5 offset:576
  s_waitcnt lgkmcnt(3) vmcnt(21)
  v_mfma_f32_16x16x32_bf16 v[112:115], v[16:19], v[136:139], v[112:115]
  v_mfma_f32_16x16x32_bf16 v[116:119], v[20:23], v[136:139], v[116:119]
  v_mfma_f32_16x16x32_bf16 v[120:123], v[24:27], v[136:139], v[120:123]
  ds_read_b128 v[136:139], v5 offset:640
  s_waitcnt lgkmcnt(3) vmcnt(18)
  v_mfma_f32_16x16x32_bf16 v[112:115], v[28:31], v[140:143], v[112:115]
  v_mfma_f32_16x16x32_bf16 v[116:119], v[32:35], v[140:143], v[116:119]
  v_mfma_f32_16x16x32_bf16 v[120:123], v[36:39], v[140:143], v[120:123]
  ds_read_b128 v[140:143], v5 offset:704
  s_waitcnt lgkmcnt(3) vmcnt(15)
  v_mfma_f32_16x16x32_bf16 v[112:115], v[40:43], v[128:131], v[112:115]
  v_mfma_f32_16x16x32_bf16 v[116:119], v[44:47], v[128:131], v[116:119]
  v_mfma_f32_16x16x32_bf16 v[120:123], v[48:51], v[128:131], v[120:123]
  ds_read_b128 v[128:131], v5 offset:768
  s_waitcnt lgkmcnt(3) vmcnt(12)
  v_mfma_f32_16x16x32_bf16 v[112:115], v[52:55], v[132:135], v[112:115]
  v_mfma_f32_16x16x32_bf16 v[116:119], v[56:59], v[132:135], v[116:119]
  v_mfma_f32_16x16x32_bf16 v[120:123], v[60:63], v[132:135], v[120:123]
  ds_read_b128 v[132:135], v5 offset:832
  s_waitcnt lgkmcnt(3) vmcnt(9)
  v_mfma_f32_16x16x32_bf16 v[112:115], v[64:67], v[136:139], v[112:115]
  v_mfma_f32_16x16x32_bf16 v[116:119], v[68:71], v[136:139], v[116:119]
  v_mfma_f32_16x16x32_bf16 v[120:123], v[72:75], v[136:139], v[120:123]
  s_waitcnt lgkmcnt(2) vmcnt(6)
  v_mfma_f32_16x16x32_bf16 v[112:115], v[76:79], v[140:143], v[112:115]
  v_mfma_f32_16x16x32_bf16 v[116:119], v[80:83], v[140:143], v[116:119]
  v_mfma_f32_16x16x32_bf16 v[120:123], v[84:87], v[140:143], v[120:123]
  s_waitcnt lgkmcnt(1) vmcnt(3)
  v_mfma_f32_16x16x32_bf16 v[112:115], v[88:91], v[128:131], v[112:115]
  v_mfma_f32_16x16x32_bf16 v[116:119], v[92:95], v[128:131], v[116:119]
  v_mfma_f32_16x16x32_bf16 v[120:123], v[96:99], v[128:131], v[120:123]
  s_waitcnt lgkmcnt(0) vmcnt(0)
  v_mfma_f32_16x16x32_bf16 v[112:115], v[100:103], v[132:135], v[112:115]
  v_mfma_f32_16x16x32_bf16 v[116:119], v[104:107], v[132:135], v[116:119]
  v_mfma_f32_16x16x32_bf16 v[120:123], v[108:111], v[132:135], v[120:123]
  s_nop 5
  v_pk_mul_f32 v[146:147], v[112:113], v[112:113]
  v_pk_mul_f32 v[148:149], v[112:113], v[160:161]
  v_pk_add_f32 v[144:145], v[112:113], v[114:115]
  v_pk_fma_f32 v[146:147], v[114:115], v[114:115], v[146:147]
  v_pk_fma_f32 v[148:149], v[114:115], v[162:163], v[148:149]
  v_pk_add_f32 v[144:145], v[144:145], v[116:117]
  v_pk_fma_f32 v[146:147], v[116:117], v[116:117], v[146:147]
  v_pk_fma_f32 v[148:149], v[116:117], v[164:165], v[148:149]
  v_pk_add_f32 v[144:145], v[144:145], v[118:119]
  v_pk_fma_f32 v[146:147], v[118:119], v[118:119], v[146:147]
  v_pk_fma_f32 v[148:149], v[118:119], v[166:167], v[148:149]
  v_pk_add_f32 v[144:145], v[144:145], v[120:121]
  v_pk_fma_f32 v[146:147], v[120:121], v[120:121], v[146:147]
  v_pk_fma_f32 v[148:149], v[120:121], v[168:169], v[148:149]
  v_pk_add_f32 v[144:145], v[144:145], v[122:123]
  v_pk_fma_f32 v[146:147], v[122:123], v[122:123], v[146:147]
  v_pk_fma_f32 v[148:149], v[122:123], v[170:171], v[148:149]
  v_add_f32 v144, v144, v145
  v_add_f32 v146, v146, v147
  v_add_f32 v148, v148, v149
L_p3_j:
  s_nop 0
  v_permlane32_swap_b32 v144, v146
  v_permlane32_swap_b32 v148, v13
  v_add_f32 v144, v144, v146
  v_add_f32 v148, v148, v13
  s_nop 1
  v_permlane16_swap_b32 v144, v148
  v_add_f32 v144, v144, v148
  ds_write_b32 v2, v144
  v_and_b32 v7, 15, v1
  v_mul_u32_u24 v8, 912, v7
  v_add_u32 v8, v8, v14
  s_waitcnt lgkmcnt(0)
  s_barrier
  ds_read_b128 v[144:147], v3
  ds_read_b128 v[148:151], v3 offset:16
  v_add_u32 v8, 86016, v8
  v_add_u32 v10, s63, v8
  s_lshl_b32 s58, s2, 4
  s_sub_u32 s58, 2047, s58
  v_sub_u32 v12, s58, v7
  v_lshlrev_b32 v12, 1, v12
  v_mov_b32 v157, s48
  v_mov_b32 v159, s48
  s_lshl_b32 s58, s2, 7
  s_add_u32 s58, s58, 86016
  s_waitcnt lgkmcnt(0)
  v_pk_add_f32 v[144:145], v[144:145], v[146:147]
  v_pk_add_f32 v[148:149], v[148:149], v[150:151]
  v_pk_add_f32 v[144:145], v[144:145], v[148:149]
  v_add_f32 v144, v144, v145
  v_mov_b32 v145, v144
  s_nop 1
  v_permlane32_swap_b32 v145, v144
  v_mov_b32 v146, v145
  v_mov_b32 v147, v144
  s_nop 0
  v_permlane16_swap_b32 v145, v146
  v_permlane16_swap_b32 v144, v147
  v_mul_f32 v148, 0x3b124925, v145
  v_mul_f32 v150, 0x3b124925, v144
  v_fma_f32 v150, -v148, v148, v150
  v_max_f32 v150, 0, v150
  v_cvt_pk_bf16_f32 v150, v150, v150
  v_lshlrev_b32 v150, 16, v150
  v_add_f32 v150, 0x3727c5ac, v150
  v_cvt_pk_bf16_f32 v150, v150, v150
  v_lshlrev_b32 v150, 16, v150
  v_sqrt_f32 v150, v150
  v_cvt_pk_bf16_f32 v148, v148, v148
  v_lshlrev_b32 v148, 16, v148
  v_fma_f32 v146, -v148, v147, v146
  v_cvt_pk_bf16_f32 v150, v150, v150
  v_lshlrev_b32 v150, 16, v150
  v_rcp_f32 v149, v150
  s_nop 0
  v_mul_f32 v148, v148, v149
  s_cmp_lg_u32 s49, 0
  s_cbranch_scc1 L_p3_nokey
  v_mul_f32 v146, v149, v146
  v_cvt_pk_bf16_f32 v146, v146, v146
  v_ashrrev_i32 v147, 31, v146
  v_or_b32 v147, 0x80000000, v147
  v_xor_b32 v146, v146, v147
  v_and_b32 v146, 0xffff0000, v146
  v_or_b32 v156, v146, v12
  v_mov_b32 v2, 0
  v_mov_b32 v3, 82944
  v_min_u32_dpp v158, v156, v156 row_ror:8 row_mask:0xf bank_mask:0xf
  v_max_u32_dpp v156, v156, v156 row_ror:8 row_mask:0xf bank_mask:0xf
  s_nop 1
  v_min_u32_dpp v154, v156, v156 row_ror:4 row_mask:0xf bank_mask:0xf
  v_max_u32_dpp v156, v156, v156 row_ror:4 row_mask:0xf bank_mask:0xf
  v_max_u32_dpp v158, v158, v158 row_ror:4 row_mask:0xf bank_mask:0xf
  v_max_u32 v158, v158, v154
  s_nop 0
  v_min_u32_dpp v154, v156, v156 row_ror:2 row_mask:0xf bank_mask:0xf
  v_max_u32_dpp v156, v156, v156 row_ror:2 row_mask:0xf bank_mask:0xf
  v_max_u32_dpp v158, v158, v158 row_ror:2 row_mask:0xf bank_mask:0xf
  v_max_u32 v158, v158, v154
  s_nop 0
  v_min_u32_dpp v154, v156, v156 row_ror:1 row_mask:0xf bank_mask:0xf
  v_max_u32_dpp v156, v156, v156 row_ror:1 row_mask:0xf bank_mask:0xf
  v_max_u32_dpp v158, v158, v158 row_ror:1 row_mask:0xf bank_mask:0xf
  v_max_u32 v158, v158, v154
  v_or_b32 v158, 1, v158
  s_mov_b64 exec, 1
  buffer_store_dwordx4 v[156:159], v2, s[36:39], s58 offen sc1
  ds_write_b128 v3, v[156:159]
  s_mov_b64 exec, -1
L_p3_nokey:
  s_cmp_eq_u32 s55, 1
  s_cbranch_scc1 L_p3_rb
  v_fma_f32 v16, v112, v149, -v148
  v_fma_f32 v17, v113, v149, -v148
  v_fma_f32 v18, v114, v149, -v148
  v_fma_f32 v19, v115, v149, -v148
  v_cvt_pk_bf16_f32 v32, v16, v17
  v_cvt_pk_bf16_f32 v33, v18, v19
  ds_write_b64 v8, v[32:33] offset:0
  v_fma_f32 v20, v116, v149, -v148
  v_fma_f32 v21, v117, v149, -v148
  v_fma_f32 v22, v118, v149, -v148
  v_fma_f32 v23, v119, v149, -v148
  v_cvt_pk_bf16_f32 v34, v20, v21
  v_cvt_pk_bf16_f32 v35, v22, v23
  ds_write_b64 v8, v[34:35] offset:8
  v_fma_f32 v24, v120, v149, -v148
  v_fma_f32 v25, v121, v149, -v148
  v_fma_f32 v26, v122, v149, -v148
  v_fma_f32 v27, v123, v149, -v148
  v_cvt_pk_bf16_f32 v36, v24, v25
  v_cvt_pk_bf16_f32 v37, v26, v27
  ds_write_b64 v8, v[36:37] offset:64
  v_fma_f32 v28, v124, v149, -v148
  v_fma_f32 v29, v125, v149, -v148
  v_fma_f32 v30, v126, v149, -v148
  v_fma_f32 v31, v127, v149, -v148
  v_cvt_pk_bf16_f32 v38, v28, v29
  v_cvt_pk_bf16_f32 v39, v30, v31
  ds_write_b64 v8, v[38:39] offset:72
  v_pk_add_f32 v[16:17], v[16:17], v[112:113]
  v_pk_add_f32 v[18:19], v[18:19], v[114:115]
  v_cvt_pk_bf16_f32 v40, v16, v17
  v_cvt_pk_bf16_f32 v41, v18, v19
  ds_write_b64 v8, v[40:41] offset:16384
  v_pk_add_f32 v[20:21], v[20:21], v[116:117]
  v_pk_add_f32 v[22:23], v[22:23], v[118:119]
  v_cvt_pk_bf16_f32 v42, v20, v21
  v_cvt_pk_bf16_f32 v43, v22, v23
  ds_write_b64 v8, v[42:43] offset:16392
  v_pk_add_f32 v[24:25], v[24:25], v[120:121]
  v_pk_add_f32 v[26:27], v[26:27], v[122:123]
  v_cvt_pk_bf16_f32 v44, v24, v25
  v_cvt_pk_bf16_f32 v45, v26, v27
  ds_write_b64 v8, v[44:45] offset:16448
  v_pk_add_f32 v[28:29], v[28:29], v[124:125]
  v_pk_add_f32 v[30:31], v[30:31], v[126:127]
  v_cvt_pk_bf16_f32 v46, v28, v29
  v_cvt_pk_bf16_f32 v47, v30, v31
  ds_write_b64 v8, v[46:47] offset:16456
  s_branch L_p3_rj
L_p3_rb:
  v_fma_f32 v16, v112, v149, -v148
  v_fma_f32 v17, v113, v149, -v148
  v_fma_f32 v18, v114, v149, -v148
  v_fma_f32 v19, v115, v149, -v148
  v_cvt_pk_bf16_f32 v32, v16, v17
  v_cvt_pk_bf16_f32 v33, v18, v19
  ds_write_b64 v8, v[32:33] offset:0
  v_fma_f32 v20, v116, v149, -v148
  v_fma_f32 v21, v117, v149, -v148
  v_fma_f32 v22, v118, v149, -v148
  v_fma_f32 v23, v119, v149, -v148
  v_cvt_pk_bf16_f32 v34, v20, v21
  v_cvt_pk_bf16_f32 v35, v22, v23
  ds_write_b64 v8, v[34:35] offset:64
  v_fma_f32 v24, v120, v149, -v148
  v_fma_f32 v25, v121, v149, -v148
  v_fma_f32 v26, v122, v149, -v148
  v_fma_f32 v27, v123, v149, -v148
  v_cvt_pk_bf16_f32 v36, v24, v25
  v_cvt_pk_bf16_f32 v37, v26, v27
  ds_write_b64 v10, v[36:37] offset:0
  v_pk_add_f32 v[16:17], v[16:17], v[112:113]
  v_pk_add_f32 v[18:19], v[18:19], v[114:115]
  v_cvt_pk_bf16_f32 v40, v16, v17
  v_cvt_pk_bf16_f32 v41, v18, v19
  ds_write_b64 v8, v[40:41] offset:16384
  v_pk_add_f32 v[20:21], v[20:21], v[116:117]
  v_pk_add_f32 v[22:23], v[22:23], v[118:119]
  v_cvt_pk_bf16_f32 v42, v20, v21
  v_cvt_pk_bf16_f32 v43, v22, v23
  ds_write_b64 v8, v[42:43] offset:16448
  v_pk_add_f32 v[24:25], v[24:25], v[120:121]
  v_pk_add_f32 v[26:27], v[26:27], v[122:123]
  v_cvt_pk_bf16_f32 v44, v24, v25
  v_cvt_pk_bf16_f32 v45, v26, v27
  ds_write_b64 v10, v[44:45] offset:16384
L_p3_rj:
  v_mov_b32 v3, 82944
  s_mul_i32 s58, s49, 1824
  s_add_u32 s58, s58, 86016
  v_add_u32 v6, s58, v15
  v_lshl_add_u32 v7, v1, 3, s58
  s_lshl_b32 s62, s2, 3
  s_add_u32 s62, s62, s49
  s_mul_i32 s62, s62, 1792
  s_lshl_b32 s60, s2, 12
  v_mov_b32 v65, s48
  v_mov_b32 v67, s48
  v_mov_b32 v69, s48
  v_mov_b32 v71, s48
  s_waitcnt lgkmcnt(0)
  s_barrier
  ds_read_b128 v[48:51], v3
  ds_read_b128 v[52:55], v6 offset:16384
  ds_read_b128 v[56:59], v6 offset:17296
  s_waitcnt lgkmcnt(2)
  v_readfirstlane_b32 s81, v48
  v_readfirstlane_b32 s82, v50
  s_not_b32 s81, s81
  s_not_b32 s82, s82
  s_bfe_u32 s81, s81, 0x40001
  s_bfe_u32 s82, s82, 0x40001
  s_lshr_b32 s58, s81, 1
  s_cmp_lg_u32 s58, s49
  s_cbranch_scc1 L_p3_hn0
  s_and_b32 s58, s81, 1
  s_mul_i32 s58, s58, 912
  v_add_u32 v2, s58, v7
  ds_read_b64 v[60:61], v2
  ds_read_b64 v[62:63], v2 offset:512
  ds_read_b64 v[44:45], v2 offset:16384
  ds_read_b64 v[46:47], v2 offset:16896
  s_waitcnt lgkmcnt(2)
  v_mov_b32 v64, v60
  v_mov_b32 v66, v61
  v_mov_b32 v68, v62
  v_mov_b32 v70, v63
  s_add_u32 s58, s60, 131072
  buffer_store_dwordx4 v[64:67], v15, s[36:39], s58 offen sc1
  s_mov_b32 exec_hi, 0xffff
  buffer_store_dwordx4 v[68:71], v15, s[36:39], s58 offen offset:1024 sc1
  s_mov_b32 exec_hi, -1
  s_waitcnt lgkmcnt(0)
  v_mov_b32 v72, v44
  v_mov_b32 v73, s48
  v_mov_b32 v74, v45
  v_mov_b32 v75, s48
  v_mov_b32 v76, v46
  v_mov_b32 v77, s48
  v_mov_b32 v78, v47
  v_mov_b32 v79, s48
L_p3_hn0:
  s_lshr_b32 s58, s82, 1
  s_cmp_lg_u32 s58, s49
  s_cbranch_scc1 L_p3_hn1
  s_and_b32 s58, s82, 1
  s_mul_i32 s58, s58, 912
  v_add_u32 v2, s58, v7
  ds_read_b64 v[60:61], v2
  ds_read_b64 v[62:63], v2 offset:512
  ds_read_b64 v[44:45], v2 offset:16384
  ds_read_b64 v[46:47], v2 offset:16896
  s_waitcnt lgkmcnt(2)
  v_mov_b32 v64, v60
  v_mov_b32 v66, v61
  v_mov_b32 v68, v62
  v_mov_b32 v70, v63
  s_add_u32 s58, s60, 133120
  buffer_store_dwordx4 v[64:67], v15, s[36:39], s58 offen sc1
  s_mov_b32 exec_hi, 0xffff
  buffer_store_dwordx4 v[68:71], v15, s[36:39], s58 offen offset:1024 sc1
  s_mov_b32 exec_hi, -1
  s_waitcnt lgkmcnt(0)
  v_mov_b32 v80, v44
  v_mov_b32 v81, s48
  v_mov_b32 v82, v45
  v_mov_b32 v83, s48
  v_mov_b32 v84, v46
  v_mov_b32 v85, s48
  v_mov_b32 v86, v47
  v_mov_b32 v87, s48
L_p3_hn1:
  s_waitcnt lgkmcnt(0)
  s_mov_b32 exec_hi, 0x00ffffff
  s_lshr_b32 s58, s81, 1
  s_cmp_eq_u32 s58, s49
  s_cbranch_scc1 L_p3_ocand
  s_lshr_b32 s58, s82, 1
  s_cmp_eq_u32 s58, s49
  s_cbranch_scc1 L_p3_ocand
  buffer_store_dwordx4 v[52:55], v15, s[44:47], s62 offen
  buffer_store_dwordx4 v[56:59], v15, s[44:47], s62 offen offset:896
  s_mov_b32 exec_hi, -1
  s_branch L_fin
L_p3_ocand:
  buffer_store_dwordx4 v[52:55], v15, s[44:47], s62 offen sc1
  buffer_store_dwordx4 v[56:59], v15, s[44:47], s62 offen offset:896 sc1
  s_mov_b32 exec_hi, -1
  s_waitcnt vmcnt(0)
  s_lshr_b32 s58, s81, 1
  s_cmp_lg_u32 s58, s49
  s_cbranch_scc1 L_p3_ob0
  s_add_u32 s58, s60, 655360
  buffer_store_dwordx4 v[72:75], v15, s[36:39], s58 offen sc1
  s_mov_b32 exec_hi, 0xffff
  buffer_store_dwordx4 v[76:79], v15, s[36:39], s58 offen offset:1024 sc1
  s_mov_b32 exec_hi, -1
L_p3_ob0:
  s_lshr_b32 s58, s82, 1
  s_cmp_lg_u32 s58, s49
  s_cbranch_scc1 L_p3_ob1
  s_add_u32 s58, s60, 657408
  buffer_store_dwordx4 v[80:83], v15, s[36:39], s58 offen sc1
  s_mov_b32 exec_hi, 0xffff
  buffer_store_dwordx4 v[84:87], v15, s[36:39], s58 offen offset:1024 sc1
  s_mov_b32 exec_hi, -1
L_p3_ob1:
  s_branch L_fin
L_other:
  s_cmp_lg_u32 s9, 1
  s_cbranch_scc1 L_scout
  v_lshrrev_b32 v4, 4, v1
  v_and_b32 v5, 15, v1
  v_lshlrev_b32 v5, 4, v5
  v_bfe_u32 v6, v1, 2, 2
  v_lshl_add_u32 v11, v4, 3, v6
  v_and_b32 v2, 15, v11
  v_mul_u32_u24 v2, 912, v2
  v_lshrrev_b32 v3, 5, v1
  v_lshl_add_u32 v2, v3, 14, v2
  v_and_b32 v3, 3, v1
  v_lshl_add_u32 v2, v3, 3, v2
  s_min_u32 s58, s49, 6
  s_lshl_b32 s58, s58, 7
  v_add_u32 v2, s58, v2
  ds_read_b64_tr_b16 v[176:177], v2 offset:0
  ds_read_b64_tr_b16 v[178:179], v2 offset:3648
  ds_read_b64_tr_b16 v[184:185], v2 offset:32
  ds_read_b64_tr_b16 v[186:187], v2 offset:3680
  ds_read_b64_tr_b16 v[192:193], v2 offset:64
  ds_read_b64_tr_b16 v[194:195], v2 offset:3712
  ds_read_b64_tr_b16 v[200:201], v2 offset:96
  ds_read_b64_tr_b16 v[202:203], v2 offset:3744
  ds_read_b64_tr_b16 v[180:181], v2 offset:32768
  ds_read_b64_tr_b16 v[182:183], v2 offset:36416
  ds_read_b64_tr_b16 v[188:189], v2 offset:32800
  ds_read_b64_tr_b16 v[190:191], v2 offset:36448
  ds_read_b64_tr_b16 v[196:197], v2 offset:32832
  ds_read_b64_tr_b16 v[198:199], v2 offset:36480
  ds_read_b64_tr_b16 v[204:205], v2 offset:32864
  ds_read_b64_tr_b16 v[206:207], v2 offset:36512
  s_mov_b32 s40, s14
  s_mov_b32 s41, s15
  s_mov_b32 s42, 0x188000
  s_mov_b32 s43, 0x20000
  s_mov_b32 s44, s16
  s_mov_b32 s45, s17
  s_mov_b32 s46, 0x188000
  s_mov_b32 s47, 0x20000
  s_lshl_b32 s58, s91, 7
  s_mul_i32 s59, s49, 28672
  s_add_u32 s58, s58, s59
  s_and_b32 s59, s49, 1
  s_lshl_b32 s59, s59, 2
  v_lshrrev_b32 v2, 3, v1
  v_mul_u32_u24 v2, 3584, v2
  v_and_b32 v3, 7, v1
  v_xor_b32 v3, v3, v4
  v_xor_b32 v3, s59, v3
  v_lshl_add_u32 v2, v3, 4, v2
  v_add_u32 v2, s58, v2
  v_xor_b32 v3, 32, v2
  s_waitcnt lgkmcnt(0)
  s_barrier
  s_cmp_lg_u32 s49, 7
  s_cbranch_scc1 L_f_nowarm
  s_mul_i32 s61, s91, 7168
  s_add_u32 s61, s61, 5308416
  v_lshlrev_b32 v10, 7, v1
  s_mov_b32 exec_hi, 0x00ffffff
  buffer_load_dword v12, v10, s[36:39], s61 offen sc1
  s_mov_b32 exec_hi, -1
L_f_nowarm:
  s_add_u32 m0, s73, 49152
  s_mov_b32 s58, 1376256
  buffer_load_dwordx4 v2, s[40:43], s58 offen lds
  s_add_u32 m0, s73, 106496
  s_nop 0
  buffer_load_dwordx4 v3, s[44:47], s58 offen lds
  s_add_u32 m0, s73, 40960
  s_mov_b32 s58, 1146880
  buffer_load_dwordx4 v2, s[40:43], s58 offen lds
  s_add_u32 m0, s73, 98304
  s_nop 0
  buffer_load_dwordx4 v3, s[44:47], s58 offen lds
  s_add_u32 m0, s73, 32768
  s_mov_b32 s58, 917504
  buffer_load_dwordx4 v2, s[40:43], s58 offen lds
  s_add_u32 m0, s73, 90112
  s_nop 0
  buffer_load_dwordx4 v3, s[44:47], s58 offen lds
  s_add_u32 m0, s73, 24576
  s_mov_b32 s58, 688128
  buffer_load_dwordx4 v2, s[40:43], s58 offen lds
  s_add_u32 m0, s73, 81920
  s_nop 0
  buffer_load_dwordx4 v3, s[44:47], s58 offen lds
  s_add_u32 m0, s73, 16384
  s_mov_b32 s58, 458752
  buffer_load_dwordx4 v2, s[40:43], s58 offen lds
  s_add_u32 m0, s73, 73728
  s_nop 0
  buffer_load_dwordx4 v3, s[44:47], s58 offen lds
  s_add_u32 m0, s73, 8192
  s_mov_b32 s58, 229376
  buffer_load_dwordx4 v2, s[40:43], s58 offen lds
  s_add_u32 m0, s73, 65536
  s_nop 0
  buffer_load_dwordx4 v3, s[44:47], s58 offen lds
  s_add_u32 m0, s73, 0
  s_mov_b32 s58, 0
  buffer_load_dwordx4 v2, s[40:43], s58 offen lds
  s_add_u32 m0, s73, 57344
  s_nop 0
  buffer_load_dwordx4 v3, s[44:47], s58 offen lds
  s_mov_b32 s44, s20
  s_mov_b32 s45, s21
  s_mov_b32 s46, 0x1c0000
  s_mov_b32 s47, 0x20000
  v_lshlrev_b32 v7, 7, v11
  v_and_b32 v8, 1, v4
  v_lshlrev_b32 v8, 2, v8
  v_lshrrev_b32 v6, 1, v6
  v_or_b32 v8, v8, v6
  v_and_b32 v9, 2, v1
  v_xor_b32 v8, v8, v9
  v_xor_b32 v8, s49, v8
  v_lshl_add_u32 v7, v8, 4, v7
  v_and_b32 v8, 1, v1
  v_lshl_add_u32 v7, v8, 3, v7
  v_mul_u32_u24 v9, 28672, v9
  v_add_u32 v6, v7, v9
  v_xor_b32 v7, 32, v6
  v_and_b32 v9, 3, v1
  v_mul_u32_u24 v13, 576, v9
  v_lshl_add_u32 v13, v4, 4, v13
  v_add_u32 v13, 114688, v13
  v_mul_u32_u24 v134, 0xaaaa, v8
  v_add_u32 v134, 0x4444, v134
  v_lshlrev_b32 v137, 6, v9
  v_lshl_add_u32 v137, v4, 4, v137
  v_add_u32 v137, 117248, v137
  v_bfe_u32 v2, v1, 3, 1
  v_bfe_u32 v3, v1, 1, 1
  v_lshl_add_u32 v2, v2, 1, v3
  v_bfe_u32 v3, v1, 2, 1
  v_lshl_add_u32 v2, v2, 4, v3
  v_lshl_add_u32 v2, v2, 1, v8
  s_lshl_b32 s58, s49, 3
  s_add_u32 s58, s58, 117248
  v_lshl_add_u32 v136, v2, 1, s58
  v_mul_u32_u24 v14, 7168, v4
  v_add_u32 v14, v14, v5
  v_and_b32 v2, 1, v4
  v_lshlrev_b32 v135, 2, v2
  v_add_u32 v135, 116992, v135
  s_mul_i32 s63, s49, 28672
  s_lshl_b32 s58, s91, 8
  s_add_u32 s63, s63, s58
  s_add_u32 s63, s63, 5308416
  s_mul_i32 s61, s91, 7168
  s_add_u32 s61, s61, 5308416
  s_add_u32 s60, s61, 4096
  v_mov_b32 v225, s48
  v_mov_b32 v227, s48
  v_mov_b32 v128, 0
  v_mov_b32 v129, 0
  v_mov_b32 v130, 0
  v_mov_b32 v131, 0
  v_mov_b32 v208, 0
  v_mov_b32 v209, 0
  v_mov_b32 v210, 0
  v_mov_b32 v211, 0
  v_mov_b32 v212, 0
  v_mov_b32 v213, 0
  v_mov_b32 v214, 0
  v_mov_b32 v215, 0
  v_mov_b32 v216, 0
  v_mov_b32 v217, 0
  v_mov_b32 v218, 0
  v_mov_b32 v219, 0
  v_mov_b32 v220, 0
  v_mov_b32 v221, 0
  v_mov_b32 v222, 0
  v_mov_b32 v223, 0
  s_waitcnt vmcnt(0)
  s_barrier
  ds_read_b64_tr_b16 v[16:17], v6 offset:0
  ds_read_b64_tr_b16 v[18:19], v7 offset:512
  ds_read_b64_tr_b16 v[20:21], v6 offset:4096
  ds_read_b64_tr_b16 v[22:23], v7 offset:4608
  ds_read_b64_tr_b16 v[24:25], v6 offset:8192
  ds_read_b64_tr_b16 v[26:27], v7 offset:8704
  ds_read_b64_tr_b16 v[28:29], v6 offset:12288
  ds_read_b64_tr_b16 v[30:31], v7 offset:12800
  ds_read_b64_tr_b16 v[32:33], v6 offset:16384
  ds_read_b64_tr_b16 v[34:35], v7 offset:16896
  ds_read_b64_tr_b16 v[36:37], v6 offset:20480
  ds_read_b64_tr_b16 v[38:39], v7 offset:20992
  ds_read_b64_tr_b16 v[40:41], v6 offset:24576
  ds_read_b64_tr_b16 v[42:43], v7 offset:25088
  ds_read_b64_tr_b16 v[44:45], v6 offset:28672
  ds_read_b64_tr_b16 v[46:47], v7 offset:29184
  ds_read_b64_tr_b16 v[48:49], v6 offset:32768
  ds_read_b64_tr_b16 v[50:51], v7 offset:33280
  ds_read_b64_tr_b16 v[52:53], v6 offset:36864
  ds_read_b64_tr_b16 v[54:55], v7 offset:37376
  ds_read_b64_tr_b16 v[56:57], v6 offset:40960
  ds_read_b64_tr_b16 v[58:59], v7 offset:41472
  ds_read_b64_tr_b16 v[60:61], v6 offset:45056
  ds_read_b64_tr_b16 v[62:63], v7 offset:45568
  ds_read_b64_tr_b16 v[64:65], v6 offset:49152
  ds_read_b64_tr_b16 v[66:67], v7 offset:49664
  ds_read_b64_tr_b16 v[68:69], v6 offset:53248
  ds_read_b64_tr_b16 v[70:71], v7 offset:53760
  s_cmp_lg_u32 s49, 0
  s_cbranch_scc1 L_f1_wait
  v_lshlrev_b32 v2, 2, v1
  v_add_u32 v142, 114688, v2
  v_add_u32 v139, 115840, v2
  v_mov_b32 v143, 116992
  v_lshlrev_b32 v2, 7, v1
  v_add_u32 v2, 86016, v2
  s_movk_i32 s58, 0x2000
  s_mov_b32 s76, -1
  s_mov_b32 s77, -1
  s_mov_b32 s78, -1
  s_mov_b32 s79, -1
  s_mov_b32 s75, 0
L_c1_poll:
  s_mov_b64 exec, s[76:77]
  s_cbranch_execz L_c1_skip0
  buffer_load_dwordx4 v[4:7], v2, s[36:39], 0 offen offset:0 sc1
L_c1_skip0:
  s_mov_b64 exec, s[78:79]
  s_cbranch_execz L_c1_skip1
  buffer_load_dwordx4 v[8:11], v2, s[36:39], s58 offen offset:0 sc1
L_c1_skip1:
  s_add_u32 s75, s75, 1
  s_waitcnt vmcnt(0)
  s_mov_b64 exec, s[78:79]
  v_xor_b32 v12, s48, v9
  v_bitop3_b32 v12, v12, v11, s48 bitop3:0xf6
  v_cmp_ne_u32 s[78:79], 0, v12
  s_mov_b64 exec, s[76:77]
  v_xor_b32 v12, s48, v5
  v_bitop3_b32 v12, v12, v7, s48 bitop3:0xf6
  v_cmp_ne_u32 s[76:77], 0, v12
  s_mov_b64 exec, -1
  s_or_b64 vcc, s[76:77], s[78:79]
  s_cbranch_scc0 L_c1_ok
  s_cmp_lt_u32 s75, 262144
  s_cbranch_scc1 L_c1_poll
L_c1_ok:
  v_max_u32 v140, v4, v8
  v_min_u32 v12, v4, v8
  v_max3_u32 v141, v6, v10, v12
  s_nop 0
  v_min_u32_dpp v12, v140, v140 row_ror:8 row_mask:0xf bank_mask:0xf
  v_max_u32_dpp v140, v140, v140 row_ror:8 row_mask:0xf bank_mask:0xf
  v_max_u32_dpp v141, v141, v141 row_ror:8 row_mask:0xf bank_mask:0xf
  v_max_u32 v141, v141, v12
  s_nop 0
  v_min_u32_dpp v12, v140, v140 row_ror:4 row_mask:0xf bank_mask:0xf
  v_max_u32_dpp v140, v140, v140 row_ror:4 row_mask:0xf bank_mask:0xf
  v_max_u32_dpp v141, v141, v141 row_ror:4 row_mask:0xf bank_mask:0xf
  v_max_u32 v141, v141, v12
  s_nop 0
  v_min_u32_dpp v12, v140, v140 row_ror:2 row_mask:0xf bank_mask:0xf
  v_max_u32_dpp v140, v140, v140 row_ror:2 row_mask:0xf bank_mask:0xf
  v_max_u32_dpp v141, v141, v141 row_ror:2 row_mask:0xf bank_mask:0xf
  v_max_u32 v141, v141, v12
  s_nop 0
  v_min_u32_dpp v12, v140, v140 row_ror:1 row_mask:0xf bank_mask:0xf
  v_max_u32_dpp v140, v140, v140 row_ror:1 row_mask:0xf bank_mask:0xf
  v_max_u32_dpp v141, v141, v141 row_ror:1 row_mask:0xf bank_mask:0xf
  v_max_u32 v141, v141, v12
  v_mov_b32 v12, v140
  v_mov_b32 v3, v141
  s_nop 0
  v_permlane16_swap_b32 v12, v140
  v_permlane16_swap_b32 v3, v141
  v_max_u32 v141, v141, v3
  v_min_u32 v3, v12, v140
  v_max_u32 v140, v12, v140
  v_max_u32 v141, v141, v3
  v_mov_b32 v12, v140
  v_mov_b32 v3, v141
  s_nop 0
  v_permlane32_swap_b32 v12, v140
  v_permlane32_swap_b32 v3, v141
  v_max_u32 v141, v141, v3
  v_min_u32 v3, v12, v140
  v_max_u32 v140, v12, v140
  v_max_u32 v141, v141, v3
  v_not_b32 v2, v140
  v_and_b32 v12, 1, v140
  v_bfe_u32 v2, v2, 5, 7
  v_lshl_add_u32 v12, v12, 11, v15
  v_lshl_add_u32 v2, v2, 12, v12
  v_not_b32 v3, v141
  v_and_b32 v12, 1, v141
  v_bfe_u32 v3, v3, 5, 7
  v_lshl_add_u32 v12, v12, 11, v15
  v_lshl_add_u32 v3, v3, 12, v12
  s_mov_b32 s58, 131072
  s_mov_b32 s75, 0
L_hn1_poll:
  buffer_load_dwordx4 v[144:147], v2, s[36:39], s58 offen sc1
  buffer_load_dwordx4 v[152:155], v3, s[36:39], s58 offen sc1
  s_mov_b32 exec_hi, 0xffff
  buffer_load_dwordx4 v[148:151], v2, s[36:39], s58 offen offset:1024 sc1
  buffer_load_dwordx4 v[156:159], v3, s[36:39], s58 offen offset:1024 sc1
  s_mov_b32 exec_hi, -1
  ds_write_b64 v143, v[140:141]
  s_add_u32 s75, s75, 1
  s_waitcnt vmcnt(3)
  ds_write2_b32 v142, v144, v146 offset0:0 offset1:144
  v_xor_b32 v12, s48, v145
  v_bitop3_b32 v12, v12, v147, s48 bitop3:0xf6
  s_waitcnt vmcnt(2)
  ds_write2_b32 v139, v152, v154 offset0:0 offset1:144
  v_bitop3_b32 v12, v12, v153, s48 bitop3:0xf6
  v_bitop3_b32 v12, v12, v155, s48 bitop3:0xf6
  s_waitcnt vmcnt(1)
  s_mov_b32 exec_hi, 0xffff
  ds_write2_b32 v142, v148, v150 offset0:64 offset1:208
  v_bitop3_b32 v12, v12, v149, s48 bitop3:0xf6
  v_bitop3_b32 v12, v12, v151, s48 bitop3:0xf6
  s_waitcnt vmcnt(0)
  ds_write2_b32 v139, v156, v158 offset0:64 offset1:208
  v_bitop3_b32 v12, v12, v157, s48 bitop3:0xf6
  v_bitop3_b32 v12, v12, v159, s48 bitop3:0xf6
  s_mov_b32 exec_hi, -1
  v_cmp_ne_u32 s[76:77], 0, v12
  s_nop 0
  s_cmp_eq_u64 s[76:77], 0
  s_cbranch_scc1 L_hn1_ok
  s_cmp_lt_u32 s75, 262144
  s_cbranch_scc1 L_hn1_poll
L_hn1_ok:
  s_cmp_lg_u32 s91, 27
  s_cbranch_scc1 L_f1_wait
  v_mov_b32 v2, 0
  v_mov_b32 v3, s48
  s_mov_b64 exec, 1
  buffer_store_dword v3, v2, s[36:39], 0 offen sc1
  s_mov_b64 exec, -1
L_f1_wait:
  s_waitcnt lgkmcnt(0)
  s_barrier
  s_cmp_lg_u32 s49, 7
  s_cbranch_scc1 L_f_nokey
  ds_read_b32 v142, v135
L_f_nokey:
  ds_read_b128 v[72:75], v13 offset:0
  ds_read_b128 v[76:79], v13 offset:64
  ds_read_b128 v[80:83], v13 offset:128
  ds_read_b128 v[84:87], v13 offset:192
  ds_read_b128 v[88:91], v13 offset:256
  ds_read_b128 v[92:95], v13 offset:320
  ds_read_b128 v[96:99], v13 offset:384
  s_cbranch_scc1 L_f_nob
  s_lshl_b32 s62, s91, 6
  s_add_u32 s62, s62, 655360
  v_bfe_u32 v5, v1, 1, 3
  v_lshlrev_b32 v3, 3, v5
  s_waitcnt lgkmcnt(7)
  v_not_b32 v141, v142
  v_and_b32 v12, 1, v142
  v_bfe_u32 v141, v141, 5, 7
  v_lshl_add_u32 v12, v12, 11, v3
  v_lshl_add_u32 v141, v141, 12, v12
L_f_nob:
  s_waitcnt lgkmcnt(6)
  v_smfmac_f32_16x16x64_bf16 v[128:131], v[72:75], v[16:23], v134
  s_waitcnt lgkmcnt(5)
  v_smfmac_f32_16x16x64_bf16 v[128:131], v[76:79], v[24:31], v134
  s_waitcnt lgkmcnt(4)
  v_smfmac_f32_16x16x64_bf16 v[128:131], v[80:83], v[32:39], v134
  s_waitcnt lgkmcnt(3)
  v_smfmac_f32_16x16x64_bf16 v[128:131], v[84:87], v[40:47], v134
  s_waitcnt lgkmcnt(2)
  v_smfmac_f32_16x16x64_bf16 v[128:131], v[88:91], v[48:55], v134
  s_waitcnt lgkmcnt(1)
  v_smfmac_f32_16x16x64_bf16 v[128:131], v[92:95], v[56:63], v134
  s_waitcnt lgkmcnt(0)
  v_smfmac_f32_16x16x64_bf16 v[128:131], v[96:99], v[64:71], v134
  s_cmp_eq_u32 s49, 7
  s_nop 6
  v_add_f32 v128, v128, v129
  v_add_f32 v129, v130, v131
  v_add_f32 v130, v130, v131
  s_nop 1
  v_mov_b32_dpp v130, v128 row_ror:8 row_mask:0xf bank_mask:0x3
  v_mov_b32_dpp v128, v129 row_ror:8 row_mask:0xf bank_mask:0xc
  v_mul_f32 v2, 0xbfb8aa3b, v128
  v_exp_f32 v2, v2
  v_mul_f32 v128, v128, v130
  v_add_f32 v2, 1.0, v2
  v_rcp_f32 v2, v2
  s_nop 0
  v_mul_f32 v128, v128, v2
  v_cvt_pk_bf16_f32 v128, v128, v128
  ds_write_b16 v136, v128
  s_waitcnt lgkmcnt(0)
  s_barrier
  s_cbranch_scc1 L_f_last
  ds_read_b128 v[72:75], v137
  s_waitcnt lgkmcnt(0)
  v_smfmac_f32_16x16x64_bf16 v[208:211], v[72:75], v[176:183], v134
  v_smfmac_f32_16x16x64_bf16 v[212:215], v[72:75], v[184:191], v134
  v_smfmac_f32_16x16x64_bf16 v[216:219], v[72:75], v[192:199], v134
  v_smfmac_f32_16x16x64_bf16 v[220:223], v[72:75], v[200:207], v134
  s_cmp_eq_u32 s74, 0
  s_nop 3
  v_add_f32 v224, v208, v209
  v_add_f32 v226, v210, v211
  s_mov_b32 exec_lo, 0xffff0000
  v_add_f32 v224, v212, v213
  v_add_f32 v226, v214, v215
  s_mov_b32 exec_lo, 0
  v_add_f32 v224, v216, v217
  v_add_f32 v226, v218, v219
  s_mov_b32 exec_hi, 0xffff0000
  v_add_f32 v224, v220, v221
  v_add_f32 v226, v222, v223
  s_mov_b64 exec, -1
  s_cbranch_scc1 L_yp_slow
  buffer_store_dwordx4 v[224:227], v14, s[36:39], s63 offen
L_yp_done:
  s_branch L_fin
L_f_last:
  buffer_load_dwordx2 v[144:145], v141, s[36:39], s62 offen sc1
  v_not_b32 v3, v142
  v_ashrrev_i32 v6, 31, v3
  v_or_b32 v6, 0x80000000, v6
  v_xor_b32 v6, v6, v142
  v_and_b32 v6, 0xffff0000, v6
  v_mul_f32 v6, 0xbfb8aa3b, v6
  v_exp_f32 v6, v6
  v_bfe_u32 v3, v3, 1, 11
  v_add_f32 v6, 1.0, v6
  v_rcp_f32 v6, v6
  v_mul_u32_u24 v139, 896, v3
  v_lshl_add_u32 v139, v5, 2, v139
  v_cvt_pk_bf16_f32 v143, v6, v6
  v_lshlrev_b32 v143, 16, v143
  s_mov_b32 vcc_lo, 0xaaaaaaaa
  s_mov_b32 vcc_hi, 0xaaaaaaaa
  s_lshl_b32 s58, s91, 5
  s_waitcnt vmcnt(0)
  v_xor_b32 v12, s48, v145
  v_cmp_ne_u32 s[76:77], 0, v12
  s_nop 0
  s_and_b64 s[76:77], s[76:77], exec
  s_cbranch_scc1 L_hn2_spin
L_hn2_go:
  s_mov_b32 s75, 0
L_act_poll:
  buffer_load_dwordx4 v[16:19], v15, s[36:39], s61 offen offset:0 sc1
  buffer_load_dwordx4 v[20:23], v15, s[36:39], s61 offen offset:1024 sc1
  buffer_load_dwordx4 v[24:27], v15, s[36:39], s61 offen offset:2048 sc1
  buffer_load_dwordx4 v[28:31], v15, s[36:39], s61 offen offset:3072 sc1
  buffer_load_dwordx4 v[32:35], v15, s[36:39], s60 offen offset:0 sc1
  buffer_load_dwordx4 v[36:39], v15, s[36:39], s60 offen offset:1024 sc1
  buffer_load_dwordx4 v[40:43], v15, s[36:39], s60 offen offset:2048 sc1
  v_lshlrev_b32 v152, 16, v144
  v_and_b32 v153, 0xffff0000, v144
  v_cndmask_b32 v152, v152, v153, vcc
  s_add_u32 s75, s75, 1
L_act_take:
  s_waitcnt vmcnt(6)
  v_xor_b32 v12, s48, v17
  v_bitop3_b32 v12, v12, v19, s48 bitop3:0xf6
  s_waitcnt vmcnt(5)
  v_add_f32 v16, v16, v20
  v_add_f32 v18, v18, v22
  v_bitop3_b32 v12, v12, v21, s48 bitop3:0xf6
  v_bitop3_b32 v12, v12, v23, s48 bitop3:0xf6
  s_waitcnt vmcnt(4)
  v_add_f32 v16, v16, v24
  v_add_f32 v18, v18, v26
  v_bitop3_b32 v12, v12, v25, s48 bitop3:0xf6
  v_bitop3_b32 v12, v12, v27, s48 bitop3:0xf6
  s_waitcnt vmcnt(3)
  v_add_f32 v16, v16, v28
  v_add_f32 v18, v18, v30
  v_bitop3_b32 v12, v12, v29, s48 bitop3:0xf6
  v_bitop3_b32 v12, v12, v31, s48 bitop3:0xf6
  s_waitcnt vmcnt(2)
  v_add_f32 v16, v16, v32
  v_add_f32 v18, v18, v34
  v_bitop3_b32 v12, v12, v33, s48 bitop3:0xf6
  v_bitop3_b32 v12, v12, v35, s48 bitop3:0xf6
  s_waitcnt vmcnt(1)
  v_add_f32 v16, v16, v36
  v_add_f32 v18, v18, v38
  v_bitop3_b32 v12, v12, v37, s48 bitop3:0xf6
  v_bitop3_b32 v12, v12, v39, s48 bitop3:0xf6
  s_waitcnt vmcnt(0)
  v_add_f32 v16, v16, v40
  v_add_f32 v18, v18, v42
  v_bitop3_b32 v12, v12, v41, s48 bitop3:0xf6
  v_bitop3_b32 v12, v12, v43, s48 bitop3:0xf6
  v_cmp_ne_u32 s[76:77], 0, v12
  v_permlane16_swap_b32 v16, v18
  v_add_f32 v16, v16, v18
  v_mov_b32 v17, v16
  s_cmp_eq_u64 s[76:77], 0
  s_cbranch_scc1 L_act_ok
  s_cmp_lt_u32 s75, 262144
  s_cbranch_scc1 L_act_poll
L_act_ok:
  v_permlane32_swap_b32 v16, v17
  v_add_f32 v16, v16, v17
  v_fma_f32 v16, v16, v143, v152
  s_nop 1
  v_mov_b32_dpp v17, v16 quad_perm:[1,1,3,3] row_mask:0xf bank_mask:0xf
  v_cvt_pk_bf16_f32 v16, v16, v17
  s_mov_b64 exec, 0x55555555
  buffer_store_dword v16, v139, s[44:47], s58 offen
  s_mov_b64 exec, -1
L_fin:
L_end:
  s_endpgm
L_cnt_spin:
  ds_read_b32 v87, v88
  s_waitcnt lgkmcnt(0)
  v_readfirstlane_b32 s58, v87
  s_nop 0
  s_cmp_lg_u32 s58, 8
  s_cbranch_scc1 L_cnt_spin
  s_branch L_cnt_go
L_wot_spin:
  s_mov_b32 s75, 0
L_wot_poll:
  buffer_load_dword v12, v15, s[36:39], s59 offen sc1
  buffer_load_dword v13, v11, s[36:39], s59 offen offset:1024 sc1
  s_add_u32 s75, s75, 1
  s_waitcnt vmcnt(0)
  v_xor_b32 v9, s48, v12
  v_bitop3_b32 v9, v9, v13, s48 bitop3:0xf6
  v_cmp_ne_u32 s[76:77], 0, v9
  s_nop 0
  s_and_b64 s[76:77], s[76:77], exec
  s_cbranch_scc0 L_wot_ok
  s_cmp_ge_u32 s75, 262144
  s_cbranch_scc1 L_wot_ok
  s_sleep 1
  s_branch L_wot_poll
L_wot_ok:
  s_branch L_wot_go
L_p3_a:
  s_add_u32 s62, s52, s54
  s_add_u32 s62, s62, 1
  s_and_b32 s62, s62, 7
  v_lshrrev_b32 v4, 4, v1
  v_and_b32 v5, 15, v1
  v_lshlrev_b32 v5, 4, v5
  s_mov_b32 s44, s20
  s_mov_b32 s45, s21
  s_mov_b32 s46, 0x1c0000
  s_mov_b32 s47, 0x20000
  s_lshr_b32 s58, s3, 1
  s_lshl_b32 s58, s58, 6
  s_and_b32 s59, s3, 1
  s_mul_i32 s63, s59, 48
  s_add_u32 s63, s63, 8
  s_lshl_b32 s59, s59, 3
  s_add_u32 s58, s58, s59
  v_lshl_add_u32 v14, v4, 4, s58
  v_add_u32 v9, 131072, v14
  v_add_u32 v11, s63, v9
  v_bfe_u32 v2, v1, 2, 2
  v_and_b32 v3, 3, v1
  v_mul_u32_u24 v3, 912, v3
  v_lshl_add_u32 v3, v2, 14, v3
  v_add_u32 v8, v3, v14
  v_add_u32 v8, 12288, v8
  v_add_u32 v10, s63, v8
  v_mul_u32_u24 v7, 58, v5
  v_add_u32 v7, 65536, v7
  v_mul_u32_u24 v6, 12, v4
  s_mul_i32 s58, s62, 112
  v_add3_u32 v6, v6, v7, s58
  v_lshl_add_u32 v3, v4, 2, v5
  v_lshlrev_b32 v3, 3, v3
  v_add_u32 v3, 80896, v3
  s_lshl_b32 s58, s49, 2
  v_add_u32 v2, s58, v3
  v_lshl_add_u32 v5, v4, 4, v7
  s_lshl_b32 s58, s54, 14
  v_add_u32 v7, s58, v15
  ds_read_b64 v[128:129], v8 offset:0
  ds_read_b64 v[136:137], v9 offset:0
  ds_read_b64 v[130:131], v8 offset:8
  ds_read_b64 v[138:139], v9 offset:8
  ds_read_b64 v[132:133], v8 offset:64
  ds_read_b64 v[140:141], v9 offset:64
  ds_read_b64 v[134:135], v8 offset:72
  ds_read_b64 v[142:143], v9 offset:72
  s_waitcnt lgkmcnt(0)
  v_lshlrev_b32 v112, 16, v128
  v_and_b32 v113, 0xffff0000, v128
  v_lshlrev_b32 v160, 16, v136
  v_and_b32 v161, 0xffff0000, v136
  v_lshlrev_b32 v114, 16, v129
  v_and_b32 v115, 0xffff0000, v129
  v_lshlrev_b32 v162, 16, v137
  v_and_b32 v163, 0xffff0000, v137
  v_lshlrev_b32 v116, 16, v130
  v_and_b32 v117, 0xffff0000, v130
  v_lshlrev_b32 v164, 16, v138
  v_and_b32 v165, 0xffff0000, v138
  v_lshlrev_b32 v118, 16, v131
  v_and_b32 v119, 0xffff0000, v131
  v_lshlrev_b32 v166, 16, v139
  v_and_b32 v167, 0xffff0000, v139
  v_lshlrev_b32 v120, 16, v132
  v_and_b32 v121, 0xffff0000, v132
  v_lshlrev_b32 v168, 16, v140
  v_and_b32 v169, 0xffff0000, v140
  v_lshlrev_b32 v122, 16, v133
  v_and_b32 v123, 0xffff0000, v133
  v_lshlrev_b32 v170, 16, v141
  v_and_b32 v171, 0xffff0000, v141
  v_lshlrev_b32 v124, 16, v134
  v_and_b32 v125, 0xffff0000, v134
  v_lshlrev_b32 v172, 16, v142
  v_and_b32 v173, 0xffff0000, v142
  v_lshlrev_b32 v126, 16, v135
  v_and_b32 v127, 0xffff0000, v135
  v_lshlrev_b32 v174, 16, v143
  v_and_b32 v175, 0xffff0000, v143
  v_add_f32 v13, v160, v161
  v_add_f32 v13, v13, v162
  v_add_f32 v13, v13, v163
  v_add_f32 v13, v13, v164
  v_add_f32 v13, v13, v165
  v_add_f32 v13, v13, v166
  v_add_f32 v13, v13, v167
  v_add_f32 v13, v13, v168
  v_add_f32 v13, v13, v169
  v_add_f32 v13, v13, v170
  v_add_f32 v13, v13, v171
  v_add_f32 v13, v13, v172
  v_add_f32 v13, v13, v173
  v_add_f32 v13, v13, v174
  v_add_f32 v13, v13, v175
  s_mul_i32 s59, s2, 20480
  s_add_u32 s59, s59, 1638400
  s_mul_i32 s58, s62, 2560
  s_add_u32 s60, s59, s58
  s_xor_b32 s61, s62, 4
  s_sub_i32 s58, s61, s62
  s_mul_i32 s58, s58, 112
  v_add_u32 v10, 44, v6
  s_mov_b64 exec, 0xffff
  v_add_u32 v10, 4, v10
  s_mov_b64 exec, -1
  v_add_u32 v9, s58, v6
  v_add_u32 v11, s58, v10
  s_mul_i32 s61, s61, 2560
  s_add_u32 s61, s61, s59
  s_mov_b32 s75, 1
  v_mov_b32 v155, s48
  v_mov_b32 v139, s48
  s_barrier
L_og_first:
  buffer_load_dwordx4 v[144:147], v15, s[36:39], s60 offen offset:0 sc1
  buffer_load_dwordx4 v[148:151], v15, s[36:39], s60 offen offset:1024 sc1
  s_mov_b32 exec_hi, 0
  buffer_load_dwordx4 v[152:155], v15, s[36:39], s60 offen offset:2048 sc1
  s_mov_b32 exec_hi, -1
  buffer_load_dwordx4 v[128:131], v15, s[36:39], s61 offen offset:0 sc1
  buffer_load_dwordx4 v[132:135], v15, s[36:39], s61 offen offset:1024 sc1
  s_mov_b32 exec_hi, 0
  buffer_load_dwordx4 v[136:139], v15, s[36:39], s61 offen offset:2048 sc1
  s_mov_b32 exec_hi, -1
  s_waitcnt vmcnt(5)
  ds_write2_b32 v6, v144, v145 offset0:0 offset1:1
  ds_write_b32 v6, v146 offset:8
  v_xor_b32 v12, s48, v147
  s_waitcnt vmcnt(4)
  ds_write2_b32 v10, v148, v149 offset0:0 offset1:1
  v_bitop3_b32 v12, v12, v151, s48 bitop3:0xf6
  s_mov_b32 exec_lo, 0xffff0000
  ds_write_b32 v10, v150 offset:8
  s_mov_b32 exec_lo, -1
  s_waitcnt vmcnt(3)
  v_bitop3_b32 v12, v12, v155, s48 bitop3:0xf6
  v_cmp_ne_u32 s[76:77], 0, v12
  s_mov_b32 exec_hi, 0
  ds_write2_b32 v6, v152, v153 offset0:23 offset1:24
  s_mov_b32 exec_lo, 0xffff
  ds_write_b32 v6, v154 offset:100
  s_mov_b64 exec, -1
  s_waitcnt vmcnt(2)
  ds_write2_b32 v9, v128, v129 offset0:0 offset1:1
  ds_write_b32 v9, v130 offset:8
  v_xor_b32 v12, s48, v131
  s_waitcnt vmcnt(1)
  ds_write2_b32 v11, v132, v133 offset0:0 offset1:1
  v_bitop3_b32 v12, v12, v135, s48 bitop3:0xf6
  s_mov_b32 exec_lo, 0xffff0000
  ds_write_b32 v11, v134 offset:8
  s_mov_b32 exec_lo, -1
  s_waitcnt vmcnt(0)
  v_bitop3_b32 v12, v12, v139, s48 bitop3:0xf6
  v_cmp_ne_u32 s[78:79], 0, v12
  s_mov_b32 exec_hi, 0
  ds_write2_b32 v9, v136, v137 offset0:23 offset1:24
  s_mov_b32 exec_lo, 0xffff
  ds_write_b32 v9, v138 offset:100
  s_mov_b64 exec, -1
  s_or_b64 vcc, s[76:77], s[78:79]
  s_cbranch_scc0 L_og_ok
L_og_both:
  s_cmp_eq_u64 s[76:77], 0
  s_cbranch_scc1 L_og1_chk
  s_cmp_eq_u64 s[78:79], 0
  s_cbranch_scc1 L_og0_chk
  s_add_u32 s75, s75, 1
  s_cmp_lt_u32 s75, 262144
  s_cbranch_scc1 L_og_first
L_og0_chk:
  s_cmp_eq_u64 s[76:77], 0
  s_cbranch_scc1 L_og0_ok
  s_cmp_ge_u32 s75, 262144
  s_cbranch_scc1 L_og0_ok
  s_add_u32 s75, s75, 1
  buffer_load_dwordx4 v[144:147], v15, s[36:39], s60 offen offset:0 sc1
  buffer_load_dwordx4 v[148:151], v15, s[36:39], s60 offen offset:1024 sc1
  s_mov_b32 exec_hi, 0
  buffer_load_dwordx4 v[152:155], v15, s[36:39], s60 offen offset:2048 sc1
  s_mov_b32 exec_hi, -1
  s_waitcnt vmcnt(2)
  ds_write2_b32 v6, v144, v145 offset0:0 offset1:1
  ds_write_b32 v6, v146 offset:8
  v_xor_b32 v12, s48, v147
  s_waitcnt vmcnt(1)
  ds_write2_b32 v10, v148, v149 offset0:0 offset1:1
  v_bitop3_b32 v12, v12, v151, s48 bitop3:0xf6
  s_mov_b32 exec_lo, 0xffff0000
  ds_write_b32 v10, v150 offset:8
  s_mov_b32 exec_lo, -1
  s_waitcnt vmcnt(0)
  v_bitop3_b32 v12, v12, v155, s48 bitop3:0xf6
  v_cmp_ne_u32 s[76:77], 0, v12
  s_mov_b32 exec_hi, 0
  ds_write2_b32 v6, v152, v153 offset0:23 offset1:24
  s_mov_b32 exec_lo, 0xffff
  ds_write_b32 v6, v154 offset:100
  s_mov_b64 exec, -1
  s_branch L_og0_chk
L_og0_ok:
L_og1_chk:
  s_cmp_eq_u64 s[78:79], 0
  s_cbranch_scc1 L_og1_ok
  s_cmp_ge_u32 s75, 262144
  s_cbranch_scc1 L_og1_ok
  s_add_u32 s75, s75, 1
  buffer_load_dwordx4 v[128:131], v15, s[36:39], s61 offen offset:0 sc1
  buffer_load_dwordx4 v[132:135], v15, s[36:39], s61 offen offset:1024 sc1
  s_mov_b32 exec_hi, 0
  buffer_load_dwordx4 v[136:139], v15, s[36:39], s61 offen offset:2048 sc1
  s_mov_b32 exec_hi, -1
  s_waitcnt vmcnt(2)
  ds_write2_b32 v9, v128, v129 offset0:0 offset1:1
  ds_write_b32 v9, v130 offset:8
  v_xor_b32 v12, s48, v131
  s_waitcnt vmcnt(1)
  ds_write2_b32 v11, v132, v133 offset0:0 offset1:1
  v_bitop3_b32 v12, v12, v135, s48 bitop3:0xf6
  s_mov_b32 exec_lo, 0xffff0000
  ds_write_b32 v11, v134 offset:8
  s_mov_b32 exec_lo, -1
  s_waitcnt vmcnt(0)
  v_bitop3_b32 v12, v12, v139, s48 bitop3:0xf6
  v_cmp_ne_u32 s[78:79], 0, v12
  s_mov_b32 exec_hi, 0
  ds_write2_b32 v9, v136, v137 offset0:23 offset1:24
  s_mov_b32 exec_lo, 0xffff
  ds_write_b32 v9, v138 offset:100
  s_mov_b64 exec, -1
  s_branch L_og1_chk
L_og1_ok:
L_og_ok:
  s_waitcnt lgkmcnt(0)
  s_barrier
  ds_read_b128 v[128:131], v5 offset:0
  ds_read_b128 v[132:135], v5 offset:64
  ds_read_b128 v[136:139], v5 offset:128
  ds_read_b128 v[140:143], v5 offset:192
  s_waitcnt lgkmcnt(3)
  v_mfma_f32_16x16x32_bf16 v[112:115], v[176:179], v[128:131], v[112:115]
  v_mfma_f32_16x16x32_bf16 v[116:119], v[180:183], v[128:131], v[116:119]
  v_mfma_f32_16x16x32_bf16 v[120:123], v[184:187], v[128:131], v[120:123]
  v_mfma_f32_16x16x32_bf16 v[124:127], v[188:191], v[128:131], v[124:127]
  ds_read_b128 v[128:131], v5 offset:256
  s_waitcnt lgkmcnt(3)
  v_mfma_f32_16x16x32_bf16 v[112:115], v[192:195], v[132:135], v[112:115]
  v_mfma_f32_16x16x32_bf16 v[116:119], v[196:199], v[132:135], v[116:119]
  ds_read_b128 v[176:179], v7 offset:0
  v_mfma_f32_16x16x32_bf16 v[120:123], v[200:203], v[132:135], v[120:123]
  v_mfma_f32_16x16x32_bf16 v[124:127], v[204:207], v[132:135], v[124:127]
  ds_read_b128 v[180:183], v7 offset:1024
  ds_read_b128 v[132:135], v5 offset:320
  s_waitcnt lgkmcnt(5)
  v_mfma_f32_16x16x32_bf16 v[112:115], v[208:211], v[136:139], v[112:115]
  v_mfma_f32_16x16x32_bf16 v[116:119], v[212:215], v[136:139], v[116:119]
  ds_read_b128 v[184:187], v7 offset:2048
  v_mfma_f32_16x16x32_bf16 v[120:123], v[216:219], v[136:139], v[120:123]
  v_mfma_f32_16x16x32_bf16 v[124:127], v[220:223], v[136:139], v[124:127]
  ds_read_b128 v[188:191], v7 offset:3072
  ds_read_b128 v[136:139], v5 offset:384
  s_waitcnt lgkmcnt(7)
  v_mfma_f32_16x16x32_bf16 v[112:115], v[224:227], v[140:143], v[112:115]
  v_mfma_f32_16x16x32_bf16 v[116:119], v[228:231], v[140:143], v[116:119]
  ds_read_b128 v[192:195], v7 offset:4096
  v_mfma_f32_16x16x32_bf16 v[120:123], v[232:235], v[140:143], v[120:123]
  v_mfma_f32_16x16x32_bf16 v[124:127], v[236:239], v[140:143], v[124:127]
  ds_read_b128 v[196:199], v7 offset:5120
  ds_read_b128 v[140:143], v5 offset:448
  s_waitcnt lgkmcnt(9)
  v_mfma_f32_16x16x32_bf16 v[112:115], v[240:243], v[128:131], v[112:115]
  v_mfma_f32_16x16x32_bf16 v[116:119], v[244:247], v[128:131], v[116:119]
  ds_read_b128 v[200:203], v7 offset:6144
  v_mfma_f32_16x16x32_bf16 v[120:123], v[248:251], v[128:131], v[120:123]
  v_mfma_f32_16x16x32_bf16 v[124:127], v[252:255], v[128:131], v[124:127]
  ds_read_b128 v[204:207], v7 offset:7168
  ds_read_b128 v[128:131], v5 offset:512
  s_waitcnt lgkmcnt(9)
  v_mfma_f32_16x16x32_bf16 v[112:115], v[16:19], v[132:135], v[112:115]
  v_mfma_f32_16x16x32_bf16 v[116:119], v[20:23], v[132:135], v[116:119]
  ds_read_b128 v[208:211], v7 offset:8192
  v_mfma_f32_16x16x32_bf16 v[120:123], v[24:27], v[132:135], v[120:123]
  v_mfma_f32_16x16x32_bf16 v[124:127], v[28:31], v[132:135], v[124:127]
  ds_read_b128 v[212:215], v7 offset:9216
  ds_read_b128 v[132:135], v5 offset:576
  s_waitcnt lgkmcnt(9)
  v_mfma_f32_16x16x32_bf16 v[112:115], v[32:35], v[136:139], v[112:115]
  v_mfma_f32_16x16x32_bf16 v[116:119], v[36:39], v[136:139], v[116:119]
  ds_read_b128 v[216:219], v7 offset:10240
  v_mfma_f32_16x16x32_bf16 v[120:123], v[40:43], v[136:139], v[120:123]
  v_mfma_f32_16x16x32_bf16 v[124:127], v[44:47], v[136:139], v[124:127]
  ds_read_b128 v[220:223], v7 offset:11264
  ds_read_b128 v[136:139], v5 offset:640
  s_waitcnt lgkmcnt(9)
  v_mfma_f32_16x16x32_bf16 v[112:115], v[48:51], v[140:143], v[112:115]
  v_mfma_f32_16x16x32_bf16 v[116:119], v[52:55], v[140:143], v[116:119]
  v_mfma_f32_16x16x32_bf16 v[120:123], v[56:59], v[140:143], v[120:123]
  v_mfma_f32_16x16x32_bf16 v[124:127], v[60:63], v[140:143], v[124:127]
  ds_read_b128 v[140:143], v5 offset:704
  s_waitcnt lgkmcnt(7)
  v_mfma_f32_16x16x32_bf16 v[112:115], v[64:67], v[128:131], v[112:115]
  v_mfma_f32_16x16x32_bf16 v[116:119], v[68:71], v[128:131], v[116:119]
  v_mfma_f32_16x16x32_bf16 v[120:123], v[72:75], v[128:131], v[120:123]
  v_mfma_f32_16x16x32_bf16 v[124:127], v[76:79], v[128:131], v[124:127]
  ds_read_b128 v[128:131], v5 offset:768
  s_waitcnt lgkmcnt(5)
  v_mfma_f32_16x16x32_bf16 v[112:115], v[80:83], v[132:135], v[112:115]
  v_mfma_f32_16x16x32_bf16 v[116:119], v[84:87], v[132:135], v[116:119]
  v_mfma_f32_16x16x32_bf16 v[120:123], v[88:91], v[132:135], v[120:123]
  v_mfma_f32_16x16x32_bf16 v[124:127], v[92:95], v[132:135], v[124:127]
  ds_read_b128 v[132:135], v5 offset:832
  s_waitcnt lgkmcnt(3)
  v_mfma_f32_16x16x32_bf16 v[112:115], v[96:99], v[136:139], v[112:115]
  v_mfma_f32_16x16x32_bf16 v[116:119], v[100:103], v[136:139], v[116:119]
  v_mfma_f32_16x16x32_bf16 v[120:123], v[104:107], v[136:139], v[120:123]
  v_mfma_f32_16x16x32_bf16 v[124:127], v[108:111], v[136:139], v[124:127]
  s_waitcnt lgkmcnt(2)
  v_mfma_f32_16x16x32_bf16 v[112:115], v[176:179], v[140:143], v[112:115]
  v_mfma_f32_16x16x32_bf16 v[116:119], v[180:183], v[140:143], v[116:119]
  v_mfma_f32_16x16x32_bf16 v[120:123], v[184:187], v[140:143], v[120:123]
  v_mfma_f32_16x16x32_bf16 v[124:127], v[188:191], v[140:143], v[124:127]
  s_waitcnt lgkmcnt(1)
  v_mfma_f32_16x16x32_bf16 v[112:115], v[192:195], v[128:131], v[112:115]
  v_mfma_f32_16x16x32_bf16 v[116:119], v[196:199], v[128:131], v[116:119]
  v_mfma_f32_16x16x32_bf16 v[120:123], v[200:203], v[128:131], v[120:123]
  v_mfma_f32_16x16x32_bf16 v[124:127], v[204:207], v[128:131], v[124:127]
  s_waitcnt lgkmcnt(0)
  v_mfma_f32_16x16x32_bf16 v[112:115], v[208:211], v[132:135], v[112:115]
  v_mfma_f32_16x16x32_bf16 v[116:119], v[212:215], v[132:135], v[116:119]
  v_mfma_f32_16x16x32_bf16 v[120:123], v[216:219], v[132:135], v[120:123]
  v_mfma_f32_16x16x32_bf16 v[124:127], v[220:223], v[132:135], v[124:127]
  s_nop 4
  v_mul_f32 v146, v112, v112
  v_mul_f32 v148, v112, v160
  v_add_f32 v144, v112, v113
  v_fmac_f32 v146, v113, v113
  v_fmac_f32 v148, v113, v161
  v_add_f32 v144, v144, v114
  v_fmac_f32 v146, v114, v114
  v_fmac_f32 v148, v114, v162
  v_add_f32 v144, v144, v115
  v_fmac_f32 v146, v115, v115
  v_fmac_f32 v148, v115, v163
  v_add_f32 v144, v144, v116
  v_fmac_f32 v146, v116, v116
  v_fmac_f32 v148, v116, v164
  v_add_f32 v144, v144, v117
  v_fmac_f32 v146, v117, v117
  v_fmac_f32 v148, v117, v165
  v_add_f32 v144, v144, v118
  v_fmac_f32 v146, v118, v118
  v_fmac_f32 v148, v118, v166
  v_add_f32 v144, v144, v119
  v_fmac_f32 v146, v119, v119
  v_fmac_f32 v148, v119, v167
  v_add_f32 v144, v144, v120
  v_fmac_f32 v146, v120, v120
  v_fmac_f32 v148, v120, v168
  v_add_f32 v144, v144, v121
  v_fmac_f32 v146, v121, v121
  v_fmac_f32 v148, v121, v169
  v_add_f32 v144, v144, v122
  v_fmac_f32 v146, v122, v122
  v_fmac_f32 v148, v122, v170
  v_add_f32 v144, v144, v123
  v_fmac_f32 v146, v123, v123
  v_fmac_f32 v148, v123, v171
  v_add_f32 v144, v144, v124
  v_fmac_f32 v146, v124, v124
  v_fmac_f32 v148, v124, v172
  v_add_f32 v144, v144, v125
  v_fmac_f32 v146, v125, v125
  v_fmac_f32 v148, v125, v173
  v_add_f32 v144, v144, v126
  v_fmac_f32 v146, v126, v126
  v_fmac_f32 v148, v126, v174
  v_add_f32 v144, v144, v127
  v_fmac_f32 v146, v127, v127
  v_fmac_f32 v148, v127, v175
  s_branch L_p3_j
L_hn2_spin:
  s_mov_b32 s75, 0
L_hn2_poll:
  buffer_load_dwordx2 v[144:145], v141, s[36:39], s62 offen sc1
  s_add_u32 s75, s75, 1
  s_waitcnt vmcnt(0)
  v_xor_b32 v12, s48, v145
  v_cmp_ne_u32 s[76:77], 0, v12
  s_nop 0
  s_and_b64 s[76:77], s[76:77], exec
  s_cbranch_scc0 L_hn2_ok
  s_cmp_ge_u32 s75, 262144
  s_cbranch_scc1 L_hn2_ok
  s_sleep 1
  s_branch L_hn2_poll
L_hn2_ok:
  s_branch L_hn2_go
L_scout:
  s_cmp_lg_u32 s52, 7
  s_cbranch_scc1 L_fin
  s_lshl_b32 s58, s91, 3
  s_add_u32 s58, s58, s49
  s_cmp_lg_u32 s58, 228
  s_cbranch_scc1 L_fin
  v_lshlrev_b32 v2, 7, v1
  v_add_u32 v2, 86016, v2
  s_movk_i32 s58, 0x2000
  v_and_b32 v16, 15, v1
  v_min_u32 v16, 13, v16
  v_lshlrev_b32 v16, 7, v16
  v_lshrrev_b32 v17, 5, v1
  v_mul_u32_u24 v17, 524288, v17
  v_add_u32 v16, v16, v17
  s_mov_b32 s59, 131072
  s_mov_b64 s[76:77], -1
  s_mov_b64 s[78:79], -1
  s_mov_b32 s75, 0
L_sc_poll:
  s_mov_b64 exec, s[76:77]
  s_cbranch_execz L_sc_skip0
  buffer_load_dwordx4 v[4:7], v2, s[36:39], 0 offen sc1
L_sc_skip0:
  s_mov_b64 exec, s[78:79]
  s_cbranch_execz L_sc_skip1
  buffer_load_dwordx4 v[8:11], v2, s[36:39], s58 offen sc1
L_sc_skip1:
  s_add_u32 s75, s75, 1
  s_waitcnt vmcnt(0)
  s_mov_b64 exec, s[78:79]
  v_xor_b32 v12, s48, v9
  v_bitop3_b32 v12, v12, v11, s48 bitop3:0xf6
  v_cmp_ne_u32 s[78:79], 0, v12
  s_nop 0
  s_mov_b64 exec, s[78:79]
  v_mov_b32 v8, 0
  v_mov_b32 v10, 0
  s_mov_b64 exec, s[76:77]
  v_xor_b32 v12, s48, v5
  v_bitop3_b32 v12, v12, v7, s48 bitop3:0xf6
  v_cmp_ne_u32 s[76:77], 0, v12
  s_nop 0
  s_mov_b64 exec, s[76:77]
  v_mov_b32 v4, 0
  v_mov_b32 v6, 0
  s_mov_b64 exec, -1
  s_or_b64 vcc, s[76:77], s[78:79]
  s_cbranch_scc0 L_fin
  s_cmp_ge_u32 s75, 262144
  s_cbranch_scc1 L_fin
  s_bcnt1_i32_b64 s60, s[76:77]
  s_bcnt1_i32_b64 s61, s[78:79]
  s_add_u32 s60, s60, s61
  s_cmp_gt_u32 s60, 112
  s_cbranch_scc1 L_sc_poll
  v_max_u32 v18, v4, v8
  v_min_u32 v12, v4, v8
  v_max3_u32 v19, v6, v10, v12
  s_mov_b32 vcc_lo, 0xffff0000
  s_mov_b32 vcc_hi, 0xffff0000
  v_min_u32_dpp v12, v18, v18 row_ror:8 row_mask:0xf bank_mask:0xf
  v_max_u32_dpp v18, v18, v18 row_ror:8 row_mask:0xf bank_mask:0xf
  v_max_u32_dpp v19, v19, v19 row_ror:8 row_mask:0xf bank_mask:0xf
  v_max_u32 v19, v19, v12
  s_nop 0
  v_min_u32_dpp v12, v18, v18 row_ror:4 row_mask:0xf bank_mask:0xf
  v_max_u32_dpp v18, v18, v18 row_ror:4 row_mask:0xf bank_mask:0xf
  v_max_u32_dpp v19, v19, v19 row_ror:4 row_mask:0xf bank_mask:0xf
  v_max_u32 v19, v19, v12
  s_nop 0
  v_min_u32_dpp v12, v18, v18 row_ror:2 row_mask:0xf bank_mask:0xf
  v_max_u32_dpp v18, v18, v18 row_ror:2 row_mask:0xf bank_mask:0xf
  v_max_u32_dpp v19, v19, v19 row_ror:2 row_mask:0xf bank_mask:0xf
  v_max_u32 v19, v19, v12
  s_nop 0
  v_min_u32_dpp v12, v18, v18 row_ror:1 row_mask:0xf bank_mask:0xf
  v_max_u32_dpp v18, v18, v18 row_ror:1 row_mask:0xf bank_mask:0xf
  v_max_u32_dpp v19, v19, v19 row_ror:1 row_mask:0xf bank_mask:0xf
  v_max_u32 v19, v19, v12
  v_mov_b32 v12, v18
  v_mov_b32 v3, v19
  s_nop 0
  v_permlane16_swap_b32 v12, v18
  v_permlane16_swap_b32 v3, v19
  v_max_u32 v19, v19, v3
  v_min_u32 v3, v12, v18
  v_max_u32 v18, v12, v18
  v_max_u32 v19, v19, v3
  v_mov_b32 v12, v18
  v_mov_b32 v3, v19
  s_nop 0
  v_permlane32_swap_b32 v12, v18
  v_permlane32_swap_b32 v3, v19
  v_max_u32 v19, v19, v3
  v_min_u32 v3, v12, v18
  v_max_u32 v18, v12, v18
  v_max_u32 v19, v19, v3
  v_cndmask_b32 v18, v18, v19, vcc
  v_not_b32 v3, v18
  v_and_b32 v12, 1, v18
  v_bfe_u32 v3, v3, 5, 7
  v_lshl_add_u32 v12, v12, 11, v16
  v_lshl_add_u32 v3, v3, 12, v12
  s_mov_b32 exec_hi, 0
  buffer_load_dword v20, v3, s[36:39], s59 offen sc1
  s_branch L_sc_poll
L_code_end:
L_sts_5:
  buffer_store_dwordx4 v[64:67], v90, s[36:39], s62 offen offset:0 sc1
  buffer_store_dwordx4 v[68:71], v90, s[36:39], s62 offen offset:1024 sc1
  s_branch L_std_6
L_sts_7:
  buffer_store_dwordx4 v[72:75], v90, s[36:39], s63 offen offset:0 sc1
  buffer_store_dwordx4 v[76:79], v90, s[36:39], s63 offen offset:1024 sc1
  s_branch L_std_8
L_sts_9:
  buffer_store_dwordx4 v[64:67], v90, s[36:39], s62 offen offset:0 sc1
  buffer_store_dwordx4 v[68:71], v90, s[36:39], s62 offen offset:1024 sc1
  s_branch L_std_10
L_sts_11:
  buffer_store_dwordx4 v[72:75], v90, s[36:39], s63 offen offset:0 sc1
  buffer_store_dwordx4 v[76:79], v90, s[36:39], s63 offen offset:1024 sc1
  s_branch L_std_12
L_flag_slow:
  buffer_store_dword v2, v80, s[36:39], s60 offen sc1
  s_branch L_flag_done
L_yp_slow:
  buffer_store_dwordx4 v[224:227], v14, s[36:39], s63 offen sc1
  s_branch L_yp_done
L_slow:
  s_lshl_b32 s58, s52, 9
  s_add_u32 s58, s58, 36864
  v_and_b32 v10, 31, v1
  v_lshl_add_u32 v10, v10, 4, s58
  s_mov_b32 s75, 0
L_slowf_poll:
  buffer_load_dwordx4 v[112:115], v10, s[36:39], 0 offen sc1
  s_add_u32 s75, s75, 1
  s_waitcnt vmcnt(0)
  v_xor_b32 v12, s48, v112
  v_bitop3_b32 v12, v12, v113, s48 bitop3:0xf6
  v_bitop3_b32 v12, v12, v114, s48 bitop3:0xf6
  v_bitop3_b32 v12, v12, v115, s48 bitop3:0xf6
  v_cmp_ne_u32 s[76:77], 0, v12
  s_nop 0
  s_and_b64 s[76:77], s[76:77], exec
  s_cbranch_scc0 L_slowf_ok
  s_cmp_ge_u32 s75, 262144
  s_cbranch_scc1 L_slowf_ok
  s_sleep 1
  s_branch L_slowf_poll
L_slowf_ok:
  v_mov_b32 v11, 0xff800000
  s_lshl_b32 s59, s51, 18
  s_add_u32 s59, s59, 6291456
  s_mov_b32 s58, s59
  s_add_u32 s62, s59, 262144
  s_waitcnt lgkmcnt(0)
L_slow1:
  buffer_load_dwordx4 v[120:123], v15, s[36:39], s58 offen sc1
  buffer_load_dwordx4 v[124:127], v15, s[36:39], s58 offen offset:1024 sc1
  s_waitcnt vmcnt(0)
  v_mfma_f32_32x32x16_bf16 v[136:151], v[120:123], v[40:43], 0
  v_mfma_f32_32x32x16_bf16 v[136:151], v[124:127], v[44:47], v[136:151]
  s_nop 11
  v_max3_f32 v11, v11, v136, v137
  v_max3_f32 v11, v11, v138, v139
  v_max3_f32 v11, v11, v140, v141
  v_max3_f32 v11, v11, v142, v143
  v_max3_f32 v11, v11, v144, v145
  v_max3_f32 v11, v11, v146, v147
  v_max3_f32 v11, v11, v148, v149
  v_max3_f32 v11, v11, v150, v151
  s_add_u32 s58, s58, 4096
  s_cmp_lt_u32 s58, s62
  s_cbranch_scc1 L_slow1
  v_mov_b32 v10, v11
  s_nop 1
  v_permlane32_swap_b32 v10, v11
  v_max_f32 v11, v11, v10
  s_mov_b32 s58, s59
  v_mov_b32 v160, 0
  v_mov_b32 v161, 0
  v_mov_b32 v162, 0
  v_mov_b32 v163, 0
  v_mov_b32 v164, 0
  v_mov_b32 v165, 0
  v_mov_b32 v166, 0
  v_mov_b32 v167, 0
  v_mov_b32 v168, 0
  v_mov_b32 v169, 0
  v_mov_b32 v170, 0
  v_mov_b32 v171, 0
  v_mov_b32 v172, 0
  v_mov_b32 v173, 0
  v_mov_b32 v174, 0
  v_mov_b32 v175, 0
L_slow2:
  buffer_load_dwordx4 v[120:123], v15, s[36:39], s58 offen sc1
  buffer_load_dwordx4 v[124:127], v15, s[36:39], s58 offen offset:1024 sc1
  buffer_load_dwordx4 v[128:131], v15, s[36:39], s58 offen offset:2048 sc1
  buffer_load_dwordx4 v[132:135], v15, s[36:39], s58 offen offset:3072 sc1
  s_waitcnt vmcnt(0)
  v_mfma_f32_32x32x16_bf16 v[136:151], v[120:123], v[40:43], 0
  v_mfma_f32_32x32x16_bf16 v[136:151], v[124:127], v[44:47], v[136:151]
  s_nop 11
  v_sub_f32 v136, v136, v11
  v_sub_f32 v137, v137, v11
  v_sub_f32 v138, v138, v11
  v_sub_f32 v139, v139, v11
  v_sub_f32 v140, v140, v11
  v_sub_f32 v141, v141, v11
  v_sub_f32 v142, v142, v11
  v_sub_f32 v143, v143, v11
  v_sub_f32 v144, v144, v11
  v_sub_f32 v145, v145, v11
  v_sub_f32 v146, v146, v11
  v_sub_f32 v147, v147, v11
  v_sub_f32 v148, v148, v11
  v_sub_f32 v149, v149, v11
  v_sub_f32 v150, v150, v11
  v_sub_f32 v151, v151, v11
  v_exp_f32 v136, v136
  v_exp_f32 v137, v137
  v_exp_f32 v138, v138
  v_exp_f32 v139, v139
  v_exp_f32 v140, v140
  v_exp_f32 v141, v141
  v_exp_f32 v142, v142
  v_exp_f32 v143, v143
  v_exp_f32 v144, v144
  v_exp_f32 v145, v145
  v_exp_f32 v146, v146
  v_exp_f32 v147, v147
  v_exp_f32 v148, v148
  v_exp_f32 v149, v149
  v_exp_f32 v150, v150
  v_exp_f32 v151, v151
  s_nop 1
  v_smfmac_f32_32x32x32_bf16 v[160:175], v[128:131], v[136:143], v14
  v_smfmac_f32_32x32x32_bf16 v[160:175], v[132:135], v[144:151], v14
  s_add_u32 s58, s58, 4096
  s_cmp_lt_u32 s58, s62
  s_cbranch_scc1 L_slow2
  s_nop 11
  v_mov_b32 v9, v172
  v_mov_b32 v10, v172
  v_mov_b32 v115, s48
  v_mov_b32 v119, s48
  v_mov_b32 v123, s48
  v_permlane32_swap_b32 v9, v10
  v_rcp_f32 v9, v10
  s_nop 0
  s_branch L_norm2
.section .rodata,"a"
.p2align 6
.amdhsa_kernel sequential_preLN__mha_block__moe_arch_mod__prompt_kernel
  .amdhsa_next_free_vgpr 256
  .amdhsa_next_free_sgpr 102
  .amdhsa_accum_offset 256
  .amdhsa_group_segment_fixed_size 0
  .amdhsa_kernarg_size 88
  .amdhsa_user_sgpr_count 2
  .amdhsa_user_sgpr_kernarg_segment_ptr 1
  .amdhsa_system_sgpr_workgroup_id_x 1
  .amdhsa_float_denorm_mode_32 3
.end_amdhsa_kernel
```
